```python
import torch

def _softmax(x, axis=-1):
    return torch.softmax(x, dim=axis)
def _gelu(x):
    return torch.nn.functional.gelu(x, approximate="tanh")
def _silu(x):
    return torch.nn.functional.silu(x)
def _sigmoid(x):
    return torch.sigmoid(x)
def _layernorm(x, axis=-1, eps=1e-5):
    m = x.mean(dim=axis, keepdim=True)
    v = x.var(dim=axis, keepdim=True, unbiased=False)
    return (x - m) / torch.sqrt(v + eps)
def _scatter_add(tgt, idx, src, axis=0):
    return tgt.clone().index_add_(axis, idx, src)
def _segment_sum(src, seg, n):
    out = torch.zeros((n,) + src.shape[1:], dtype=src.dtype)
    return out.index_add_(0, seg, src)
def _pad(x, pw):
    flat = tuple(v for pair in reversed(pw) for v in pair)
    return torch.nn.functional.pad(x, flat)

kernel_name = 'interleave_layers__sliding_local_dilated__dense_activation_relu__prompt'

def setup_inputs():

    _w = (lambda a: (lambda t: t.to(torch.bfloat16) if t.is_floating_point() else t)(torch.as_tensor(a)))
    def _A_setup():
        B, S, D = 1, 2048, 512
        return {
            "x": _w((lambda *s: torch.randn(*s, dtype=torch.bfloat16) * 0.05)(B, S, D)),
            "wqkv": _w((lambda *s: torch.randn(*s, dtype=torch.bfloat16) * 0.05)(D, 3 * D)),
            "wo": _w((lambda *s: torch.randn(*s, dtype=torch.bfloat16) * 0.05)(D, D)),
        }
    _A_in = _A_setup()

    def _B_setup():
        B, S, D, Dff = 1, 2048, 512, 1376
        return {
            "x": _w((lambda *s: torch.randn(*s, dtype=torch.bfloat16) * 0.05)(B, S, D)),
            "w1": _w((lambda *s: torch.randn(*s, dtype=torch.bfloat16) * 0.05)(D, Dff)),
            "w2": _w((lambda *s: torch.randn(*s, dtype=torch.bfloat16) * 0.05)(Dff, D)),
        }
    _B_in = _B_setup()

    return {
        "A_x": _A_in["x"],
        "A_wqkv": _A_in["wqkv"],
        "A_wo": _A_in["wo"],
        "B_x": _B_in["x"],
        "B_w1": _B_in["w1"],
        "B_w2": _B_in["w2"],
    }

def reference(A_x, A_wqkv, A_wo, B_x, B_w1, B_w2):
    def _A_ref(x, wqkv, wo):
        B, S, D = x.shape
        H = 32; Dh = D // H
        W, dil = 8, 2
        qkv = (lambda x, *d: x.permute(*d))((x @ wqkv).reshape(B, S, 3, H, Dh), 2, 0, 3, 1, 4)
        q, k, v = qkv[0], qkv[1], qkv[2]
        scale = Dh ** -0.5
        pos = torch.arange(S)
        off = torch.arange(W) * dil
        idx = pos[:, None] - off[None, :]
        mask = idx >= 0
        idx_c = torch.where(mask, idx, 0).reshape(-1)
        kg = k[:, :, idx_c, :].reshape(B, H, S, W, Dh)
        vg = v[:, :, idx_c, :].reshape(B, H, S, W, Dh)
        logits = torch.einsum("bhsd,bhswd->bhsw", q, kg) * scale
        logits = torch.where(mask[None, None, :, :], logits, -1e9)
        attn = _softmax(logits, axis=-1)
        o = torch.einsum("bhsw,bhswd->bhsd", attn, vg)
        return (lambda x, *d: x.permute(*d))(o, 0, 2, 1, 3).reshape(B, S, D) @ wo

    def _B_ref(x, w1, w2):
        h = torch.einsum("bsd,df->bsf", x, w1)
        zero = torch.zeros_like(h)
        h = torch.maximum(h, zero)
        return torch.einsum("bsf,fd->bsd", h, w2)

    x = A_x
    x = x + _A_ref(_layernorm(x, axis=-1), A_wqkv, A_wo)
    x = x + _B_ref(_layernorm(x, axis=-1), B_w1, B_w2)
    x = x + _A_ref(_layernorm(x, axis=-1), A_wqkv, A_wo)
    x = x + _B_ref(_layernorm(x, axis=-1), B_w1, B_w2)
    return x
```

```asm
; @launch grid=(256,1,1) block=(256,1,1) lds=163840
.amdgcn_target "amdgcn-amd-amdhsa--gfx950"
.text
.globl interleave_layers__sliding_local_dilated__dense_activation_relu__prompt_kernel
.p2align 12
.p2align 8
.type interleave_layers__sliding_local_dilated__dense_activation_relu__prompt_kernel,@function
interleave_layers__sliding_local_dilated__dense_activation_relu__prompt_kernel:
    s_load_dwordx16 s[80:95], s[0:1], 0
    s_load_dwordx2 s[16:17], s[0:1], 64
    s_cmpk_ge_u32 s2, 256
    s_cbranch_scc1 L_end
    v_lshrrev_b32 v11, 6, v0
    v_and_b32 v0, 63, v0
    v_readfirstlane_b32 s6, v11
    s_getpc_b64 s[8:9]
    s_lshr_b32 s3, s2, 3
    s_lshl2_add_u32 s3, s3, s6
    s_mulk_i32 s3, 384
    v_lshl_add_u32 v12, v0, 7, s3
    s_mov_b64 exec, 7
    global_load_dword v126, v12, s[8:9]
    s_mov_b64 exec, -1
    s_and_b32 s3, s2, 7
    s_lshr_b32 s4, s2, 6
    s_lshl2_add_u32 s4, s3, s4
    s_bfe_u32 s5, s2, 0x30003
    v_lshrrev_b32 v10, 4, v0
    v_lshrrev_b32 v40, 3, v0
    v_and_b32 v9, 7, v0
    v_xor_b32 v11, v9, v10
    v_lshlrev_b32 v11, 4, v11
    v_lshl_add_u32 v26, v40, 10, v11
    v_xor_b32 v27, 64, v26
    v_add_u32 v27, 0x1c00, v27
    s_lshl_b32 s44, s6, 14
    s_lshl_b32 s3, s4, 16
    s_add_u32 s47, s3, s44
    s_lshl_b32 s3, s5, 7
    s_add_u32 s57, s47, s3
    s_mov_b32 m0, s44
    v_add_u32 v13, s57, v26
    v_add_u32 v14, s57, v27
    s_lshl2_add_u32 s62, s2, s6
    s_mul_i32 s3, s62, 1536
    v_lshl_add_u32 v12, v0, 7, s3
    s_waitcnt lgkmcnt(0)
    s_load_dword s86, s[82:83], 0
    global_load_lds_dwordx4 v13, s[80:81] nt
    global_load_lds_dwordx4 v14, s[80:81] offset:1024 nt
    s_mov_b64 exec, 0xfff
    global_load_dword v126, v12, s[82:83]
    s_mov_b64 exec, -1
L_head_end:
    s_load_dwordx2 s[60:61], s[16:17], 0
    s_load_dword s86, s[88:89], 0
    s_load_dword s86, s[90:91], 0
    s_load_dword s86, s[84:85], 0
    s_load_dword s86, s[92:93], 0
    s_mov_b32 s8, s80
    s_mov_b32 s9, s81
    s_mov_b32 s12, s82
    s_mov_b32 s13, s83
    s_mov_b32 s10, 0x200000
    s_mov_b32 s11, 0x20000
    s_mov_b32 s14, 1572864
    s_mov_b32 s15, 0x20000
    s_lshr_b32 s24, s6, 1
    s_and_b32 s25, s6, 1
    s_mov_b32 s3, 1969500448
    s_mov_b32 s56, 1985167888
    s_bitcmp1_b32 s2, 6
    s_cselect_b32 s3, 1733567248, s3
    s_cselect_b32 s56, 1984246288, s56
    s_bitcmp1_b32 s2, 7
    s_cselect_b32 s56, s56, s3
    s_mul_i32 s3, s5, 0x11111111
    s_add_u32 s56, s56, s3
    s_and_b32 s56, s56, 0x77777777
    v_and_b32 v13, 1, v10
    s_lshl_b32 s3, s25, 1
    v_or_b32 v11, s3, v13
    v_lshlrev_b32 v11, 1, v11
    v_xor_b32 v11, v11, v9
    v_mul_u32_u24 v28, 3072, v40
    v_lshl_add_u32 v28, v11, 4, v28
    s_mul_i32 s29, s6, 3072
    s_lshl_b32 s3, s5, 7
    s_lshl3_add_u32 s3, s29, s3
    v_add_u32 v28, s3, v28
    s_lshl_b32 s3, s4, 16
    s_sub_u32 s3, s3, 16384
    s_max_i32 s28, s3, 0
    s_mul_i32 s3, s25, 0x2040
    v_xor_b32 v158, s3, v26
    s_sub_u32 s58, 0x180, s82
    s_and_b32 s58, s58, 0x380
    s_mul_i32 s58, s58, 1537
    s_lshr_b32 s3, s2, 3
    s_lshl2_add_u32 s3, s3, s6
    s_mulk_i32 s3, 3072
    s_add_u32 s3, s3, s58
    v_lshl_add_u32 v151, v0, 10, s3
    v_subrev_u32 v12, 1572864, v151
    v_min_u32 v151, v12, v151
    s_mov_b32 s18, 16777216
    s_mov_b32 s19, 0x20000
    s_mov_b32 s22, 1409024
    s_mov_b32 s23, 0x20000
    s_lshl_b32 s63, s62, 9
    s_mul_i32 s62, s6, 232
    s_add_u32 s62, s62, s2
    s_cmpk_lt_u32 s2, 232
    s_cselect_b32 s62, s62, 1000
    s_sub_u32 s3, s62, 352
    s_lshr_b32 s99, s3, 3
    s_and_b32 s100, s3, 7
    s_and_b32 s57, s62, 15
    s_lshr_b32 s58, s62, 4
    s_cmpk_lt_u32 s62, 352
    s_cselect_b32 s20, s88, s90
    s_cselect_b32 s21, s89, s91
    s_cselect_b32 s99, s57, s99
    s_cselect_b32 s100, s58, s100
    s_mov_b32 s3, 12582912
    s_cselect_b32 s97, 11010048, s3
    s_mov_b32 s3, 44032
    s_cselect_b32 s98, 17408, s3
    s_movk_i32 s3, 1024
    s_cselect_b32 s94, 2752, s3
    s_movk_i32 s3, 2048
    s_cselect_b32 s101, 32, s3
    s_cselect_b64 vcc, -1, 0
    v_mul_lo_u32 v11, v40, s94
    v_lshl_add_u32 v11, v9, 4, v11
    s_mul_i32 s3, s99, s94
    s_lshl_b32 s3, s3, 5
    s_lshl_b32 s57, s100, 7
    s_add_u32 s3, s3, s57
    v_add_u32 v144, s3, v11
    s_lshl_b32 s94, s94, 3
    v_add_u32 v145, s94, v144
    v_add_u32 v146, s94, v145
    v_add_u32 v147, s94, v146
    s_lshl_b32 s58, s6, 12
    s_add_u32 s95, s58, 143360
    s_add_u32 s58, s58, 0x10000
    s_cmp_eq_u32 s6, 3
    s_cselect_b32 s7, 155648, s95
    v_lshlrev_b32 v1, 4, v0
    s_mul_i32 s3, s4, 32768
    s_add_u32 s37, s3, 65536
    s_lshl2_add_u32 s40, s5, s6
    s_mul_i32 s3, s40, 640
    s_add_u32 s3, s3, s37
    s_add_u32 s54, s3, 10240
    v_mov_b32 v44, -1
    v_mov_b32 v45, -1
    v_mov_b32 v46, -1
    v_mov_b32 v47, -1
    v_lshl_add_u32 v42, v0, 7, s63
    s_lshr_b32 s3, s2, 3
    s_lshl2_add_u32 s3, s3, s6
    s_lshl_b32 s3, s3, 2
    v_add_lshl_u32 v154, v0, s3, 10
    s_sub_u32 s3, 0x180, s84
    s_and_b32 s3, s3, 0x380
    v_add_u32 v154, s3, v154
    v_and_b32 v14, 15, v0
    v_lshrrev_b32 v12, 5, v0
    v_and_b32 v11, 3, v0
    v_lshlrev_b32 v11, 3, v11
    v_lshl_add_u32 v11, v10, 10, v11
    v_lshlrev_b32 v149, 10, v12
    v_lshl_add_u32 v149, v13, 5, v149
    v_and_b32 v148, 1, v0
    v_lshl_add_u32 v149, v148, 4, v149
    v_bfe_u32 v148, v0, 1, 1
    v_lshl_add_u32 v149, v148, 3, v149
    v_cndmask_b32 v148, v149, v11, vcc
    v_bfe_u32 v11, v0, 2, 2
    v_lshl_add_u32 v148, v11, 7, v148
    v_lshl_add_u32 v149, v11, 7, v149
    s_lshl_b32 s3, s25, 11
    s_lshl_b32 s57, s24, 6
    s_add_u32 s3, s3, s57
    v_add_u32 v149, s3, v149
    v_bfe_u32 v11, v0, 3, 1
    v_lshlrev_b32 v11, 6, v11
    v_xor_b32 v149, v149, v11
    v_add_u32 v15, 81920, v149
    v_add_u32 v148, s95, v148
    v_add_u32 v149, s101, v148
    s_mov_b32 s101, s7
    s_mul_i32 s3, s100, s98
    s_lshl2_add_u32 s97, s3, s97
    s_lshl_b32 s3, s99, 10
    s_add_u32 s97, s97, s3
    s_cmpk_lt_u32 s62, 696
    s_cselect_b32 s97, s97, 134217728
    s_lshl1_add_u32 s99, s98, s97
    s_cmp_eq_u32 s100, 21
    s_cselect_b32 s99, 134217728, s99
    s_add_u32 s100, s99, s98
    s_add_u32 s98, s97, s98
    s_mov_b64 s[26:27], s[92:93]
    s_mov_b64 s[0:1], s[84:85]
    v_lshlrev_b32 v11, 2, v13
    v_xor_b32 v11, v11, v9
    v_lshlrev_b32 v11, 4, v11
    v_lshl_add_u32 v150, v40, 10, v11
    s_mul_i32 s33, s40, 44032
    s_add_u32 s33, s33, 12582912
    s_add_u32 s39, s37, 28672
    s_lshl2_add_u32 s40, s40, s39
    s_getreg_b32 s59, hwreg(HW_REG_XCC_ID, 0, 4)
    s_mov_b32 s46, 0x200000
    s_mov_b32 s7, 0
    v_bfe_u32 v11, v0, 3, 2
    v_lshlrev_b32 v11, 1, v11
    v_bfe_u32 v16, v0, 1, 1
    s_lshl_b32 s3, s6, 1
    v_or_b32 v16, s3, v16
    v_xor_b32 v11, v11, v16
    v_mul_u32_u24 v29, 3072, v10
    v_lshl_add_u32 v29, v11, 4, v29
    v_bfe_u32 v11, v0, 2, 2
    v_lshl_add_u32 v29, v11, 7, v29
    v_and_b32 v11, 1, v0
    v_lshl_add_u32 v29, v11, 3, v29
    v_add_u32 v29, 81920, v29
    v_lshrrev_b32 v16, 1, v14
    v_xor_b32 v11, v16, v10
    v_lshlrev_b32 v11, 4, v11
    v_lshl_add_u32 v30, v14, 7, v11
    v_xor_b32 v31, 64, v30
    s_lshl_b32 s3, s24, 2
    v_or_b32 v11, s3, v12
    v_xor_b32 v11, v11, v16
    v_lshlrev_b32 v11, 4, v11
    v_lshl_add_u32 v11, v14, 7, v11
    v_lshl_add_u32 v11, v13, 14, v11
    s_lshl_b32 s3, s25, 15
    v_add_u32 v41, s3, v11
    v_add_u32 v2, 0x10000, v1
    v_lshl_add_u32 v3, s25, 10, v1
    v_add_u32 v156, 0x10000, v30
    v_add_u32 v157, 0x10000, v31
    v_lshlrev_b32 v5, 14, v13
    v_lshl_add_u32 v5, v12, 8, v5
    v_lshl_add_u32 v5, v14, 4, v5
    v_and_b32 v11, 31, v0
    v_lshlrev_b32 v6, 2, v11
    v_lshlrev_b32 v7, 4, v11
    v_lshl_add_u32 v7, v12, 2, v7
    v_lshlrev_b32 v8, 11, v10
    v_lshl_add_u32 v8, v14, 4, v8
    s_cmp_eq_u32 s4, 0
    s_cselect_b32 s3, 0, 128
    v_bfe_u32 v11, v0, 3, 1
    v_mul_u32_u24 v11, s3, v11
    v_lshlrev_b32 v124, 3, v9
    v_sub_u32 v124, v124, v11
    s_lshl_b32 s3, s4, 7
    s_add_u32 s3, s3, 4096
    v_add_u32 v124, s3, v124
    v_lshlrev_b32 v9, 3, v14
    v_add_u32 v9, 159744, v9
    v_and_b32 v11, 1, v0
    v_cmp_eq_u32 s[48:49], 1, v11
    v_lshl_add_u32 v11, v10, 2, v11
    v_cmp_le_u32 s[50:51], v11, v14
    v_add_u32 v11, 2, v11
    v_cmp_le_u32 s[52:53], v11, v14
    v_lshlrev_b32 v10, 4, v10
    v_add_u32 v10, 160768, v10
    s_lshl_b32 s3, s4, 16
    s_add_u32 s34, s3, 2097152
    s_mul_i32 s3, s4, 180224
    s_add_u32 s35, s3, 4194304
    s_mul_i32 s3, s5, 11
    s_mul_i32 s30, s6, 3
    s_add_u32 s3, s3, s30
    s_mul_i32 s30, s3, 17408
    s_add_u32 s31, s30, 17408
    s_add_u32 s32, s30, 34816
    s_cmp_eq_u32 s6, 3
    s_cselect_b32 s32, 134217728, s32
    s_lshl1_add_u32 s57, s5, s24
    s_lshl1_add_u32 s41, s4, s25
    s_lshl_b32 s41, s41, 15
    s_lshl_b32 s3, s57, 6
    s_add_u32 s41, s41, s3
    s_lshl1_add_u32 s3, s5, s25
    s_lshl_b32 s3, s3, 9
    s_add_u32 s36, s37, s3
    s_lshl3_add_u32 s36, s24, s36
    s_lshl_b32 s3, s57, 10
    s_add_u32 s42, s37, s3
    s_add_u32 s42, s42, -4096
    s_lshl_b32 s3, s5, 8
    s_lshl3_add_u32 s3, s24, s3
    s_add_u32 s3, s3, s37
    s_add_u32 s96, s3, 7936
    s_cmp_eq_u32 s25, 0
    s_cselect_b32 s42, 134217728, s42
    s_cselect_b32 s96, 134217728, s96
    s_mov_b32 s3, 0x7f800000
    s_cmp_eq_u32 s4, 0
    s_cselect_b32 s45, 0xf149f2ca, s3
    s_cselect_b32 s3, 0, 32768
    s_sub_u32 s38, s37, s3
    s_add_u32 s43, s38, 12288
    s_add_u32 s38, s38, 8192
    s_lshl_b32 s3, s6, 8
    s_add_u32 s37, s37, s3
    v_mov_b32 v248, 0x3f803f80
    v_mov_b32 v249, 0x3f803f80
    v_mov_b32 v250, 0x3f803f80
    v_mov_b32 v251, 0x3f803f80
    v_mov_b32 v11, 0xffff
    v_mov_b32 v12, 0xffff0000
    v_cndmask_b32 v11, v11, v12, s[48:49]
    v_cndmask_b32 v252, v11, 0, s[50:51]
    v_cndmask_b32 v253, v11, 0, s[52:53]
    v_cndmask_b32 v254, 0, v11, s[50:51]
    v_cndmask_b32 v255, 0, v11, s[52:53]
    v_mov_b32 v0, v41
    s_bfe_u32 s57, s56, 196608
    s_lshl1_add_u32 s57, s57, 0
    s_add_u32 m0, s29, 81920
    s_mul_i32 s57, s57, 98304
    buffer_load_dwordx4 v28, s[12:15], s57 offen offset:0 lds
    buffer_load_dwordx4 v28, s[12:15], s57 offen offset:1024 lds
    buffer_load_dwordx4 v28, s[12:15], s57 offen offset:2048 lds
    s_lshl2_add_u32 s3, s24, 196608
    s_bfe_u32 s3, s56, s3
    s_lshl_b32 s3, s3, 7
    s_add_u32 s57, s3, s28
    s_lshl_b32 s3, s6, 10
    s_add_u32 m0, s3, 65536
    s_nop 0
    buffer_load_dwordx4 v158, s[8:11], s57 offen lds
    s_mov_b64 exec, 7
    buffer_load_dword v126, v151, s[12:15], 0 offen
    s_mov_b64 exec, -1
    s_mov_b32 exec_hi, 0xff
    buffer_store_dwordx4 v[44:47], v1, s[16:19], s54 offen sc1
    s_mov_b64 exec, 15
    global_load_dword v126, v42, s[84:85]
    s_mov_b64 exec, -1
    s_mov_b64 exec, 0
    s_cmp_eq_u32 s6, 0
    s_cbranch_scc1 L_pad1
    s_cmp_eq_u32 s6, 1
    s_cbranch_scc1 L_pad2
    s_cmp_eq_u32 s6, 2
    s_cbranch_scc1 L_pad3
    s_branch L_pad4
    .p2align 12
L_body:
    s_mov_b64 exec, -1
    s_bfe_u32 s57, s56, 196608
    s_lshl1_add_u32 s57, s57, 1
    s_add_u32 m0, s29, 94208
    s_mul_i32 s57, s57, 98304
    buffer_load_dwordx4 v28, s[12:15], s57 offen offset:0 lds
    buffer_load_dwordx4 v28, s[12:15], s57 offen offset:1024 lds
    buffer_load_dwordx4 v28, s[12:15], s57 offen offset:2048 lds
    s_bfe_u32 s3, s56, 196612
    s_lshl_b32 s3, s3, 7
    s_add_u32 m0, s44, 2048
    s_add_u32 s57, s3, s47
    buffer_load_dwordx4 v26, s[8:11], s57 offen lds
    buffer_load_dwordx4 v27, s[8:11], s57 offen offset:1024 lds
    v_add_u32 v151, 393216, v151
    v_subrev_u32 v12, 1572864, v151
    v_min_u32 v151, v12, v151
    s_mov_b64 exec, 7
    buffer_load_dword v155, v151, s[12:15], 0 offen
    s_mov_b64 exec, -1
    v_xor_b32 v11, 32, v0
    s_waitcnt vmcnt(14)
    s_barrier
    ds_read_b128 v[80:83], v0
    ds_read_b128 v[84:87], v11
    s_bfe_u32 s57, s56, 196612
    s_lshl1_add_u32 s57, s57, 0
    s_add_u32 m0, s29, 106496
    s_mul_i32 s57, s57, 98304
    buffer_load_dwordx4 v28, s[12:15], s57 offen offset:0 lds
    buffer_load_dwordx4 v28, s[12:15], s57 offen offset:1024 lds
    buffer_load_dwordx4 v28, s[12:15], s57 offen offset:2048 lds
    s_waitcnt lgkmcnt(0)
    v_lshlrev_b32 v48, 16, v80
    v_and_b32 v49, 0xffff0000, v80
    v_lshlrev_b32 v50, 16, v81
    v_and_b32 v51, 0xffff0000, v81
    v_lshlrev_b32 v52, 16, v82
    v_and_b32 v53, 0xffff0000, v82
    v_lshlrev_b32 v54, 16, v83
    v_and_b32 v55, 0xffff0000, v83
    v_lshlrev_b32 v56, 16, v84
    v_and_b32 v57, 0xffff0000, v84
    v_lshlrev_b32 v58, 16, v85
    v_and_b32 v59, 0xffff0000, v85
    v_lshlrev_b32 v60, 16, v86
    v_and_b32 v61, 0xffff0000, v86
    v_lshlrev_b32 v62, 16, v87
    v_and_b32 v63, 0xffff0000, v87
    v_pk_add_f32 v[12:13], v[48:49], v[50:51]
    v_pk_mul_f32 v[78:79], v[48:49], v[48:49]
    v_pk_fma_f32 v[78:79], v[50:51], v[50:51], v[78:79]
    v_pk_add_f32 v[12:13], v[12:13], v[52:53]
    v_pk_fma_f32 v[78:79], v[52:53], v[52:53], v[78:79]
    v_pk_add_f32 v[12:13], v[12:13], v[54:55]
    v_pk_fma_f32 v[78:79], v[54:55], v[54:55], v[78:79]
    v_pk_add_f32 v[12:13], v[12:13], v[56:57]
    v_pk_fma_f32 v[78:79], v[56:57], v[56:57], v[78:79]
    v_pk_add_f32 v[12:13], v[12:13], v[58:59]
    v_pk_fma_f32 v[78:79], v[58:59], v[58:59], v[78:79]
    v_pk_add_f32 v[12:13], v[12:13], v[60:61]
    v_pk_fma_f32 v[78:79], v[60:61], v[60:61], v[78:79]
    v_pk_add_f32 v[12:13], v[12:13], v[62:63]
    v_pk_fma_f32 v[78:79], v[62:63], v[62:63], v[78:79]
    v_add_f32 v12, v12, v13
    v_add_f32 v14, v78, v79
    s_nop 1
    v_permlane32_swap_b32 v12, v14
    v_add_f32_e64 v14, v12, v14
    buffer_store_dword v14, v7, s[16:19], s36 offen sc1
    s_mov_b32 exec_lo, 0xffff0000
    s_mov_b32 exec_hi, 0xffff0000
    buffer_store_dword v14, v7, s[16:19], s96 offen offset:0 sc1
    s_mov_b64 exec, -1
    s_mul_i32 s62, s60, 0x9E3779B1
    s_add_u32 s62, s62, 0x7F4A7C15
    s_and_b32 s62, s62, 0xfffffff0
    s_add_u32 s63, s61, 0x85EBCA6B
    s_waitcnt vmcnt(14)
    s_barrier
    ds_read_b64_tr_b16 a[0:1], v29 offset:0
    ds_read_b64_tr_b16 a[2:3], v29 offset:512
    ds_read_b64_tr_b16 a[4:5], v29 offset:1024
    ds_read_b64_tr_b16 a[6:7], v29 offset:1536
    ds_read_b64_tr_b16 a[8:9], v29 offset:2048
    ds_read_b64_tr_b16 a[10:11], v29 offset:2560
    ds_read_b128 v[88:91], v30 offset:0
    ds_read_b128 v[92:95], v30 offset:16384
    ds_read_b128 v[96:99], v30 offset:32768
    ds_read_b128 v[100:103], v30 offset:49152
    s_waitcnt lgkmcnt(3)
    v_mfma_f32_16x16x32_bf16 v[32:35], a[0:3], v[88:91], 0
    ds_read_b128 v[104:107], v156 offset:0
    v_mfma_f32_16x16x32_bf16 v[48:51], a[4:7], v[88:91], 0
    s_add_u32 m0, s101, 0
    s_nop 0
    buffer_load_dwordx4 v144, s[20:23], 0 offen nt lds
    v_mfma_f32_16x16x32_bf16 v[72:75], v[88:91], a[8:11], 0
    s_waitcnt lgkmcnt(3)
    s_add_u32 m0, s101, 1024
    s_nop 0
    buffer_load_dwordx4 v145, s[20:23], 0 offen nt lds
    v_mfma_f32_16x16x32_bf16 v[236:239], a[0:3], v[248:251], 0
    s_add_u32 m0, s101, 2048
    s_nop 0
    buffer_load_dwordx4 v146, s[20:23], 0 offen nt lds
    s_add_u32 m0, s101, 3072
    s_nop 0
    buffer_load_dwordx4 v147, s[20:23], 0 offen nt lds
    s_add_u32 s20, s16, 11010048
    s_addc_u32 s21, s17, 0
    s_mov_b32 s22, 1497088
    v_mfma_f32_16x16x32_bf16 v[36:39], a[0:3], v[92:95], 0
    s_waitcnt vmcnt(12)
    s_barrier
    ds_read_b128 v[88:91], v31 offset:0
    v_mfma_f32_16x16x32_bf16 v[52:55], a[4:7], v[92:95], 0
    ds_read_b64_tr_b16 a[12:13], v29 offset:12288
    v_mfma_f32_16x16x32_bf16 v[76:79], v[92:95], a[8:11], 0
    s_waitcnt lgkmcnt(4)
    ds_read_b64_tr_b16 a[14:15], v29 offset:12800
    v_mfma_f32_16x16x32_bf16 v[240:243], a[4:7], v[248:251], 0
    ds_read_b64_tr_b16 a[16:17], v29 offset:13312
    s_bfe_u32 s57, s56, 196612
    s_lshl1_add_u32 s57, s57, 1
    s_add_u32 m0, s29, 118784
    s_mul_i32 s57, s57, 98304
    buffer_load_dwordx4 v28, s[12:15], s57 offen offset:0 lds
    v_mfma_f32_16x16x32_bf16 v[40:43], a[0:3], v[96:99], 0
    ds_read_b128 v[92:95], v31 offset:16384
    v_mfma_f32_16x16x32_bf16 v[56:59], a[4:7], v[96:99], 0
    ds_read_b64_tr_b16 a[18:19], v29 offset:13824
    v_mfma_f32_16x16x32_bf16 v[80:83], v[96:99], a[8:11], 0
    s_waitcnt lgkmcnt(7)
    ds_read_b64_tr_b16 a[20:21], v29 offset:14336
    v_mfma_f32_16x16x32_bf16 v[244:247], v[248:251], a[8:11], 0
    ds_read_b64_tr_b16 a[22:23], v29 offset:14848
    buffer_load_dwordx4 v28, s[12:15], s57 offen offset:1024 lds
    v_mfma_f32_16x16x32_bf16 v[44:47], a[0:3], v[100:103], 0
    ds_read_b128 v[96:99], v31 offset:32768
    v_mfma_f32_16x16x32_bf16 v[60:63], a[4:7], v[100:103], 0
    buffer_load_dwordx4 v28, s[12:15], s57 offen offset:2048 lds
    v_mfma_f32_16x16x32_bf16 v[84:87], v[100:103], a[8:11], 0
    s_waitcnt lgkmcnt(9)
    s_bfe_u32 s3, s56, 196616
    s_lshl_b32 s3, s3, 7
    s_add_u32 m0, s44, 4096
    s_add_u32 s57, s3, s47
    buffer_load_dwordx4 v26, s[8:11], s57 offen lds
    v_mfma_f32_16x16x32_bf16 v[64:67], a[4:7], v[104:107], 0
    ds_read_b128 v[100:103], v31 offset:49152
    v_mfma_f32_16x16x32_bf16 v[68:71], v[104:107], a[8:11], 0
    s_waitcnt lgkmcnt(9)
    s_waitcnt lgkmcnt(2)
    v_mfma_f32_16x16x32_bf16 v[32:35], a[12:15], v[88:91], v[32:35]
    ds_read_b128 v[104:107], v157 offset:0
    v_mfma_f32_16x16x32_bf16 v[48:51], a[16:19], v[88:91], v[48:51]
    buffer_load_dwordx4 v27, s[8:11], s57 offen offset:1024 lds
    v_mfma_f32_16x16x32_bf16 v[72:75], v[88:91], a[20:23], v[72:75]
    s_lshl2_add_u32 s3, s24, 196616
    s_bfe_u32 s3, s56, s3
    s_lshl_b32 s3, s3, 7
    s_add_u32 s57, s3, s28
    s_lshl_b32 s3, s6, 10
    s_add_u32 m0, s3, 69632
    s_nop 0
    buffer_load_dwordx4 v158, s[8:11], s57 offen lds
    v_mfma_f32_16x16x32_bf16 v[236:239], a[12:15], v[248:251], v[236:239]
    v_mfma_f32_16x16x32_bf16 v[36:39], a[12:15], v[92:95], v[36:39]
    s_waitcnt vmcnt(12)
    s_barrier
    ds_read_b128 v[88:91], v30 offset:2048
    v_mfma_f32_16x16x32_bf16 v[52:55], a[16:19], v[92:95], v[52:55]
    ds_read_b64_tr_b16 a[24:25], v29 offset:24576
    v_mfma_f32_16x16x32_bf16 v[76:79], v[92:95], a[20:23], v[76:79]
    s_waitcnt lgkmcnt(4)
    ds_read_b64_tr_b16 a[26:27], v29 offset:25088
    v_mfma_f32_16x16x32_bf16 v[240:243], a[16:19], v[248:251], v[240:243]
    ds_read_b64_tr_b16 a[28:29], v29 offset:25600
    s_bfe_u32 s57, s56, 196616
    s_lshl1_add_u32 s57, s57, 0
    s_add_u32 m0, s29, 131072
    s_mul_i32 s57, s57, 98304
    buffer_load_dwordx4 v28, s[12:15], s57 offen offset:0 lds
    v_mfma_f32_16x16x32_bf16 v[40:43], a[12:15], v[96:99], v[40:43]
    ds_read_b128 v[92:95], v30 offset:18432
    v_mfma_f32_16x16x32_bf16 v[56:59], a[16:19], v[96:99], v[56:59]
    ds_read_b64_tr_b16 a[30:31], v29 offset:26112
    v_mfma_f32_16x16x32_bf16 v[80:83], v[96:99], a[20:23], v[80:83]
    s_waitcnt lgkmcnt(7)
    ds_read_b64_tr_b16 a[32:33], v29 offset:26624
    v_mfma_f32_16x16x32_bf16 v[244:247], v[248:251], a[20:23], v[244:247]
    ds_read_b64_tr_b16 a[34:35], v29 offset:27136
    buffer_load_dwordx4 v28, s[12:15], s57 offen offset:1024 lds
    v_mfma_f32_16x16x32_bf16 v[44:47], a[12:15], v[100:103], v[44:47]
    ds_read_b128 v[96:99], v30 offset:34816
    v_mfma_f32_16x16x32_bf16 v[60:63], a[16:19], v[100:103], v[60:63]
    buffer_load_dwordx4 v28, s[12:15], s57 offen offset:2048 lds
    v_mfma_f32_16x16x32_bf16 v[84:87], v[100:103], a[20:23], v[84:87]
    s_waitcnt lgkmcnt(9)
    v_mfma_f32_16x16x32_bf16 v[64:67], a[16:19], v[104:107], v[64:67]
    ds_read_b128 v[100:103], v30 offset:51200
    v_mfma_f32_16x16x32_bf16 v[68:71], v[104:107], a[20:23], v[68:71]
    s_waitcnt lgkmcnt(9)
    s_waitcnt lgkmcnt(2)
    v_mfma_f32_16x16x32_bf16 v[32:35], a[24:27], v[88:91], v[32:35]
    ds_read_b128 v[104:107], v156 offset:2048
    v_mfma_f32_16x16x32_bf16 v[48:51], a[28:31], v[88:91], v[48:51]
    v_mfma_f32_16x16x32_bf16 v[72:75], v[88:91], a[32:35], v[72:75]
    v_mfma_f32_16x16x32_bf16 v[236:239], a[24:27], v[248:251], v[236:239]
    v_mfma_f32_16x16x32_bf16 v[36:39], a[24:27], v[92:95], v[36:39]
    s_waitcnt vmcnt(6)
    s_barrier
    ds_read_b128 v[88:91], v31 offset:2048
    v_mfma_f32_16x16x32_bf16 v[52:55], a[28:31], v[92:95], v[52:55]
    ds_read_b64_tr_b16 a[36:37], v29 offset:36864
    v_mfma_f32_16x16x32_bf16 v[76:79], v[92:95], a[32:35], v[76:79]
    s_waitcnt lgkmcnt(4)
    ds_read_b64_tr_b16 a[38:39], v29 offset:37376
    v_mfma_f32_16x16x32_bf16 v[240:243], a[28:31], v[248:251], v[240:243]
    ds_read_b64_tr_b16 a[40:41], v29 offset:37888
    s_bfe_u32 s57, s56, 196616
    s_lshl1_add_u32 s57, s57, 1
    s_add_u32 m0, s29, 81920
    s_mul_i32 s57, s57, 98304
    buffer_load_dwordx4 v28, s[12:15], s57 offen offset:0 lds
    v_mfma_f32_16x16x32_bf16 v[40:43], a[24:27], v[96:99], v[40:43]
    ds_read_b128 v[92:95], v31 offset:18432
    v_mfma_f32_16x16x32_bf16 v[56:59], a[28:31], v[96:99], v[56:59]
    ds_read_b64_tr_b16 a[42:43], v29 offset:38400
    v_mfma_f32_16x16x32_bf16 v[80:83], v[96:99], a[32:35], v[80:83]
    s_waitcnt lgkmcnt(7)
    ds_read_b64_tr_b16 a[44:45], v29 offset:38912
    v_mfma_f32_16x16x32_bf16 v[244:247], v[248:251], a[32:35], v[244:247]
    ds_read_b64_tr_b16 a[46:47], v29 offset:39424
    buffer_load_dwordx4 v28, s[12:15], s57 offen offset:1024 lds
    v_mfma_f32_16x16x32_bf16 v[44:47], a[24:27], v[100:103], v[44:47]
    ds_read_b128 v[96:99], v31 offset:34816
    v_mfma_f32_16x16x32_bf16 v[60:63], a[28:31], v[100:103], v[60:63]
    buffer_load_dwordx4 v28, s[12:15], s57 offen offset:2048 lds
    v_mfma_f32_16x16x32_bf16 v[84:87], v[100:103], a[32:35], v[84:87]
    s_waitcnt lgkmcnt(9)
    s_bfe_u32 s3, s56, 196620
    s_lshl_b32 s3, s3, 7
    s_add_u32 m0, s44, 6144
    s_add_u32 s57, s3, s47
    buffer_load_dwordx4 v26, s[8:11], s57 offen lds
    v_mfma_f32_16x16x32_bf16 v[64:67], a[28:31], v[104:107], v[64:67]
    ds_read_b128 v[100:103], v31 offset:51200
    v_mfma_f32_16x16x32_bf16 v[68:71], v[104:107], a[32:35], v[68:71]
    s_waitcnt lgkmcnt(9)
    s_waitcnt lgkmcnt(2)
    v_mfma_f32_16x16x32_bf16 v[32:35], a[36:39], v[88:91], v[32:35]
    ds_read_b128 v[104:107], v157 offset:2048
    v_mfma_f32_16x16x32_bf16 v[48:51], a[40:43], v[88:91], v[48:51]
    buffer_load_dwordx4 v27, s[8:11], s57 offen offset:1024 lds
    v_mfma_f32_16x16x32_bf16 v[72:75], v[88:91], a[44:47], v[72:75]
    v_add_u32 v151, 393216, v151
    v_subrev_u32 v12, 1572864, v151
    v_min_u32 v151, v12, v151
    s_mov_b64 exec, 7
    buffer_load_dword v155, v151, s[12:15], 0 offen
    s_mov_b64 exec, -1
    v_mfma_f32_16x16x32_bf16 v[236:239], a[36:39], v[248:251], v[236:239]
    ds_read_b64_tr_b16 v[128:129], v148 offset:0
    ds_read_b64_tr_b16 v[130:131], v148 offset:512
    ds_read_b64_tr_b16 v[132:133], v149 offset:0
    ds_read_b64_tr_b16 v[134:135], v149 offset:512
    ds_read_b64_tr_b16 v[136:137], v148 offset:64
    ds_read_b64_tr_b16 v[138:139], v148 offset:576
    ds_read_b64_tr_b16 v[140:141], v149 offset:64
    ds_read_b64_tr_b16 v[142:143], v149 offset:576
    v_mfma_f32_16x16x32_bf16 v[36:39], a[36:39], v[92:95], v[36:39]
    s_waitcnt vmcnt(6)
    s_barrier
    ds_read_b128 v[88:91], v30 offset:4096
    v_mfma_f32_16x16x32_bf16 v[52:55], a[40:43], v[92:95], v[52:55]
    ds_read_b64_tr_b16 a[48:49], v29 offset:49152
    v_mfma_f32_16x16x32_bf16 v[76:79], v[92:95], a[44:47], v[76:79]
    s_waitcnt lgkmcnt(12)
    ds_read_b64_tr_b16 a[50:51], v29 offset:49664
    v_mfma_f32_16x16x32_bf16 v[240:243], a[40:43], v[248:251], v[240:243]
    ds_read_b64_tr_b16 a[52:53], v29 offset:50176
    s_bfe_u32 s57, s56, 196620
    s_lshl1_add_u32 s57, s57, 0
    s_add_u32 m0, s29, 94208
    s_mul_i32 s57, s57, 98304
    buffer_load_dwordx4 v28, s[12:15], s57 offen offset:0 lds
    v_mfma_f32_16x16x32_bf16 v[40:43], a[36:39], v[96:99], v[40:43]
    ds_read_b128 v[92:95], v30 offset:20480
    v_mfma_f32_16x16x32_bf16 v[56:59], a[40:43], v[96:99], v[56:59]
    ds_read_b64_tr_b16 a[54:55], v29 offset:50688
    v_mfma_f32_16x16x32_bf16 v[80:83], v[96:99], a[44:47], v[80:83]
    s_waitcnt lgkmcnt(15)
    ds_read_b64_tr_b16 a[56:57], v29 offset:51200
    v_mfma_f32_16x16x32_bf16 v[244:247], v[248:251], a[44:47], v[244:247]
    ds_read_b64_tr_b16 a[58:59], v29 offset:51712
    buffer_load_dwordx4 v28, s[12:15], s57 offen offset:1024 lds
    v_mfma_f32_16x16x32_bf16 v[44:47], a[36:39], v[100:103], v[44:47]
    ds_read_b128 v[96:99], v30 offset:36864
    v_mfma_f32_16x16x32_bf16 v[60:63], a[40:43], v[100:103], v[60:63]
    s_or_b32 s3, s62, s59
    v_mov_b32 v12, s3
    v_mov_b32 v13, s63
    v_mov_b32 v11, 0
    s_lshl4_add_u32 s3, s4, s5
    s_lshl_b32 s3, s3, 3
    s_add_u32 s3, s3, 4096
    s_cmp_eq_u32 s6, 0
    s_cselect_b32 s3, s3, 134217728
    s_mov_b64 exec, 1
    buffer_store_dwordx2 v[12:13], v11, s[16:19], s3 offen sc1
    s_mov_b64 exec, -1
    v_mfma_f32_16x16x32_bf16 v[84:87], v[100:103], a[44:47], v[84:87]
    s_waitcnt lgkmcnt(15)
    buffer_load_dwordx4 v28, s[12:15], s57 offen offset:2048 lds
    v_mfma_f32_16x16x32_bf16 v[64:67], a[40:43], v[104:107], v[64:67]
    ds_read_b128 v[100:103], v30 offset:53248
    v_mfma_f32_16x16x32_bf16 v[68:71], v[104:107], a[44:47], v[68:71]
    s_waitcnt lgkmcnt(9)
    s_waitcnt lgkmcnt(2)
    v_mfma_f32_16x16x32_bf16 v[32:35], a[48:51], v[88:91], v[32:35]
    ds_read_b128 v[104:107], v156 offset:4096
    v_mfma_f32_16x16x32_bf16 v[48:51], a[52:55], v[88:91], v[48:51]
    buffer_store_dwordx4 v[128:131], v1, s[16:19], s97 offen sc1
    v_mfma_f32_16x16x32_bf16 v[72:75], v[88:91], a[56:59], v[72:75]
    v_mfma_f32_16x16x32_bf16 v[236:239], a[48:51], v[248:251], v[236:239]
    v_mfma_f32_16x16x32_bf16 v[36:39], a[48:51], v[92:95], v[36:39]
    s_waitcnt vmcnt(8)
    s_barrier
    ds_read_b128 v[88:91], v31 offset:4096
    v_mfma_f32_16x16x32_bf16 v[52:55], a[52:55], v[92:95], v[52:55]
    ds_read_b64_tr_b16 a[60:61], v29 offset:0
    v_mfma_f32_16x16x32_bf16 v[76:79], v[92:95], a[56:59], v[76:79]
    s_waitcnt lgkmcnt(4)
    ds_read_b64_tr_b16 a[62:63], v29 offset:512
    v_mfma_f32_16x16x32_bf16 v[240:243], a[52:55], v[248:251], v[240:243]
    ds_read_b64_tr_b16 a[64:65], v29 offset:1024
    s_bfe_u32 s57, s56, 196620
    s_lshl1_add_u32 s57, s57, 1
    s_add_u32 m0, s29, 106496
    s_mul_i32 s57, s57, 98304
    buffer_load_dwordx4 v28, s[12:15], s57 offen offset:0 lds
    v_mfma_f32_16x16x32_bf16 v[40:43], a[48:51], v[96:99], v[40:43]
    ds_read_b128 v[92:95], v31 offset:20480
    v_mfma_f32_16x16x32_bf16 v[56:59], a[52:55], v[96:99], v[56:59]
    ds_read_b64_tr_b16 a[66:67], v29 offset:1536
    v_mfma_f32_16x16x32_bf16 v[80:83], v[96:99], a[56:59], v[80:83]
    s_waitcnt lgkmcnt(7)
    ds_read_b64_tr_b16 a[68:69], v29 offset:2048
    v_mfma_f32_16x16x32_bf16 v[244:247], v[248:251], a[56:59], v[244:247]
    ds_read_b64_tr_b16 a[70:71], v29 offset:2560
    buffer_load_dwordx4 v28, s[12:15], s57 offen offset:1024 lds
    v_mfma_f32_16x16x32_bf16 v[44:47], a[48:51], v[100:103], v[44:47]
    ds_read_b128 v[96:99], v31 offset:36864
    v_mfma_f32_16x16x32_bf16 v[60:63], a[52:55], v[100:103], v[60:63]
    buffer_load_dwordx4 v28, s[12:15], s57 offen offset:2048 lds
    v_mfma_f32_16x16x32_bf16 v[84:87], v[100:103], a[56:59], v[84:87]
    s_waitcnt lgkmcnt(9)
    s_bfe_u32 s3, s56, 196624
    s_lshl_b32 s3, s3, 7
    s_add_u32 m0, s44, 8192
    s_add_u32 s57, s3, s47
    buffer_load_dwordx4 v26, s[8:11], s57 offen lds
    v_mfma_f32_16x16x32_bf16 v[64:67], a[52:55], v[104:107], v[64:67]
    ds_read_b128 v[100:103], v31 offset:53248
    v_mfma_f32_16x16x32_bf16 v[68:71], v[104:107], a[56:59], v[68:71]
    s_waitcnt lgkmcnt(9)
    s_waitcnt lgkmcnt(2)
    v_mfma_f32_16x16x32_bf16 v[32:35], a[60:63], v[88:91], v[32:35]
    ds_read_b128 v[104:107], v157 offset:4096
    v_mfma_f32_16x16x32_bf16 v[48:51], a[64:67], v[88:91], v[48:51]
    buffer_load_dwordx4 v27, s[8:11], s57 offen offset:1024 lds
    v_mfma_f32_16x16x32_bf16 v[72:75], v[88:91], a[68:71], v[72:75]
    s_lshl2_add_u32 s3, s24, 196624
    s_bfe_u32 s3, s56, s3
    s_lshl_b32 s3, s3, 7
    s_add_u32 s57, s3, s28
    s_lshl_b32 s3, s6, 10
    s_add_u32 m0, s3, 73728
    s_nop 0
    buffer_load_dwordx4 v158, s[8:11], s57 offen lds
    v_mfma_f32_16x16x32_bf16 v[236:239], a[60:63], v[248:251], v[236:239]
    buffer_store_dwordx4 v[132:135], v1, s[16:19], s98 offen sc1
    v_mfma_f32_16x16x32_bf16 v[36:39], a[60:63], v[92:95], v[36:39]
    s_waitcnt vmcnt(8)
    s_barrier
    ds_read_b128 v[88:91], v30 offset:6144
    v_mfma_f32_16x16x32_bf16 v[52:55], a[64:67], v[92:95], v[52:55]
    ds_read_b64_tr_b16 a[72:73], v29 offset:12288
    v_mfma_f32_16x16x32_bf16 v[76:79], v[92:95], a[68:71], v[76:79]
    s_waitcnt lgkmcnt(4)
    ds_read_b64_tr_b16 a[74:75], v29 offset:12800
    v_mfma_f32_16x16x32_bf16 v[240:243], a[64:67], v[248:251], v[240:243]
    ds_read_b64_tr_b16 a[76:77], v29 offset:13312
    s_bfe_u32 s57, s56, 196624
    s_lshl1_add_u32 s57, s57, 0
    s_add_u32 m0, s29, 118784
    s_mul_i32 s57, s57, 98304
    buffer_load_dwordx4 v28, s[12:15], s57 offen offset:0 lds
    v_mfma_f32_16x16x32_bf16 v[40:43], a[60:63], v[96:99], v[40:43]
    ds_read_b128 v[92:95], v30 offset:22528
    v_mfma_f32_16x16x32_bf16 v[56:59], a[64:67], v[96:99], v[56:59]
    ds_read_b64_tr_b16 a[78:79], v29 offset:13824
    v_mfma_f32_16x16x32_bf16 v[80:83], v[96:99], a[68:71], v[80:83]
    s_waitcnt lgkmcnt(7)
    ds_read_b64_tr_b16 a[80:81], v29 offset:14336
    v_mfma_f32_16x16x32_bf16 v[244:247], v[248:251], a[68:71], v[244:247]
    ds_read_b64_tr_b16 a[82:83], v29 offset:14848
    buffer_load_dwordx4 v28, s[12:15], s57 offen offset:1024 lds
    v_mfma_f32_16x16x32_bf16 v[44:47], a[60:63], v[100:103], v[44:47]
    ds_read_b128 v[96:99], v30 offset:38912
    v_mfma_f32_16x16x32_bf16 v[60:63], a[64:67], v[100:103], v[60:63]
    buffer_load_dwordx4 v28, s[12:15], s57 offen offset:2048 lds
    v_mfma_f32_16x16x32_bf16 v[84:87], v[100:103], a[68:71], v[84:87]
    s_waitcnt lgkmcnt(9)
    buffer_store_dwordx4 v[136:139], v1, s[16:19], s99 offen sc1
    v_mfma_f32_16x16x32_bf16 v[64:67], a[64:67], v[104:107], v[64:67]
    ds_read_b128 v[100:103], v30 offset:55296
    v_mfma_f32_16x16x32_bf16 v[68:71], v[104:107], a[68:71], v[68:71]
    s_waitcnt lgkmcnt(9)
    s_waitcnt lgkmcnt(2)
    v_mfma_f32_16x16x32_bf16 v[32:35], a[72:75], v[88:91], v[32:35]
    ds_read_b128 v[104:107], v156 offset:6144
    v_mfma_f32_16x16x32_bf16 v[48:51], a[76:79], v[88:91], v[48:51]
    v_mfma_f32_16x16x32_bf16 v[72:75], v[88:91], a[80:83], v[72:75]
    v_mfma_f32_16x16x32_bf16 v[236:239], a[72:75], v[248:251], v[236:239]
    v_mfma_f32_16x16x32_bf16 v[36:39], a[72:75], v[92:95], v[36:39]
    s_waitcnt vmcnt(8)
    s_barrier
    ds_read_b128 v[88:91], v31 offset:6144
    v_mfma_f32_16x16x32_bf16 v[52:55], a[76:79], v[92:95], v[52:55]
    ds_read_b64_tr_b16 a[84:85], v29 offset:24576
    v_mfma_f32_16x16x32_bf16 v[76:79], v[92:95], a[80:83], v[76:79]
    s_waitcnt lgkmcnt(4)
    ds_read_b64_tr_b16 a[86:87], v29 offset:25088
    v_mfma_f32_16x16x32_bf16 v[240:243], a[76:79], v[248:251], v[240:243]
    ds_read_b64_tr_b16 a[88:89], v29 offset:25600
    s_bfe_u32 s57, s56, 196624
    s_lshl1_add_u32 s57, s57, 1
    s_add_u32 m0, s29, 131072
    s_mul_i32 s57, s57, 98304
    buffer_load_dwordx4 v28, s[12:15], s57 offen offset:0 lds
    v_mfma_f32_16x16x32_bf16 v[40:43], a[72:75], v[96:99], v[40:43]
    ds_read_b128 v[92:95], v31 offset:22528
    v_mfma_f32_16x16x32_bf16 v[56:59], a[76:79], v[96:99], v[56:59]
    ds_read_b64_tr_b16 a[90:91], v29 offset:26112
    v_mfma_f32_16x16x32_bf16 v[80:83], v[96:99], a[80:83], v[80:83]
    s_waitcnt lgkmcnt(7)
    ds_read_b64_tr_b16 a[92:93], v29 offset:26624
    v_mfma_f32_16x16x32_bf16 v[244:247], v[248:251], a[80:83], v[244:247]
    ds_read_b64_tr_b16 a[94:95], v29 offset:27136
    buffer_load_dwordx4 v28, s[12:15], s57 offen offset:1024 lds
    v_mfma_f32_16x16x32_bf16 v[44:47], a[72:75], v[100:103], v[44:47]
    ds_read_b128 v[96:99], v31 offset:38912
    v_mfma_f32_16x16x32_bf16 v[60:63], a[76:79], v[100:103], v[60:63]
    buffer_load_dwordx4 v28, s[12:15], s57 offen offset:2048 lds
    v_mfma_f32_16x16x32_bf16 v[84:87], v[100:103], a[80:83], v[84:87]
    s_waitcnt lgkmcnt(9)
    s_bfe_u32 s3, s56, 196628
    s_lshl_b32 s3, s3, 7
    s_add_u32 m0, s44, 10240
    s_add_u32 s57, s3, s47
    buffer_load_dwordx4 v26, s[8:11], s57 offen lds
    v_mfma_f32_16x16x32_bf16 v[64:67], a[76:79], v[104:107], v[64:67]
    ds_read_b128 v[100:103], v31 offset:55296
    v_mfma_f32_16x16x32_bf16 v[68:71], v[104:107], a[80:83], v[68:71]
    s_waitcnt lgkmcnt(9)
    s_waitcnt lgkmcnt(2)
    v_mfma_f32_16x16x32_bf16 v[32:35], a[84:87], v[88:91], v[32:35]
    ds_read_b128 v[104:107], v157 offset:6144
    v_mfma_f32_16x16x32_bf16 v[48:51], a[88:91], v[88:91], v[48:51]
    buffer_load_dwordx4 v27, s[8:11], s57 offen offset:1024 lds
    v_mfma_f32_16x16x32_bf16 v[72:75], v[88:91], a[92:95], v[72:75]
    v_add_u32 v151, 393216, v151
    v_subrev_u32 v12, 1572864, v151
    v_min_u32 v151, v12, v151
    s_mov_b64 exec, 7
    buffer_load_dword v155, v151, s[12:15], 0 offen
    s_mov_b64 exec, -1
    v_mfma_f32_16x16x32_bf16 v[236:239], a[84:87], v[248:251], v[236:239]
    buffer_store_dwordx4 v[140:143], v1, s[16:19], s100 offen sc1
    v_mfma_f32_16x16x32_bf16 v[36:39], a[84:87], v[92:95], v[36:39]
    s_waitcnt vmcnt(8)
    s_barrier
    ds_read_b128 v[88:91], v30 offset:8192
    v_mfma_f32_16x16x32_bf16 v[52:55], a[88:91], v[92:95], v[52:55]
    ds_read_b64_tr_b16 a[96:97], v29 offset:36864
    v_mfma_f32_16x16x32_bf16 v[76:79], v[92:95], a[92:95], v[76:79]
    s_waitcnt lgkmcnt(4)
    ds_read_b64_tr_b16 a[98:99], v29 offset:37376
    v_mfma_f32_16x16x32_bf16 v[240:243], a[88:91], v[248:251], v[240:243]
    ds_read_b64_tr_b16 a[100:101], v29 offset:37888
    s_bfe_u32 s57, s56, 196628
    s_lshl1_add_u32 s57, s57, 0
    s_add_u32 m0, s29, 81920
    s_mul_i32 s57, s57, 98304
    buffer_load_dwordx4 v28, s[12:15], s57 offen offset:0 lds
    v_mfma_f32_16x16x32_bf16 v[40:43], a[84:87], v[96:99], v[40:43]
    ds_read_b128 v[92:95], v30 offset:24576
    v_mfma_f32_16x16x32_bf16 v[56:59], a[88:91], v[96:99], v[56:59]
    ds_read_b64_tr_b16 a[102:103], v29 offset:38400
    v_mfma_f32_16x16x32_bf16 v[80:83], v[96:99], a[92:95], v[80:83]
    s_waitcnt lgkmcnt(7)
    ds_read_b64_tr_b16 a[104:105], v29 offset:38912
    v_mfma_f32_16x16x32_bf16 v[244:247], v[248:251], a[92:95], v[244:247]
    ds_read_b64_tr_b16 a[106:107], v29 offset:39424
    buffer_load_dwordx4 v28, s[12:15], s57 offen offset:1024 lds
    v_mfma_f32_16x16x32_bf16 v[44:47], a[84:87], v[100:103], v[44:47]
    ds_read_b128 v[96:99], v30 offset:40960
    v_mfma_f32_16x16x32_bf16 v[60:63], a[88:91], v[100:103], v[60:63]
    buffer_load_dwordx4 v28, s[12:15], s57 offen offset:2048 lds
    v_mfma_f32_16x16x32_bf16 v[84:87], v[100:103], a[92:95], v[84:87]
    s_waitcnt lgkmcnt(9)
    v_mfma_f32_16x16x32_bf16 v[64:67], a[88:91], v[104:107], v[64:67]
    ds_read_b128 v[100:103], v30 offset:57344
    v_mfma_f32_16x16x32_bf16 v[68:71], v[104:107], a[92:95], v[68:71]
    s_waitcnt lgkmcnt(9)
    s_waitcnt lgkmcnt(2)
    v_mfma_f32_16x16x32_bf16 v[32:35], a[96:99], v[88:91], v[32:35]
    ds_read_b128 v[104:107], v156 offset:8192
    v_mfma_f32_16x16x32_bf16 v[48:51], a[100:103], v[88:91], v[48:51]
    v_mfma_f32_16x16x32_bf16 v[72:75], v[88:91], a[104:107], v[72:75]
    v_mfma_f32_16x16x32_bf16 v[236:239], a[96:99], v[248:251], v[236:239]
    v_mfma_f32_16x16x32_bf16 v[36:39], a[96:99], v[92:95], v[36:39]
    s_waitcnt vmcnt(3)
    s_barrier
    ds_read_b128 v[88:91], v31 offset:8192
    v_mfma_f32_16x16x32_bf16 v[52:55], a[100:103], v[92:95], v[52:55]
    ds_read_b64_tr_b16 a[108:109], v29 offset:49152
    v_mfma_f32_16x16x32_bf16 v[76:79], v[92:95], a[104:107], v[76:79]
    s_waitcnt lgkmcnt(4)
    ds_read_b64_tr_b16 a[110:111], v29 offset:49664
    v_mfma_f32_16x16x32_bf16 v[240:243], a[100:103], v[248:251], v[240:243]
    ds_read_b64_tr_b16 a[112:113], v29 offset:50176
    s_bfe_u32 s57, s56, 196628
    s_lshl1_add_u32 s57, s57, 1
    s_add_u32 m0, s29, 94208
    s_mul_i32 s57, s57, 98304
    buffer_load_dwordx4 v28, s[12:15], s57 offen offset:0 lds
    v_mfma_f32_16x16x32_bf16 v[40:43], a[96:99], v[96:99], v[40:43]
    ds_read_b128 v[92:95], v31 offset:24576
    v_mfma_f32_16x16x32_bf16 v[56:59], a[100:103], v[96:99], v[56:59]
    ds_read_b64_tr_b16 a[114:115], v29 offset:50688
    v_mfma_f32_16x16x32_bf16 v[80:83], v[96:99], a[104:107], v[80:83]
    s_waitcnt lgkmcnt(7)
    ds_read_b64_tr_b16 a[116:117], v29 offset:51200
    v_mfma_f32_16x16x32_bf16 v[244:247], v[248:251], a[104:107], v[244:247]
    ds_read_b64_tr_b16 a[118:119], v29 offset:51712
    buffer_load_dwordx4 v28, s[12:15], s57 offen offset:1024 lds
    v_mfma_f32_16x16x32_bf16 v[44:47], a[96:99], v[100:103], v[44:47]
    ds_read_b128 v[96:99], v31 offset:40960
    v_mfma_f32_16x16x32_bf16 v[60:63], a[100:103], v[100:103], v[60:63]
    s_or_b32 s3, s62, s59
    v_mov_b32 v12, s3
    v_mov_b32 v13, s63
    v_mov_b32 v11, 0
    s_lshl3_add_u32 s3, s4, s5
    s_lshl_b32 s3, s3, 3
    s_add_u32 s3, s3, 8192
    s_cmp_eq_u32 s6, 0
    s_cselect_b32 s3, s3, 134217728
    s_mov_b64 exec, 1
    buffer_store_dwordx2 v[12:13], v11, s[16:19], s3 offen sc1
    s_mov_b64 exec, -1
    v_mfma_f32_16x16x32_bf16 v[84:87], v[100:103], a[104:107], v[84:87]
    s_waitcnt lgkmcnt(9)
    buffer_load_dwordx4 v28, s[12:15], s57 offen offset:2048 lds
    v_mfma_f32_16x16x32_bf16 v[64:67], a[100:103], v[104:107], v[64:67]
    ds_read_b128 v[100:103], v31 offset:57344
    v_mfma_f32_16x16x32_bf16 v[68:71], v[104:107], a[104:107], v[68:71]
    s_waitcnt lgkmcnt(9)
    buffer_load_dwordx2 v[126:127], v124, s[16:19], 0 offen sc1
    s_waitcnt lgkmcnt(2)
    v_mfma_f32_16x16x32_bf16 v[32:35], a[108:111], v[88:91], v[32:35]
    ds_read_b128 v[104:107], v157 offset:8192
    v_mfma_f32_16x16x32_bf16 v[48:51], a[112:115], v[88:91], v[48:51]
    s_bfe_u32 s3, s56, 196632
    s_lshl_b32 s3, s3, 7
    s_add_u32 m0, s44, 12288
    s_add_u32 s57, s3, s47
    buffer_load_dwordx4 v26, s[8:11], s57 offen lds
    v_mfma_f32_16x16x32_bf16 v[72:75], v[88:91], a[116:119], v[72:75]
    buffer_load_dwordx4 v27, s[8:11], s57 offen offset:1024 lds
    v_mfma_f32_16x16x32_bf16 v[236:239], a[108:111], v[248:251], v[236:239]
    s_lshl2_add_u32 s3, s24, 196632
    s_bfe_u32 s3, s56, s3
    s_lshl_b32 s3, s3, 7
    s_add_u32 s57, s3, s28
    s_lshl_b32 s3, s6, 10
L_pad1:
    s_cbranch_execz L_pad5
    s_add_u32 m0, s3, 77824
    s_nop 0
    buffer_load_dwordx4 v158, s[8:11], s57 offen lds
    v_mfma_f32_16x16x32_bf16 v[36:39], a[108:111], v[92:95], v[36:39]
    s_waitcnt vmcnt(8)
    s_barrier
    ds_read_b128 v[88:91], v30 offset:10240
    v_mfma_f32_16x16x32_bf16 v[52:55], a[112:115], v[92:95], v[52:55]
    ds_read_b64_tr_b16 a[120:121], v29 offset:0
    v_mfma_f32_16x16x32_bf16 v[76:79], v[92:95], a[116:119], v[76:79]
    s_waitcnt lgkmcnt(4)
    ds_read_b64_tr_b16 a[122:123], v29 offset:512
    v_mfma_f32_16x16x32_bf16 v[240:243], a[112:115], v[248:251], v[240:243]
    ds_read_b64_tr_b16 a[124:125], v29 offset:1024
    s_bfe_u32 s57, s56, 196632
    s_lshl1_add_u32 s57, s57, 0
    s_add_u32 m0, s29, 106496
    s_mul_i32 s57, s57, 98304
    buffer_load_dwordx4 v28, s[12:15], s57 offen offset:0 lds
    v_mfma_f32_16x16x32_bf16 v[40:43], a[108:111], v[96:99], v[40:43]
    ds_read_b128 v[92:95], v30 offset:26624
    v_mfma_f32_16x16x32_bf16 v[56:59], a[112:115], v[96:99], v[56:59]
    ds_read_b64_tr_b16 a[126:127], v29 offset:1536
    v_mfma_f32_16x16x32_bf16 v[80:83], v[96:99], a[116:119], v[80:83]
    s_waitcnt lgkmcnt(7)
    ds_read_b64_tr_b16 a[128:129], v29 offset:2048
    v_mfma_f32_16x16x32_bf16 v[244:247], v[248:251], a[116:119], v[244:247]
    ds_read_b64_tr_b16 a[130:131], v29 offset:2560
    buffer_load_dwordx4 v28, s[12:15], s57 offen offset:1024 lds
    v_mfma_f32_16x16x32_bf16 v[44:47], a[108:111], v[100:103], v[44:47]
    ds_read_b128 v[96:99], v30 offset:43008
    v_mfma_f32_16x16x32_bf16 v[60:63], a[112:115], v[100:103], v[60:63]
    buffer_load_dwordx4 v28, s[12:15], s57 offen offset:2048 lds
    v_mfma_f32_16x16x32_bf16 v[84:87], v[100:103], a[116:119], v[84:87]
    s_waitcnt lgkmcnt(9)
    v_mfma_f32_16x16x32_bf16 v[64:67], a[112:115], v[104:107], v[64:67]
    ds_read_b128 v[100:103], v30 offset:59392
    v_mfma_f32_16x16x32_bf16 v[68:71], v[104:107], a[116:119], v[68:71]
    s_waitcnt lgkmcnt(9)
    s_waitcnt lgkmcnt(2)
    v_mfma_f32_16x16x32_bf16 v[32:35], a[120:123], v[88:91], v[32:35]
    ds_read_b128 v[104:107], v156 offset:10240
    v_mfma_f32_16x16x32_bf16 v[48:51], a[124:127], v[88:91], v[48:51]
    v_mfma_f32_16x16x32_bf16 v[72:75], v[88:91], a[128:131], v[72:75]
    v_mfma_f32_16x16x32_bf16 v[236:239], a[120:123], v[248:251], v[236:239]
    v_mfma_f32_16x16x32_bf16 v[36:39], a[120:123], v[92:95], v[36:39]
    s_waitcnt vmcnt(7)
    s_barrier
    ds_read_b128 v[88:91], v31 offset:10240
    v_mfma_f32_16x16x32_bf16 v[52:55], a[124:127], v[92:95], v[52:55]
    ds_read_b64_tr_b16 a[132:133], v29 offset:12288
    v_mfma_f32_16x16x32_bf16 v[76:79], v[92:95], a[128:131], v[76:79]
    s_waitcnt lgkmcnt(4)
    ds_read_b64_tr_b16 a[134:135], v29 offset:12800
    v_mfma_f32_16x16x32_bf16 v[240:243], a[124:127], v[248:251], v[240:243]
    ds_read_b64_tr_b16 a[136:137], v29 offset:13312
    s_bfe_u32 s57, s56, 196632
    s_lshl1_add_u32 s57, s57, 1
    s_add_u32 m0, s29, 118784
    s_mul_i32 s57, s57, 98304
    buffer_load_dwordx4 v28, s[12:15], s57 offen offset:0 lds
    v_mfma_f32_16x16x32_bf16 v[40:43], a[120:123], v[96:99], v[40:43]
    ds_read_b128 v[92:95], v31 offset:26624
    v_mfma_f32_16x16x32_bf16 v[56:59], a[124:127], v[96:99], v[56:59]
    ds_read_b64_tr_b16 a[138:139], v29 offset:13824
    v_mfma_f32_16x16x32_bf16 v[80:83], v[96:99], a[128:131], v[80:83]
    s_waitcnt lgkmcnt(7)
    ds_read_b64_tr_b16 a[140:141], v29 offset:14336
    v_mfma_f32_16x16x32_bf16 v[244:247], v[248:251], a[128:131], v[244:247]
    ds_read_b64_tr_b16 a[142:143], v29 offset:14848
    buffer_load_dwordx4 v28, s[12:15], s57 offen offset:1024 lds
    v_mfma_f32_16x16x32_bf16 v[44:47], a[120:123], v[100:103], v[44:47]
    ds_read_b128 v[96:99], v31 offset:43008
    v_mfma_f32_16x16x32_bf16 v[60:63], a[124:127], v[100:103], v[60:63]
    buffer_load_dwordx4 v28, s[12:15], s57 offen offset:2048 lds
    v_mfma_f32_16x16x32_bf16 v[84:87], v[100:103], a[128:131], v[84:87]
    s_waitcnt lgkmcnt(9)
    s_bfe_u32 s3, s56, 196636
    s_lshl_b32 s3, s3, 7
    s_add_u32 m0, s44, 14336
    s_add_u32 s57, s3, s47
    buffer_load_dwordx4 v26, s[8:11], s57 offen lds
    v_mfma_f32_16x16x32_bf16 v[64:67], a[124:127], v[104:107], v[64:67]
    ds_read_b128 v[100:103], v31 offset:59392
    v_mfma_f32_16x16x32_bf16 v[68:71], v[104:107], a[128:131], v[68:71]
    s_waitcnt lgkmcnt(9)
    s_waitcnt vmcnt(10)
    v_and_b32 v11, -16, v126
    v_xor_b32 v11, s62, v11
    v_xor_b32 v153, s63, v127
    v_or_b32 v152, v11, v153
    v_cmp_ne_u32 vcc, 0, v152
    s_cbranch_vccnz LF_retry_1
LF_got_2:
    v_and_b32 v11, 15, v126
    v_cmp_ne_u32 vcc, s59, v11
    s_nop 0
    s_and_b32 s3, vcc_lo, 0xff
    s_cselect_b32 s7, 0, 1
    buffer_load_dword v126, v6, s[16:19], s39 offen sc1
    buffer_load_dwordx4 v[108:111], v8, s[16:19], s37 offen offset:0 sc1
    buffer_load_dwordx4 v[112:115], v8, s[16:19], s37 offen offset:1024 sc1
    v_and_b32 v124, 0x300, v1
    v_add_u32 v124, v124, v1
    buffer_load_dwordx4 v[116:119], v124, s[16:19], s38 offen offset:0 sc1
    buffer_load_dwordx4 v[120:123], v124, s[16:19], s38 offen offset:256 sc1
    s_waitcnt lgkmcnt(2)
    v_mfma_f32_16x16x32_bf16 v[32:35], a[132:135], v[88:91], v[32:35]
    ds_read_b128 v[104:107], v157 offset:10240
    v_mfma_f32_16x16x32_bf16 v[48:51], a[136:139], v[88:91], v[48:51]
    buffer_load_dwordx4 v27, s[8:11], s57 offen offset:1024 lds
    v_mfma_f32_16x16x32_bf16 v[72:75], v[88:91], a[140:143], v[72:75]
    s_mov_b64 exec, 15
    global_load_dword v155, v154, s[0:1]
    s_mov_b64 exec, -1
    v_mfma_f32_16x16x32_bf16 v[236:239], a[132:135], v[248:251], v[236:239]
    v_mfma_f32_16x16x32_bf16 v[36:39], a[132:135], v[92:95], v[36:39]
    s_waitcnt vmcnt(11)
    s_barrier
    ds_read_b128 v[88:91], v30 offset:12288
    v_mfma_f32_16x16x32_bf16 v[52:55], a[136:139], v[92:95], v[52:55]
    ds_read_b64_tr_b16 a[144:145], v29 offset:24576
    v_mfma_f32_16x16x32_bf16 v[76:79], v[92:95], a[140:143], v[76:79]
    s_waitcnt lgkmcnt(4)
    ds_read_b64_tr_b16 a[146:147], v29 offset:25088
    v_mfma_f32_16x16x32_bf16 v[240:243], a[136:139], v[248:251], v[240:243]
    ds_read_b64_tr_b16 a[148:149], v29 offset:25600
    s_bfe_u32 s57, s56, 196636
    s_lshl1_add_u32 s57, s57, 0
    s_add_u32 m0, s29, 131072
    s_mul_i32 s57, s57, 98304
    buffer_load_dwordx4 v28, s[12:15], s57 offen offset:0 lds
    v_mfma_f32_16x16x32_bf16 v[40:43], a[132:135], v[96:99], v[40:43]
    ds_read_b128 v[92:95], v30 offset:28672
    v_mfma_f32_16x16x32_bf16 v[56:59], a[136:139], v[96:99], v[56:59]
    ds_read_b64_tr_b16 a[150:151], v29 offset:26112
    v_mfma_f32_16x16x32_bf16 v[80:83], v[96:99], a[140:143], v[80:83]
    s_waitcnt lgkmcnt(7)
    ds_read_b64_tr_b16 a[152:153], v29 offset:26624
    v_mfma_f32_16x16x32_bf16 v[244:247], v[248:251], a[140:143], v[244:247]
    ds_read_b64_tr_b16 a[154:155], v29 offset:27136
    buffer_load_dwordx4 v28, s[12:15], s57 offen offset:1024 lds
    v_mfma_f32_16x16x32_bf16 v[44:47], a[132:135], v[100:103], v[44:47]
    ds_read_b128 v[96:99], v30 offset:45056
    v_mfma_f32_16x16x32_bf16 v[60:63], a[136:139], v[100:103], v[60:63]
    buffer_load_dwordx4 v28, s[12:15], s57 offen offset:2048 lds
    v_mfma_f32_16x16x32_bf16 v[84:87], v[100:103], a[140:143], v[84:87]
    s_waitcnt lgkmcnt(9)
    v_mfma_f32_16x16x32_bf16 v[64:67], a[136:139], v[104:107], v[64:67]
    ds_read_b128 v[100:103], v30 offset:61440
    v_mfma_f32_16x16x32_bf16 v[68:71], v[104:107], a[140:143], v[68:71]
    s_waitcnt lgkmcnt(9)
    s_waitcnt lgkmcnt(2)
    v_mfma_f32_16x16x32_bf16 v[32:35], a[144:147], v[88:91], v[32:35]
    ds_read_b128 v[104:107], v156 offset:12288
    v_mfma_f32_16x16x32_bf16 v[48:51], a[148:151], v[88:91], v[48:51]
    v_mfma_f32_16x16x32_bf16 v[72:75], v[88:91], a[152:155], v[72:75]
    v_mfma_f32_16x16x32_bf16 v[236:239], a[144:147], v[248:251], v[236:239]
    v_mfma_f32_16x16x32_bf16 v[36:39], a[144:147], v[92:95], v[36:39]
    s_waitcnt vmcnt(11)
    s_barrier
    ds_read_b128 v[88:91], v31 offset:12288
    v_mfma_f32_16x16x32_bf16 v[52:55], a[148:151], v[92:95], v[52:55]
    ds_read_b64_tr_b16 a[156:157], v29 offset:36864
    v_mfma_f32_16x16x32_bf16 v[76:79], v[92:95], a[152:155], v[76:79]
    s_waitcnt lgkmcnt(4)
    ds_read_b64_tr_b16 a[158:159], v29 offset:37376
    v_mfma_f32_16x16x32_bf16 v[240:243], a[148:151], v[248:251], v[240:243]
    ds_read_b64_tr_b16 a[160:161], v29 offset:37888
    s_bfe_u32 s57, s56, 196636
    s_lshl1_add_u32 s57, s57, 1
    s_add_u32 m0, s29, 81920
    s_mul_i32 s57, s57, 98304
    buffer_load_dwordx4 v28, s[12:15], s57 offen offset:0 lds
    v_mfma_f32_16x16x32_bf16 v[40:43], a[144:147], v[96:99], v[40:43]
    ds_read_b128 v[92:95], v31 offset:28672
    v_mfma_f32_16x16x32_bf16 v[56:59], a[148:151], v[96:99], v[56:59]
    ds_read_b64_tr_b16 a[162:163], v29 offset:38400
    v_mfma_f32_16x16x32_bf16 v[80:83], v[96:99], a[152:155], v[80:83]
    s_waitcnt lgkmcnt(7)
    ds_read_b64_tr_b16 a[164:165], v29 offset:38912
    v_mfma_f32_16x16x32_bf16 v[244:247], v[248:251], a[152:155], v[244:247]
    ds_read_b64_tr_b16 a[166:167], v29 offset:39424
    buffer_load_dwordx4 v28, s[12:15], s57 offen offset:1024 lds
    v_mfma_f32_16x16x32_bf16 v[44:47], a[144:147], v[100:103], v[44:47]
    ds_read_b128 v[96:99], v31 offset:45056
    v_mfma_f32_16x16x32_bf16 v[60:63], a[148:151], v[100:103], v[60:63]
    buffer_load_dwordx4 v28, s[12:15], s57 offen offset:2048 lds
    v_mfma_f32_16x16x32_bf16 v[84:87], v[100:103], a[152:155], v[84:87]
    s_waitcnt lgkmcnt(9)
    s_mov_b32 s12, s0
    s_mov_b32 s13, s1
    s_mov_b32 s14, 524288
    s_lshl_b32 s29, s6, 10
    s_lshl_b32 s3, s5, 7
    s_lshl3_add_u32 s28, s29, s3
    s_add_u32 m0, s29, 143360
    s_add_u32 s54, s28, 0
    buffer_load_dwordx4 v150, s[12:15], s54 offen lds
    v_mfma_f32_16x16x32_bf16 v[64:67], a[148:151], v[104:107], v[64:67]
    ds_read_b128 v[100:103], v31 offset:61440
    v_mfma_f32_16x16x32_bf16 v[68:71], v[104:107], a[152:155], v[68:71]
    s_waitcnt lgkmcnt(9)
    s_waitcnt lgkmcnt(2)
    v_mfma_f32_16x16x32_bf16 v[32:35], a[156:159], v[88:91], v[32:35]
    ds_read_b128 v[104:107], v157 offset:12288
    v_mfma_f32_16x16x32_bf16 v[48:51], a[160:163], v[88:91], v[48:51]
    s_add_u32 m0, s29, 155648
    s_add_u32 s54, s28, 491520
    buffer_load_dwordx4 v150, s[12:15], s54 offen lds
    v_mfma_f32_16x16x32_bf16 v[72:75], v[88:91], a[164:167], v[72:75]
    s_add_u32 m0, s29, 147456
    s_add_u32 s54, s28, 32768
    buffer_load_dwordx4 v150, s[12:15], s54 offen lds
    v_mfma_f32_16x16x32_bf16 v[236:239], a[156:159], v[248:251], v[236:239]
    s_add_u32 m0, s29, 151552
    s_add_u32 s54, s28, 65536
    buffer_load_dwordx4 v150, s[12:15], s54 offen lds
    s_add_u32 m0, s29, 94208
    s_add_u32 s54, s28, 98304
    buffer_load_dwordx4 v150, s[12:15], s54 offen lds
    v_mfma_f32_16x16x32_bf16 v[36:39], a[156:159], v[92:95], v[36:39]
    s_waitcnt vmcnt(8)
    s_barrier
    ds_read_b128 v[88:91], v30 offset:14336
    v_mfma_f32_16x16x32_bf16 v[52:55], a[160:163], v[92:95], v[52:55]
    ds_read_b64_tr_b16 a[168:169], v29 offset:49152
    v_mfma_f32_16x16x32_bf16 v[76:79], v[92:95], a[164:167], v[76:79]
    s_waitcnt lgkmcnt(4)
    ds_read_b64_tr_b16 a[170:171], v29 offset:49664
    v_mfma_f32_16x16x32_bf16 v[240:243], a[160:163], v[248:251], v[240:243]
    ds_read_b64_tr_b16 a[172:173], v29 offset:50176
    s_add_u32 m0, s29, 98304
    s_add_u32 s54, s28, 131072
    buffer_load_dwordx4 v150, s[12:15], s54 offen lds
    v_mfma_f32_16x16x32_bf16 v[40:43], a[156:159], v[96:99], v[40:43]
    ds_read_b128 v[92:95], v30 offset:30720
    v_mfma_f32_16x16x32_bf16 v[56:59], a[160:163], v[96:99], v[56:59]
    ds_read_b64_tr_b16 a[174:175], v29 offset:50688
    v_mfma_f32_16x16x32_bf16 v[80:83], v[96:99], a[164:167], v[80:83]
    s_waitcnt lgkmcnt(7)
    ds_read_b64_tr_b16 a[176:177], v29 offset:51200
    v_mfma_f32_16x16x32_bf16 v[244:247], v[248:251], a[164:167], v[244:247]
    ds_read_b64_tr_b16 a[178:179], v29 offset:51712
    s_add_u32 m0, s29, 102400
    s_add_u32 s54, s28, 163840
    buffer_load_dwordx4 v150, s[12:15], s54 offen lds
    v_mfma_f32_16x16x32_bf16 v[44:47], a[156:159], v[100:103], v[44:47]
    ds_read_b128 v[96:99], v30 offset:47104
    v_mfma_f32_16x16x32_bf16 v[60:63], a[160:163], v[100:103], v[60:63]
    s_add_u32 m0, s29, 106496
    s_add_u32 s54, s28, 196608
    buffer_load_dwordx4 v150, s[12:15], s54 offen lds
    v_mfma_f32_16x16x32_bf16 v[84:87], v[100:103], a[164:167], v[84:87]
    s_waitcnt lgkmcnt(9)
    s_add_u32 m0, s29, 110592
    s_add_u32 s54, s28, 229376
    buffer_load_dwordx4 v150, s[12:15], s54 offen lds
    v_mfma_f32_16x16x32_bf16 v[64:67], a[160:163], v[104:107], v[64:67]
    ds_read_b128 v[100:103], v30 offset:63488
    v_mfma_f32_16x16x32_bf16 v[68:71], v[104:107], a[164:167], v[68:71]
    s_waitcnt lgkmcnt(9)
    v_add_f32 v108, v108, v110
    v_add_f32 v109, v109, v111
    s_waitcnt lgkmcnt(2)
    v_mfma_f32_16x16x32_bf16 v[32:35], a[168:171], v[88:91], v[32:35]
    ds_read_b128 v[104:107], v156 offset:14336
    v_add_f32 v112, v112, v114
    v_mfma_f32_16x16x32_bf16 v[48:51], a[172:175], v[88:91], v[48:51]
    s_add_u32 m0, s29, 114688
    s_add_u32 s54, s28, 262144
    buffer_load_dwordx4 v150, s[12:15], s54 offen lds
    v_mfma_f32_16x16x32_bf16 v[72:75], v[88:91], a[176:179], v[72:75]
    v_add_f32 v113, v113, v115
    v_add_f32 v108, v108, v112
    v_mfma_f32_16x16x32_bf16 v[236:239], a[168:171], v[248:251], v[236:239]
    v_add_f32 v109, v109, v113
    v_add_f32 v116, v116, v118
    v_mfma_f32_16x16x32_bf16 v[36:39], a[168:171], v[92:95], v[36:39]
    s_waitcnt vmcnt(10)
    s_barrier
    ds_read_b128 v[88:91], v31 offset:14336
    v_mfma_f32_16x16x32_bf16 v[52:55], a[172:175], v[92:95], v[52:55]
    ds_read_b64_tr_b16 a[180:181], v29 offset:0
    v_add_f32 v117, v117, v119
    v_mfma_f32_16x16x32_bf16 v[76:79], v[92:95], a[176:179], v[76:79]
    s_waitcnt lgkmcnt(4)
    ds_read_b64_tr_b16 a[182:183], v29 offset:512
    v_mfma_f32_16x16x32_bf16 v[240:243], a[172:175], v[248:251], v[240:243]
    ds_read_b64_tr_b16 a[184:185], v29 offset:1024
    v_add_f32 v120, v120, v122
    v_mfma_f32_16x16x32_bf16 v[40:43], a[168:171], v[96:99], v[40:43]
    ds_read_b128 v[92:95], v31 offset:30720
    v_add_f32 v121, v121, v123
    v_mfma_f32_16x16x32_bf16 v[56:59], a[172:175], v[96:99], v[56:59]
    ds_read_b64_tr_b16 a[186:187], v29 offset:1536
    v_add_f32 v116, v116, v120
    v_mfma_f32_16x16x32_bf16 v[80:83], v[96:99], a[176:179], v[80:83]
    s_waitcnt lgkmcnt(7)
    ds_read_b64_tr_b16 a[188:189], v29 offset:2048
    v_mfma_f32_16x16x32_bf16 v[244:247], v[248:251], a[176:179], v[244:247]
    ds_read_b64_tr_b16 a[190:191], v29 offset:2560
    v_add_f32 v117, v117, v121
    v_mfma_f32_16x16x32_bf16 v[44:47], a[168:171], v[100:103], v[44:47]
    ds_read_b128 v[96:99], v31 offset:47104
    v_lshl_add_u32 v110, s6, 7, v9
    v_mfma_f32_16x16x32_bf16 v[60:63], a[172:175], v[100:103], v[60:63]
    v_add_u32 v111, 512, v9
    v_mfma_f32_16x16x32_bf16 v[84:87], v[100:103], a[176:179], v[84:87]
    s_waitcnt lgkmcnt(9)
    v_permlane32_swap_b32 v108, v116
    v_mfma_f32_16x16x32_bf16 v[64:67], a[172:175], v[104:107], v[64:67]
    ds_read_b128 v[100:103], v31 offset:63488
    v_mfma_f32_16x16x32_bf16 v[68:71], v[104:107], a[176:179], v[68:71]
    s_waitcnt lgkmcnt(9)
    s_movk_i32 s3, 8192
    buffer_load_dwordx4 v[128:131], v1, s[16:19], s3 offen offset:0 sc1
    buffer_load_dwordx4 v[132:135], v1, s[16:19], s3 offen offset:1024 sc1
    s_waitcnt lgkmcnt(2)
    v_mfma_f32_16x16x32_bf16 v[32:35], a[180:183], v[88:91], v[32:35]
    ds_read_b128 v[104:107], v157 offset:14336
    v_mfma_f32_16x16x32_bf16 v[48:51], a[184:187], v[88:91], v[48:51]
    v_permlane32_swap_b32 v109, v117
    v_mfma_f32_16x16x32_bf16 v[72:75], v[88:91], a[188:191], v[72:75]
    v_add_f32 v112, v108, v116
    v_add_f32 v113, v109, v117
    v_mfma_f32_16x16x32_bf16 v[236:239], a[180:183], v[248:251], v[236:239]
    v_permlane32_swap_b32 v110, v111
    v_mfma_f32_16x16x32_bf16 v[36:39], a[180:183], v[92:95], v[36:39]
    v_permlane16_swap_b32 v112, v113
    v_mfma_f32_16x16x32_bf16 v[52:55], a[184:187], v[92:95], v[52:55]
    v_add_f32 v108, v112, v113
    v_add_f32 v109, v112, v113
    v_mfma_f32_16x16x32_bf16 v[76:79], v[92:95], a[188:191], v[76:79]
    s_waitcnt lgkmcnt(2)
    v_lshrrev_b32 v111, 1, v110
    v_add_u32 v111, 80896, v111
    v_mfma_f32_16x16x32_bf16 v[240:243], a[184:187], v[248:251], v[240:243]
    v_permlane16_swap_b32 v108, v109
    v_mfma_f32_16x16x32_bf16 v[40:43], a[180:183], v[96:99], v[40:43]
    v_mul_f32 v108, 0xbb000000, v108
    v_mul_f32 v109, 0x3b000000, v109
    v_mfma_f32_16x16x32_bf16 v[56:59], a[184:187], v[96:99], v[56:59]
    v_fma_f32 v109, -v108, v108, v109
    v_max_f32 v109, 0, v109
    v_mfma_f32_16x16x32_bf16 v[80:83], v[96:99], a[188:191], v[80:83]
    s_waitcnt lgkmcnt(1)
    v_add_f32 v109, 0x3727c5ac, v109
    v_mfma_f32_16x16x32_bf16 v[244:247], v[248:251], a[188:191], v[244:247]
    v_rsq_f32 v109, v109
    v_mfma_f32_16x16x32_bf16 v[44:47], a[180:183], v[100:103], v[44:47]
    ds_write_b64 v110, v[108:109]
    v_mfma_f32_16x16x32_bf16 v[60:63], a[184:187], v[100:103], v[60:63]
    ds_write2_b32 v111, v108, v109 offset0:0 offset1:128
    v_mfma_f32_16x16x32_bf16 v[84:87], v[100:103], a[188:191], v[84:87]
    s_waitcnt lgkmcnt(2)
    s_waitcnt lgkmcnt(0)
    s_barrier
    v_mfma_f32_16x16x32_bf16 v[64:67], a[184:187], v[104:107], v[64:67]
    ds_read_b128 v[108:111], v10 offset:256
    v_mfma_f32_16x16x32_bf16 v[68:71], v[104:107], a[188:191], v[68:71]
    ds_read_b128 v[112:115], v10 offset:768
    ds_read_b128 v[116:119], v10 offset:0
    ds_read_b128 v[120:123], v10 offset:512
    ds_read_b128 v[124:127], v10 offset:704
    ds_read_b64 v[16:17], v9 offset:0
    ds_read_b64 v[18:19], v9 offset:128
    ds_read_b64 v[20:21], v9 offset:256
    ds_read_b64 v[22:23], v9 offset:384
    ds_read_b64 v[24:25], v9 offset:512
    s_cmp_eq_u32 s7, 0
    s_cbranch_scc1 L_slow
    ds_read_b128 v[88:91], v10 offset:64
    ds_read_b128 v[92:95], v10 offset:576
    ds_read_b128 v[96:99], v10 offset:128
    ds_read_b128 v[100:103], v10 offset:640
    ds_read_b128 v[104:107], v10 offset:192
    s_lshl2_add_u32 s3, s5, s6
    s_lshl_b32 s3, s3, 10
    s_add_u32 s3, s3, s35
    s_lshl_b32 s58, s25, 15
    s_xor_b32 s57, s58, 0x8000
    s_add_u32 s57, s57, s3
    s_add_u32 s58, s58, s3
    s_waitcnt lgkmcnt(5)
    s_nop 0
    v_pk_fma_f32 v[32:33], v[236:237], v[16:17], v[32:33] op_sel:[0,0,0] op_sel_hi:[1,0,1]
    v_pk_fma_f32 v[34:35], v[238:239], v[16:17], v[34:35] op_sel:[0,0,0] op_sel_hi:[1,0,1]
    v_cvt_pk_bf16_f32 v32, v32, v33
    v_cvt_pk_bf16_f32 v33, v34, v35
    v_pk_fma_f32 v[36:37], v[236:237], v[18:19], v[36:37] op_sel:[0,0,0] op_sel_hi:[1,0,1]
    v_pk_fma_f32 v[38:39], v[238:239], v[18:19], v[38:39] op_sel:[0,0,0] op_sel_hi:[1,0,1]
    v_cvt_pk_bf16_f32 v36, v36, v37
    v_cvt_pk_bf16_f32 v37, v38, v39
    v_pk_fma_f32 v[40:41], v[236:237], v[20:21], v[40:41] op_sel:[0,0,0] op_sel_hi:[1,0,1]
    v_pk_fma_f32 v[42:43], v[238:239], v[20:21], v[42:43] op_sel:[0,0,0] op_sel_hi:[1,0,1]
    v_cvt_pk_bf16_f32 v40, v40, v41
    v_cvt_pk_bf16_f32 v41, v42, v43
    v_pk_fma_f32 v[44:45], v[236:237], v[22:23], v[44:45] op_sel:[0,0,0] op_sel_hi:[1,0,1]
    v_pk_fma_f32 v[46:47], v[238:239], v[22:23], v[46:47] op_sel:[0,0,0] op_sel_hi:[1,0,1]
    v_cvt_pk_bf16_f32 v44, v44, v45
    v_cvt_pk_bf16_f32 v45, v46, v47
    v_pk_fma_f32 v[68:69], v[108:109], v[244:245], v[68:69] op_sel:[0,0,0] op_sel_hi:[1,0,1]
    v_pk_fma_f32 v[70:71], v[110:111], v[244:245], v[70:71] op_sel:[0,0,0] op_sel_hi:[1,0,1]
    v_pk_mul_f32 v[68:69], v[68:69], v[112:113]
    v_pk_mul_f32 v[70:71], v[70:71], v[114:115]
    v_cvt_pk_bf16_f32 v68, v68, v69
    v_cvt_pk_bf16_f32 v69, v70, v71
    s_add_u32 m0, s29, 118784
    s_add_u32 s54, s28, 294912
    buffer_load_dwordx4 v150, s[12:15], s54 offen lds
    v_pk_fma_f32 v[72:73], v[116:117], v[244:245], v[72:73] op_sel:[0,0,0] op_sel_hi:[1,0,1]
    v_pk_fma_f32 v[74:75], v[118:119], v[244:245], v[74:75] op_sel:[0,0,0] op_sel_hi:[1,0,1]
    v_pk_mul_f32 v[72:73], v[72:73], v[120:121]
    v_pk_mul_f32 v[74:75], v[74:75], v[122:123]
    v_cvt_pk_bf16_f32 v70, v72, v73
    v_cvt_pk_bf16_f32 v71, v74, v75
    s_waitcnt lgkmcnt(0)
    s_nop 0
    v_pk_fma_f32 v[76:77], v[88:89], v[244:245], v[76:77] op_sel:[0,0,0] op_sel_hi:[1,0,1]
    v_pk_fma_f32 v[78:79], v[90:91], v[244:245], v[78:79] op_sel:[0,0,0] op_sel_hi:[1,0,1]
    v_pk_mul_f32 v[76:77], v[76:77], v[92:93]
    v_pk_mul_f32 v[78:79], v[78:79], v[94:95]
    v_cvt_pk_bf16_f32 v72, v76, v77
    v_cvt_pk_bf16_f32 v73, v78, v79
    v_pk_fma_f32 v[80:81], v[96:97], v[244:245], v[80:81] op_sel:[0,0,0] op_sel_hi:[1,0,1]
    v_pk_fma_f32 v[82:83], v[98:99], v[244:245], v[82:83] op_sel:[0,0,0] op_sel_hi:[1,0,1]
    v_pk_mul_f32 v[80:81], v[80:81], v[100:101]
    v_pk_mul_f32 v[82:83], v[82:83], v[102:103]
    v_cvt_pk_bf16_f32 v74, v80, v81
    v_cvt_pk_bf16_f32 v75, v82, v83
    s_add_u32 m0, s29, 122880
    s_add_u32 s54, s28, 327680
    buffer_load_dwordx4 v150, s[12:15], s54 offen lds
    v_pk_fma_f32 v[84:85], v[104:105], v[244:245], v[84:85] op_sel:[0,0,0] op_sel_hi:[1,0,1]
    v_pk_fma_f32 v[86:87], v[106:107], v[244:245], v[86:87] op_sel:[0,0,0] op_sel_hi:[1,0,1]
    v_pk_mul_f32 v[84:85], v[84:85], v[124:125]
    v_pk_mul_f32 v[86:87], v[86:87], v[126:127]
    v_cvt_pk_bf16_f32 v76, v84, v85
    v_cvt_pk_bf16_f32 v77, v86, v87
    v_pk_fma_f32 v[64:65], v[240:241], v[24:25], v[64:65] op_sel:[0,0,0] op_sel_hi:[1,0,1]
    v_pk_fma_f32 v[66:67], v[242:243], v[24:25], v[66:67] op_sel:[0,0,0] op_sel_hi:[1,0,1]
    v_pk_mul_f32 v[64:65], v[64:65], v[24:25] op_sel:[0,1] op_sel_hi:[1,1]
    v_pk_mul_f32 v[66:67], v[66:67], v[24:25] op_sel:[0,1] op_sel_hi:[1,1]
    v_cvt_pk_bf16_f32 v64, v64, v65
    v_cvt_pk_bf16_f32 v65, v66, v67
    v_pk_fma_f32 v[48:49], v[240:241], v[16:17], v[48:49] op_sel:[0,0,0] op_sel_hi:[1,0,1]
    v_pk_fma_f32 v[50:51], v[242:243], v[16:17], v[50:51] op_sel:[0,0,0] op_sel_hi:[1,0,1]
    v_pk_mul_f32 v[48:49], v[48:49], v[16:17] op_sel:[0,1] op_sel_hi:[1,1]
    v_pk_mul_f32 v[50:51], v[50:51], v[16:17] op_sel:[0,1] op_sel_hi:[1,1]
    v_cvt_pk_bf16_f32 v48, v48, v49
    v_cvt_pk_bf16_f32 v49, v50, v51
    v_pk_fma_f32 v[52:53], v[240:241], v[18:19], v[52:53] op_sel:[0,0,0] op_sel_hi:[1,0,1]
    v_pk_fma_f32 v[54:55], v[242:243], v[18:19], v[54:55] op_sel:[0,0,0] op_sel_hi:[1,0,1]
    v_pk_mul_f32 v[52:53], v[52:53], v[18:19] op_sel:[0,1] op_sel_hi:[1,1]
    v_pk_mul_f32 v[54:55], v[54:55], v[18:19] op_sel:[0,1] op_sel_hi:[1,1]
    v_cvt_pk_bf16_f32 v52, v52, v53
    v_cvt_pk_bf16_f32 v53, v54, v55
    s_add_u32 m0, s29, 126976
    s_add_u32 s54, s28, 360448
    buffer_load_dwordx4 v150, s[12:15], s54 offen lds
    v_pk_fma_f32 v[56:57], v[240:241], v[20:21], v[56:57] op_sel:[0,0,0] op_sel_hi:[1,0,1]
    v_pk_fma_f32 v[58:59], v[242:243], v[20:21], v[58:59] op_sel:[0,0,0] op_sel_hi:[1,0,1]
    v_pk_mul_f32 v[56:57], v[56:57], v[20:21] op_sel:[0,1] op_sel_hi:[1,1]
    v_pk_mul_f32 v[58:59], v[58:59], v[20:21] op_sel:[0,1] op_sel_hi:[1,1]
    v_cvt_pk_bf16_f32 v56, v56, v57
    v_cvt_pk_bf16_f32 v57, v58, v59
    v_pk_fma_f32 v[60:61], v[240:241], v[22:23], v[60:61] op_sel:[0,0,0] op_sel_hi:[1,0,1]
    v_pk_fma_f32 v[62:63], v[242:243], v[22:23], v[62:63] op_sel:[0,0,0] op_sel_hi:[1,0,1]
    v_pk_mul_f32 v[60:61], v[60:61], v[22:23] op_sel:[0,1] op_sel_hi:[1,1]
    v_pk_mul_f32 v[62:63], v[62:63], v[22:23] op_sel:[0,1] op_sel_hi:[1,1]
    v_cvt_pk_bf16_f32 v60, v60, v61
    v_cvt_pk_bf16_f32 v61, v62, v63
    v_mfma_f32_16x16x16_bf16 v[88:91], v[48:49], v[32:33], 0
    v_mul_f32 v16, 0x3eb8aa3b, v17
    v_mul_f32 v18, 0x3eb8aa3b, v19
    v_mfma_f32_16x16x16_bf16 v[92:95], v[64:65], v[32:33], 0
    v_mul_f32 v20, 0x3eb8aa3b, v21
    v_mul_f32 v22, 0x3eb8aa3b, v23
    v_mfma_f32_16x16x16_bf16 v[96:99], v[52:53], v[36:37], 0
    s_add_u32 m0, s29, 131072
    s_add_u32 s54, s28, 393216
    buffer_load_dwordx4 v150, s[12:15], s54 offen lds
    v_mfma_f32_16x16x16_bf16 v[100:103], v[48:49], v[36:37], 0
    v_cndmask_b32 v88, v88, v89, s[48:49]
    v_cndmask_b32 v89, v90, v91, s[48:49]
    v_mfma_f32_16x16x16_bf16 v[104:107], v[56:57], v[40:41], 0
    v_cndmask_b32 v92, v92, v93, s[48:49]
    v_cndmask_b32 v93, v94, v95, s[48:49]
    v_mfma_f32_16x16x16_bf16 v[108:111], v[52:53], v[40:41], 0
    v_min_f32 v92, s45, v92
    v_min_f32 v93, s45, v93
    v_mfma_f32_16x16x16_bf16 v[112:115], v[60:61], v[44:45], 0
    v_cndmask_b32 v88, v92, v88, s[50:51]
    v_cndmask_b32 v89, v93, v89, s[52:53]
    v_mfma_f32_16x16x16_bf16 v[116:119], v[56:57], v[44:45], 0
    v_max_f32_e64 v34, v88, v89
    v_cndmask_b32 v96, v96, v97, s[48:49]
    v_cndmask_b32 v97, v98, v99, s[48:49]
    v_cndmask_b32 v100, v100, v101, s[48:49]
    v_cndmask_b32 v101, v102, v103, s[48:49]
    v_cndmask_b32 v96, v100, v96, s[50:51]
    v_cndmask_b32 v97, v101, v97, s[52:53]
    v_max_f32 v38, v96, v97
    v_cndmask_b32 v104, v104, v105, s[48:49]
    v_cndmask_b32 v105, v106, v107, s[48:49]
    v_cndmask_b32 v108, v108, v109, s[48:49]
    v_permlane32_swap_b32 v34, v38
    v_cndmask_b32 v109, v110, v111, s[48:49]
    v_cndmask_b32 v104, v108, v104, s[50:51]
    v_cndmask_b32 v105, v109, v105, s[52:53]
    v_max_f32_e64 v42, v104, v105
    v_cndmask_b32 v112, v112, v113, s[48:49]
    v_cndmask_b32 v113, v114, v115, s[48:49]
    v_cndmask_b32 v116, v116, v117, s[48:49]
    v_cndmask_b32 v117, v118, v119, s[48:49]
    v_cndmask_b32 v112, v116, v112, s[50:51]
    v_cndmask_b32 v113, v117, v113, s[52:53]
    v_max_f32 v46, v112, v113
    v_max_f32 v120, v34, v38
    s_nop 0
    v_permlane32_swap_b32 v42, v46
    v_max_f32_e64 v122, v42, v46
    s_add_u32 m0, s29, 135168
    s_add_u32 s54, s28, 425984
    buffer_load_dwordx4 v150, s[12:15], s54 offen lds
    s_add_u32 m0, s29, 139264
    s_add_u32 s54, s28, 458752
    buffer_load_dwordx4 v150, s[12:15], s54 offen lds
    s_mov_b32 s12, s26
    s_mov_b32 s13, s27
    s_mov_b32 s14, 0x200000
    v_permlane16_swap_b32 v120, v122
    v_max_f32 v124, v120, v122
    v_max_f32 v126, v120, v122
    s_nop 1
    v_permlane16_swap_b32 v124, v126
    v_mov_b32 v125, v124
    v_mov_b32 v127, v126
    s_nop 0
    v_permlane32_swap_b32 v124, v125
    v_permlane32_swap_b32 v126, v127
    v_pk_add_f32 v[88:89], v[88:89], v[124:125] op_sel:[0,0] op_sel_hi:[1,0] neg_lo:[0,1] neg_hi:[0,1]
    v_pk_add_f32 v[96:97], v[96:97], v[124:125] op_sel:[0,1] op_sel_hi:[1,1] neg_lo:[0,1] neg_hi:[0,1]
    v_pk_add_f32 v[104:105], v[104:105], v[126:127] op_sel:[0,0] op_sel_hi:[1,0] neg_lo:[0,1] neg_hi:[0,1]
    v_pk_add_f32 v[112:113], v[112:113], v[126:127] op_sel:[0,1] op_sel_hi:[1,1] neg_lo:[0,1] neg_hi:[0,1]
    v_pk_mul_f32 v[88:89], v[88:89], v[16:17] op_sel:[0,0] op_sel_hi:[1,0]
    v_pk_mul_f32 v[96:97], v[96:97], v[18:19] op_sel:[0,0] op_sel_hi:[1,0]
    v_pk_mul_f32 v[104:105], v[104:105], v[20:21] op_sel:[0,0] op_sel_hi:[1,0]
    v_pk_mul_f32 v[112:113], v[112:113], v[22:23] op_sel:[0,0] op_sel_hi:[1,0]
    v_exp_f32 v88, v88
    v_exp_f32 v89, v89
    v_cvt_pk_bf16_f32 v88, v88, v88
    v_cvt_pk_bf16_f32 v89, v89, v89
    v_and_b32 v92, v252, v88
    v_and_b32 v94, v254, v88
    v_and_b32 v93, v253, v89
    v_and_b32 v95, v255, v89
    v_exp_f32 v96, v96
    v_exp_f32 v97, v97
    v_mfma_f32_16x16x32_bf16 v[48:51], v[248:251], v[92:95], 0
    v_cvt_pk_bf16_f32 v96, v96, v96
    v_cvt_pk_bf16_f32 v97, v97, v97
    v_mfma_f32_16x16x32_bf16 v[88:91], v[68:71], v[92:95], 0
    v_and_b32 v100, v252, v96
    v_and_b32 v102, v254, v96
    v_and_b32 v101, v253, v97
    v_and_b32 v103, v255, v97
    v_exp_f32 v104, v104
    v_exp_f32 v105, v105
    v_mfma_f32_16x16x32_bf16 v[52:55], v[248:251], v[100:103], 0
    v_cvt_pk_bf16_f32 v104, v104, v104
    v_cvt_pk_bf16_f32 v105, v105, v105
    v_mfma_f32_16x16x32_bf16 v[96:99], v[70:73], v[100:103], 0
    v_and_b32 v108, v252, v104
    v_and_b32 v110, v254, v104
    v_and_b32 v109, v253, v105
    v_and_b32 v111, v255, v105
    v_exp_f32 v112, v112
    v_exp_f32 v113, v113
    v_mfma_f32_16x16x32_bf16 v[56:59], v[248:251], v[108:111], 0
    v_cvt_pk_bf16_f32 v112, v112, v112
    v_cvt_pk_bf16_f32 v113, v113, v113
    v_mfma_f32_16x16x32_bf16 v[104:107], v[72:75], v[108:111], 0
    v_and_b32 v116, v252, v112
    v_and_b32 v118, v254, v112
    v_and_b32 v117, v253, v113
    v_and_b32 v119, v255, v113
    v_rcp_f32 v48, v48
    v_rcp_f32 v52, v52
    v_mfma_f32_16x16x32_bf16 v[60:63], v[248:251], v[116:119], 0
L_pad2:
    s_cbranch_execz L_pad6
    v_mul_f32 v88, v88, v48
    v_mul_f32 v89, v89, v48
    v_mfma_f32_16x16x32_bf16 v[112:115], v[74:77], v[116:119], 0
    v_mul_f32 v90, v90, v48
    v_mul_f32 v91, v91, v48
    v_cvt_pk_bf16_f32 v32, v88, v89
    v_cvt_pk_bf16_f32 v33, v90, v91
    v_mul_f32 v96, v96, v52
    v_mul_f32 v97, v97, v52
    v_mul_f32 v98, v98, v52
    v_mul_f32 v99, v99, v52
    v_cvt_pk_bf16_f32 v34, v96, v97
    v_cvt_pk_bf16_f32 v35, v98, v99
    v_rcp_f32 v56, v56
    v_rcp_f32 v60, v60
    v_permlane16_swap_b32 v32, v34
    v_permlane16_swap_b32 v33, v35
    buffer_store_dwordx4 v[32:35], v1, s[16:19], s57 offen sc1
    v_mul_f32 v104, v104, v56
    v_mul_f32 v105, v105, v56
    v_mul_f32 v106, v106, v56
    v_mul_f32 v107, v107, v56
    v_mul_f32 v112, v112, v60
    v_mul_f32 v113, v113, v60
    v_mul_f32 v114, v114, v60
    v_mul_f32_e64 v115, v115, v60
    v_cvt_pk_bf16_f32 v40, v104, v105
    v_cvt_pk_bf16_f32 v42, v112, v113
    v_cvt_pk_bf16_f32 v41, v106, v107
    v_cvt_pk_bf16_f32 v43, v114, v115
    v_permlane16_swap_b32 v40, v42
    s_nop 0
    v_permlane16_swap_b32 v41, v43
    buffer_store_dwordx4 v[40:43], v1, s[16:19], s58 offen sc1
    v_xor_b32 v11, 32, v0
    ds_read_b128 v[64:67], v0
    ds_read_b128 v[68:71], v11
    v_add_u32 v14, 0x8000, v15
    s_mul_i32 s3, s6, 192
    s_add_u32 s3, s3, 1024
    v_add_u32 v13, s3, v10
    s_add_u32 s3, s3, 81024
    v_lshrrev_b32 v12, 1, v9
    v_add_u32_e64 v12, s3, v12
    s_mov_b32 exec_lo, 0x10001
    s_mov_b32 exec_hi, 0x10001
    ds_write_b128 v13, v[236:239] offset:0
    ds_write_b128 v13, v[240:243] offset:64
    s_mov_b64 exec, 0xffff
    ds_write_b32 v12, v244
    s_mov_b64 exec, -1
    s_waitcnt vmcnt(8)
    v_and_b32 v11, -16, v128
    v_xor_b32 v11, s62, v11
    v_xor_b32 v153, s63, v129
    v_or_b32 v152, v11, v153
    v_and_b32 v11, -16, v130
    v_xor_b32 v11, s62, v11
    v_xor_b32 v153, s63, v131
    v_or3_b32 v152, v11, v153, v152
    v_and_b32 v11, -16, v132
    v_xor_b32 v11, s62, v11
    v_xor_b32 v153, s63, v133
    v_or3_b32 v152, v11, v153, v152
    v_and_b32 v11, -16, v134
    v_xor_b32 v11, s62, v11
    v_xor_b32 v153, s63, v135
    v_or3_b32 v152, v11, v153, v152
    v_cmp_ne_u32 vcc, 0, v152
    s_cbranch_vccnz LF_retry_3
LF_got_4:
    s_nop 0
    s_bfe_u32 s55, s56, 196608
    v_lshl_add_u32 v4, s55, 11, v1
    buffer_load_dwordx4 a[192:195], v4, s[20:23], s30 offen offset:0
    buffer_load_dwordx4 a[196:199], v4, s[20:23], s31 offen offset:0
    buffer_load_dwordx4 a[200:203], v4, s[20:23], s32 offen offset:0
    buffer_load_dwordx4 a[204:207], v4, s[20:23], s30 offen offset:1024
    buffer_load_dwordx4 a[208:211], v4, s[20:23], s31 offen offset:1024
    buffer_load_dwordx4 a[212:215], v4, s[20:23], s32 offen offset:1024
    s_bfe_u32 s55, s56, 196612
    v_lshl_add_u32 v4, s55, 11, v1
    buffer_load_dwordx4 a[216:219], v4, s[20:23], s30 offen offset:0
    buffer_load_dwordx4 a[220:223], v4, s[20:23], s31 offen offset:0
    buffer_load_dwordx4 a[224:227], v4, s[20:23], s32 offen offset:0
    buffer_load_dwordx4 a[228:231], v4, s[20:23], s30 offen offset:1024
    buffer_load_dwordx4 a[232:235], v4, s[20:23], s31 offen offset:1024
    buffer_load_dwordx4 a[236:239], v4, s[20:23], s32 offen offset:1024
    s_lshl_b32 s3, s25, 5
    s_add_u32 s3, s3, s24
    s_lshl_b32 s3, s3, 10
    v_add_u32 v0, s3, v5
    s_lshl_b32 s47, s5, 11
    s_add_u32 s47, s47, s3
    s_add_u32 s47, s47, s34
    s_mul_i32 s3, s5, 11
    s_mul_i32 s60, s6, 3
    s_add_u32 s60, s60, s3
    s_lshl_b32 s3, s60, 10
    s_add_u32 s3, s3, s35
    s_cmpk_ge_u32 s60, 86
    s_cselect_b32 s3, 134217728, s3
    s_add_u32 s61, s3, 88064
    s_bitcmp1_b32 s60, 0
    s_cselect_b32 s99, s3, s61
    s_cselect_b32 s100, s61, s3
    s_cmp_eq_u32 s6, 3
    s_cselect_b32 s60, 134217728, s99
    s_cselect_b32 s61, 134217728, s100
    s_waitcnt lgkmcnt(3)
    v_lshlrev_b32 v32, 16, v64
    v_and_b32 v33, 0xffff0000, v64
    v_lshlrev_b32 v34, 16, v65
    v_and_b32 v35, 0xffff0000, v65
    v_lshlrev_b32 v36, 16, v66
    v_and_b32 v37, 0xffff0000, v66
    v_lshlrev_b32 v38, 16, v67
    v_and_b32 v39, 0xffff0000, v67
    v_lshlrev_b32 v40, 16, v68
    v_and_b32 v41, 0xffff0000, v68
    v_lshlrev_b32 v42, 16, v69
    v_and_b32 v43, 0xffff0000, v69
    v_lshlrev_b32 v44, 16, v70
    v_and_b32 v45, 0xffff0000, v70
    v_lshlrev_b32 v46, 16, v71
    v_and_b32 v47, 0xffff0000, v71
    v_mov_b32 v11, 1
    s_mov_b64 exec, 1
    s_waitcnt vmcnt(12)
    buffer_store_dword v11, off, s[16:19], s40
    s_mov_b64 exec, -1
    s_barrier
    s_nop 0
    s_bfe_u32 s55, s56, 196616
    v_lshl_add_u32 v4, s55, 11, v1
    buffer_load_dwordx4 a[240:243], v4, s[20:23], s30 offen offset:0
    ds_read_b64_tr_b16 v[16:17], v14 offset:28672
    ds_read_b64_tr_b16 v[18:19], v14 offset:29184
    buffer_load_dwordx4 a[244:247], v4, s[20:23], s31 offen offset:0
    ds_read_b64_tr_b16 v[20:21], v14 offset:32768
    ds_read_b64_tr_b16 v[22:23], v14 offset:33280
    buffer_load_dwordx4 a[248:251], v4, s[20:23], s32 offen offset:0
    ds_read_b64_tr_b16 v[24:25], v14 offset:36864
    ds_read_b64_tr_b16 v[26:27], v14 offset:37376
    buffer_load_dwordx4 a[252:255], v4, s[20:23], s30 offen offset:1024
    ds_read_b64_tr_b16 v[28:29], v15 offset:12288
    ds_read_b64_tr_b16 v[30:31], v15 offset:12800
    buffer_load_dwordx4 v[128:131], v4, s[20:23], s31 offen offset:1024
    ds_read_b64_tr_b16 v[236:237], v15 offset:16384
    ds_read_b64_tr_b16 v[238:239], v15 offset:16896
    buffer_load_dwordx4 v[132:135], v4, s[20:23], s32 offen offset:1024
    ds_read_b64_tr_b16 v[240:241], v15 offset:20480
    ds_read_b64_tr_b16 v[242:243], v15 offset:20992
    s_bfe_u32 s55, s56, 196620
    v_lshl_add_u32 v4, s55, 11, v1
    buffer_load_dwordx4 v[136:139], v4, s[20:23], s30 offen offset:0
    ds_read_b64_tr_b16 v[244:245], v15 offset:24576
    ds_read_b64_tr_b16 v[246:247], v15 offset:25088
    buffer_load_dwordx4 v[140:143], v4, s[20:23], s31 offen offset:0
    ds_read_b64_tr_b16 v[248:249], v15 offset:28672
    ds_read_b64_tr_b16 v[250:251], v15 offset:29184
    buffer_load_dwordx4 v[144:147], v4, s[20:23], s32 offen offset:0
    ds_read_b64_tr_b16 v[96:97], v14 offset:0
    ds_read_b64_tr_b16 v[98:99], v14 offset:512
    buffer_load_dwordx4 v[148:151], v4, s[20:23], s30 offen offset:1024
    ds_read_b64_tr_b16 v[100:101], v14 offset:4096
    ds_read_b64_tr_b16 v[102:103], v14 offset:4608
    buffer_load_dwordx4 v[152:155], v4, s[20:23], s31 offen offset:1024
    ds_read_b64_tr_b16 v[104:105], v14 offset:8192
    ds_read_b64_tr_b16 v[106:107], v14 offset:8704
    buffer_load_dwordx4 v[156:159], v4, s[20:23], s32 offen offset:1024
    ds_read_b64_tr_b16 v[108:109], v14 offset:12288
    ds_read_b64_tr_b16 v[110:111], v14 offset:12800
    ds_read_b64_tr_b16 v[112:113], v14 offset:16384
    ds_read_b64_tr_b16 v[114:115], v14 offset:16896
    ds_read_b64_tr_b16 v[116:117], v14 offset:20480
    ds_read_b64_tr_b16 v[118:119], v14 offset:20992
    ds_read_b64_tr_b16 v[120:121], v14 offset:24576
    ds_read_b64_tr_b16 v[122:123], v14 offset:25088
    ds_read_b64_tr_b16 v[124:125], v14 offset:40960
    ds_read_b64_tr_b16 v[126:127], v14 offset:41472
    s_lshl_b32 s44, s6, 11
    s_add_u32 s57, s35, s44
    s_cmp_ge_u32 s6, 2
    s_nop 0
    s_cselect_b32 s58, 134217728, s57
    v_lshl_add_u32 v12, s6, 12, v2
    v_xor_b32 v13, 0x1000, v12
    buffer_load_dword v11, v6, s[16:19], s39 offen sc1
    s_bfe_u32 s55, s56, 196624
    v_lshl_add_u32 v4, s55, 11, v1
    buffer_load_dwordx4 v[160:163], v4, s[20:23], s30 offen offset:0
    buffer_load_dwordx4 v[164:167], v4, s[20:23], s31 offen offset:0
    buffer_load_dwordx4 v[168:171], v4, s[20:23], s32 offen offset:0
    buffer_load_dwordx4 v[172:175], v4, s[20:23], s30 offen offset:1024
    buffer_load_dwordx4 v[176:179], v4, s[20:23], s31 offen offset:1024
    buffer_load_dwordx4 v[180:183], v4, s[20:23], s32 offen offset:1024
    s_bfe_u32 s55, s56, 196628
    v_lshl_add_u32 v4, s55, 11, v1
    buffer_load_dwordx4 v[184:187], v4, s[20:23], s30 offen offset:0
    buffer_load_dwordx4 v[188:191], v4, s[20:23], s31 offen offset:0
    s_waitcnt vmcnt(8)
    v_cmp_gt_i32 vcc, 1, v11
    s_cbranch_vccnz LF_spin_6
LF_got_7:
    s_add_u32 m0, s44, 0
    s_nop 0
    buffer_load_dwordx4 v1, s[16:19], s57 offen offset:0 sc1 lds
    buffer_load_dwordx4 v1, s[16:19], s57 offen offset:1024 sc1 lds
    s_add_u32 s54, s57, 8192
    s_add_u32 m0, s44, 8192
    s_nop 0
    buffer_load_dwordx4 v1, s[16:19], s54 offen offset:0 sc1 lds
    buffer_load_dwordx4 v1, s[16:19], s54 offen offset:1024 sc1 lds
    s_add_u32 s54, s57, 16384
    s_add_u32 m0, s44, 16384
    s_nop 0
    buffer_load_dwordx4 v1, s[16:19], s54 offen offset:0 sc1 lds
    buffer_load_dwordx4 v1, s[16:19], s54 offen offset:1024 sc1 lds
    s_waitcnt vmcnt(4)
    s_barrier
    s_nop 0
    ds_read_b128 v[64:67], v3 offset:0
    ds_read_b128 v[68:71], v3 offset:2048
    ds_read_b128 v[72:75], v3 offset:4096
    ds_read_b128 v[76:79], v3 offset:6144
    s_add_u32 s54, s57, 24576
    s_add_u32 m0, s44, 24576
    s_nop 0
    buffer_load_dwordx4 v1, s[16:19], s54 offen offset:0 sc1 lds
    buffer_load_dwordx4 v1, s[16:19], s54 offen offset:1024 sc1 lds
    s_add_u32 s54, s57, 32768
    s_add_u32 m0, s44, 32768
    s_nop 0
    buffer_load_dwordx4 v1, s[16:19], s54 offen offset:0 sc1 lds
    buffer_load_dwordx4 v1, s[16:19], s54 offen offset:1024 sc1 lds
    s_waitcnt lgkmcnt(3)
    v_mfma_f32_32x32x16_bf16 v[48:63], v[16:19], v[64:67], 0
    s_add_u32 s54, s57, 40960
    s_add_u32 m0, s44, 40960
    s_nop 0
    buffer_load_dwordx4 v1, s[16:19], s54 offen offset:0 sc1 lds
    s_waitcnt lgkmcnt(2)
    v_mfma_f32_32x32x16_bf16 v[48:63], v[20:23], v[68:71], v[48:63]
    s_waitcnt vmcnt(7)
    s_barrier
    ds_read_b128 v[80:83], v3 offset:8192
    ds_read_b128 v[84:87], v3 offset:10240
    s_waitcnt lgkmcnt(3)
    v_mfma_f32_32x32x16_bf16 v[48:63], v[24:27], v[72:75], v[48:63]
    ds_read_b128 v[88:91], v3 offset:12288
    ds_read_b128 v[92:95], v3 offset:14336
    s_waitcnt lgkmcnt(4)
    v_mfma_f32_32x32x16_bf16 v[48:63], v[28:31], v[76:79], v[48:63]
    buffer_load_dwordx4 v1, s[16:19], s54 offen offset:1024 sc1 lds
    s_waitcnt lgkmcnt(3)
    v_mfma_f32_32x32x16_bf16 v[48:63], v[236:239], v[80:83], v[48:63]
    s_add_u32 s54, s57, 49152
    s_add_u32 m0, s44, 49152
    s_nop 0
    buffer_load_dwordx4 v1, s[16:19], s54 offen offset:0 sc1 lds
    s_waitcnt lgkmcnt(2)
    v_mfma_f32_32x32x16_bf16 v[48:63], v[240:243], v[84:87], v[48:63]
    s_waitcnt vmcnt(7)
    s_barrier
    ds_read_b128 v[64:67], v3 offset:16384
    ds_read_b128 v[68:71], v3 offset:18432
    s_waitcnt lgkmcnt(3)
    v_mfma_f32_32x32x16_bf16 v[48:63], v[244:247], v[88:91], v[48:63]
    ds_read_b128 v[72:75], v3 offset:20480
    ds_read_b128 v[76:79], v3 offset:22528
    s_waitcnt lgkmcnt(4)
    v_mfma_f32_32x32x16_bf16 v[48:63], v[248:251], v[92:95], v[48:63]
    buffer_load_dwordx4 v1, s[16:19], s54 offen offset:1024 sc1 lds
    s_waitcnt lgkmcnt(3)
    v_mfma_f32_32x32x16_bf16 v[48:63], v[96:99], v[64:67], v[48:63]
    s_add_u32 s54, s57, 57344
    s_add_u32 m0, s44, 57344
    s_nop 0
    buffer_load_dwordx4 v1, s[16:19], s54 offen offset:0 sc1 lds
    s_waitcnt lgkmcnt(2)
    v_mfma_f32_32x32x16_bf16 v[48:63], v[100:103], v[68:71], v[48:63]
    s_waitcnt vmcnt(7)
    s_barrier
    ds_read_b128 v[80:83], v3 offset:24576
    ds_read_b128 v[84:87], v3 offset:26624
    s_waitcnt lgkmcnt(3)
    v_mfma_f32_32x32x16_bf16 v[48:63], v[104:107], v[72:75], v[48:63]
    ds_read_b128 v[88:91], v3 offset:28672
    ds_read_b128 v[92:95], v3 offset:30720
    s_waitcnt lgkmcnt(4)
    v_mfma_f32_32x32x16_bf16 v[48:63], v[108:111], v[76:79], v[48:63]
    buffer_load_dwordx4 v1, s[16:19], s54 offen offset:1024 sc1 lds
    s_waitcnt lgkmcnt(3)
    v_mfma_f32_32x32x16_bf16 v[48:63], v[112:115], v[80:83], v[48:63]
    s_waitcnt lgkmcnt(2)
    v_mfma_f32_32x32x16_bf16 v[48:63], v[116:119], v[84:87], v[48:63]
    s_waitcnt vmcnt(6)
    s_barrier
    ds_read_b128 v[64:67], v3 offset:32768
    ds_read_b128 v[68:71], v3 offset:34816
    s_waitcnt lgkmcnt(3)
    v_mfma_f32_32x32x16_bf16 v[48:63], v[120:123], v[88:91], v[48:63]
    ds_read_b128 v[72:75], v3 offset:36864
    ds_read_b128 v[76:79], v3 offset:38912
    s_waitcnt lgkmcnt(4)
    v_mfma_f32_32x32x16_bf16 v[48:63], v[124:127], v[92:95], v[48:63]
    s_waitcnt lgkmcnt(3)
    v_mfma_f32_32x32x16_bf16 v[32:47], v[16:19], v[64:67], v[32:47]
    buffer_load_dwordx4 v[192:195], v4, s[20:23], s32 offen offset:0
    s_waitcnt lgkmcnt(2)
    v_mfma_f32_32x32x16_bf16 v[32:47], v[20:23], v[68:71], v[32:47]
    s_waitcnt vmcnt(5)
    s_barrier
    ds_read_b128 v[80:83], v3 offset:40960
    ds_read_b128 v[84:87], v3 offset:43008
    s_nop 2
    v_cvt_pk_bf16_f32 v48, v48, v49
    s_waitcnt lgkmcnt(3)
    v_mfma_f32_32x32x16_bf16 v[32:47], v[24:27], v[72:75], v[32:47]
    ds_read_b128 v[88:91], v3 offset:45056
    ds_read_b128 v[92:95], v3 offset:47104
    buffer_load_dwordx4 v[196:199], v4, s[20:23], s30 offen offset:1024
    s_waitcnt lgkmcnt(4)
    v_mfma_f32_32x32x16_bf16 v[32:47], v[28:31], v[76:79], v[32:47]
    v_cvt_pk_bf16_f32 v49, v50, v51
    v_cvt_pk_bf16_f32 v50, v52, v53
    v_cvt_pk_bf16_f32 v51, v54, v55
    v_cvt_pk_bf16_f32 v52, v56, v57
    v_cvt_pk_bf16_f32 v53, v58, v59
    v_cvt_pk_bf16_f32 v54, v60, v61
    s_waitcnt lgkmcnt(3)
    v_mfma_f32_32x32x16_bf16 v[32:47], v[236:239], v[80:83], v[32:47]
    buffer_load_dwordx4 v[200:203], v4, s[20:23], s31 offen offset:1024
    v_cvt_pk_bf16_f32 v55, v62, v63
    s_waitcnt lgkmcnt(2)
    v_mfma_f32_32x32x16_bf16 v[32:47], v[240:243], v[84:87], v[32:47]
    s_waitcnt vmcnt(5)
    s_barrier
    ds_read_b128 v[64:67], v3 offset:49152
    ds_read_b128 v[68:71], v3 offset:51200
    s_waitcnt lgkmcnt(3)
    v_mfma_f32_32x32x16_bf16 v[32:47], v[244:247], v[88:91], v[32:47]
    ds_read_b128 v[72:75], v3 offset:53248
    ds_read_b128 v[76:79], v3 offset:55296
    buffer_load_dwordx4 v[204:207], v4, s[20:23], s32 offen offset:1024
    s_waitcnt lgkmcnt(4)
    v_mfma_f32_32x32x16_bf16 v[32:47], v[248:251], v[92:95], v[32:47]
    ds_write_b128 v12, v[48:51] offset:0
    s_waitcnt lgkmcnt(4)
    v_mfma_f32_32x32x16_bf16 v[32:47], v[96:99], v[64:67], v[32:47]
    ds_write_b128 v12, v[52:55] offset:1024
    s_bfe_u32 s55, s56, 196632
    v_lshl_add_u32 v4, s55, 11, v1
    buffer_load_dwordx4 v[208:211], v4, s[20:23], s30 offen offset:0
    s_waitcnt lgkmcnt(4)
    v_mfma_f32_32x32x16_bf16 v[32:47], v[100:103], v[68:71], v[32:47]
    s_waitcnt lgkmcnt(0)
    s_waitcnt vmcnt(5)
    s_barrier
    ds_read_b128 v[80:83], v3 offset:57344
    ds_read_b128 v[84:87], v3 offset:59392
    v_mfma_f32_32x32x16_bf16 v[32:47], v[104:107], v[72:75], v[32:47]
    ds_read_b128 v[88:91], v3 offset:61440
    ds_read_b128 v[92:95], v3 offset:63488
    buffer_load_dwordx4 v[212:215], v4, s[20:23], s31 offen offset:0
    v_mfma_f32_32x32x16_bf16 v[32:47], v[108:111], v[76:79], v[32:47]
    ds_read_b128 v[56:59], v13 offset:0
    ds_read_b128 v[60:63], v13 offset:1024
    s_waitcnt lgkmcnt(5)
    v_mfma_f32_32x32x16_bf16 v[32:47], v[112:115], v[80:83], v[32:47]
    buffer_load_dwordx4 v[216:219], v4, s[20:23], s32 offen offset:0
    s_waitcnt lgkmcnt(0)
    v_lshlrev_b32 v48, 16, v56
    v_and_b32 v49, 0xffff0000, v56
    v_lshlrev_b32 v50, 16, v57
    v_mfma_f32_32x32x16_bf16 v[32:47], v[116:119], v[84:87], v[32:47]
    v_and_b32 v51, 0xffff0000, v57
    v_lshlrev_b32 v52, 16, v58
    v_and_b32 v53, 0xffff0000, v58
    v_lshlrev_b32 v54, 16, v59
    v_and_b32 v55, 0xffff0000, v59
    v_lshlrev_b32 v56, 16, v60
    v_mfma_f32_32x32x16_bf16 v[32:47], v[120:123], v[88:91], v[32:47]
    buffer_load_dwordx4 v[220:223], v4, s[20:23], s30 offen offset:1024
    v_and_b32 v57, 0xffff0000, v60
    v_lshlrev_b32 v58, 16, v61
    v_and_b32 v59, 0xffff0000, v61
    v_lshlrev_b32 v60, 16, v62
    v_mfma_f32_32x32x16_bf16 v[32:47], v[124:127], v[92:95], v[32:47]
    v_and_b32 v61, 0xffff0000, v62
    v_lshlrev_b32 v62, 16, v63
    v_and_b32 v63, 0xffff0000, v63
    s_nop 8
    v_pk_add_f32 v[16:17], v[32:33], v[48:49]
    v_pk_add_f32 v[18:19], v[34:35], v[50:51]
    v_pk_add_f32 v[20:21], v[36:37], v[52:53]
    v_pk_add_f32 v[22:23], v[38:39], v[54:55]
    v_cvt_pk_bf16_f32 v80, v16, v17
    v_cvt_pk_bf16_f32 v81, v18, v19
    v_cvt_pk_bf16_f32 v82, v20, v21
    v_cvt_pk_bf16_f32 v83, v22, v23
    buffer_store_dwordx4 v[80:83], v5, s[16:19], s47 offen offset:0 sc1
    v_pk_add_f32 v[24:25], v[40:41], v[56:57]
    v_pk_add_f32 v[26:27], v[42:43], v[58:59]
    v_pk_add_f32 v[28:29], v[44:45], v[60:61]
    v_pk_add_f32 v[30:31], v[46:47], v[62:63]
    v_cvt_pk_bf16_f32 v84, v24, v25
    v_cvt_pk_bf16_f32 v85, v26, v27
    v_cvt_pk_bf16_f32 v86, v28, v29
    v_cvt_pk_bf16_f32 v87, v30, v31
    buffer_store_dwordx4 v[84:87], v5, s[16:19], s47 offen offset:512 sc1
    v_pk_add_f32 v[12:13], v[16:17], v[18:19]
    v_pk_mul_f32 v[78:79], v[16:17], v[16:17]
    v_pk_fma_f32 v[78:79], v[18:19], v[18:19], v[78:79]
    v_pk_add_f32 v[12:13], v[12:13], v[20:21]
    v_pk_fma_f32 v[78:79], v[20:21], v[20:21], v[78:79]
    v_pk_add_f32 v[12:13], v[12:13], v[22:23]
    v_pk_fma_f32 v[78:79], v[22:23], v[22:23], v[78:79]
    v_pk_add_f32 v[12:13], v[12:13], v[24:25]
    v_pk_fma_f32 v[78:79], v[24:25], v[24:25], v[78:79]
    v_pk_add_f32 v[12:13], v[12:13], v[26:27]
    v_pk_fma_f32 v[78:79], v[26:27], v[26:27], v[78:79]
    v_pk_add_f32 v[12:13], v[12:13], v[28:29]
    v_pk_fma_f32 v[78:79], v[28:29], v[28:29], v[78:79]
    v_pk_add_f32 v[12:13], v[12:13], v[30:31]
    v_pk_fma_f32 v[78:79], v[30:31], v[30:31], v[78:79]
    v_add_f32 v12, v12, v13
    v_add_f32 v14, v78, v79
    s_nop 1
    v_permlane32_swap_b32 v12, v14
    v_add_f32 v14, v12, v14
    buffer_store_dword v14, v7, s[16:19], s36 offen
    ds_write_b128 v0, v[80:83] offset:0
    ds_write_b128 v0, v[84:87] offset:512
    s_lshl_b32 s44, s6, 14
    s_add_u32 s58, s34, s44
    v_mov_b32 v120, 0x3f803f80
    v_mov_b32 v121, 0x3f803f80
    v_mov_b32 v122, 0x3f803f80
    v_mov_b32 v123, 0x3f803f80
    s_waitcnt lgkmcnt(0)
    s_barrier
    ds_read_b128 v[88:91], v1 offset:0
    ds_read_b128 v[92:95], v1 offset:16384
    ds_read_b128 v[96:99], v1 offset:32768
    ds_read_b128 v[100:103], v1 offset:49152
    s_waitcnt lgkmcnt(3)
    v_mfma_f32_16x16x32_bf16 v[32:35], a[192:195], v[88:91], 0
    ds_read_b128 v[104:107], v1 offset:1024
    v_mfma_f32_16x16x32_bf16 v[48:51], a[196:199], v[88:91], 0
    v_mfma_f32_16x16x32_bf16 v[64:67], a[200:203], v[88:91], 0
    s_waitcnt lgkmcnt(3)
    v_mfma_f32_16x16x32_bf16 v[108:111], a[192:195], v[120:123], 0
    v_mfma_f32_16x16x32_bf16 v[36:39], a[192:195], v[92:95], 0
    ds_read_b128 v[88:91], v1 offset:17408
    v_mfma_f32_16x16x32_bf16 v[52:55], a[196:199], v[92:95], 0
    v_mfma_f32_16x16x32_bf16 v[108:111], a[216:219], v[120:123], v[108:111]
    v_mfma_f32_16x16x32_bf16 v[112:115], a[220:223], v[120:123], 0
    v_mfma_f32_16x16x32_bf16 v[116:119], a[224:227], v[120:123], 0
    v_mfma_f32_16x16x32_bf16 v[108:111], a[228:231], v[120:123], v[108:111]
    v_mfma_f32_16x16x32_bf16 v[112:115], a[232:235], v[120:123], v[112:115]
    v_mfma_f32_16x16x32_bf16 v[116:119], a[236:239], v[120:123], v[116:119]
    v_mfma_f32_16x16x32_bf16 v[108:111], a[240:243], v[120:123], v[108:111]
    v_mfma_f32_16x16x32_bf16 v[112:115], a[244:247], v[120:123], v[112:115]
    v_mfma_f32_16x16x32_bf16 v[116:119], a[248:251], v[120:123], v[116:119]
    v_mfma_f32_16x16x32_bf16 v[108:111], a[252:255], v[120:123], v[108:111]
    v_mfma_f32_16x16x32_bf16 v[112:115], v[128:131], v[120:123], v[112:115]
    v_mfma_f32_16x16x32_bf16 v[116:119], v[132:135], v[120:123], v[116:119]
    v_mfma_f32_16x16x32_bf16 v[108:111], v[136:139], v[120:123], v[108:111]
    v_mfma_f32_16x16x32_bf16 v[112:115], v[140:143], v[120:123], v[112:115]
    v_mfma_f32_16x16x32_bf16 v[116:119], v[144:147], v[120:123], v[116:119]
    v_mfma_f32_16x16x32_bf16 v[108:111], v[148:151], v[120:123], v[108:111]
    v_mfma_f32_16x16x32_bf16 v[112:115], v[152:155], v[120:123], v[112:115]
    v_mfma_f32_16x16x32_bf16 v[116:119], v[156:159], v[120:123], v[116:119]
    v_mov_b32 v11, 2
    s_mov_b64 exec, 1
    s_waitcnt vmcnt(0)
    buffer_store_dword v11, off, s[16:19], s40
    s_mov_b64 exec, -1
    v_mfma_f32_16x16x32_bf16 v[68:71], a[200:203], v[92:95], 0
    s_waitcnt lgkmcnt(3)
    v_mfma_f32_16x16x32_bf16 v[112:115], a[196:199], v[120:123], v[112:115]
    v_mfma_f32_16x16x32_bf16 v[40:43], a[192:195], v[96:99], 0
    ds_read_b128 v[92:95], v1 offset:33792
    v_mfma_f32_16x16x32_bf16 v[56:59], a[196:199], v[96:99], 0
    v_mfma_f32_16x16x32_bf16 v[72:75], a[200:203], v[96:99], 0
    s_waitcnt lgkmcnt(3)
    v_mfma_f32_16x16x32_bf16 v[116:119], a[200:203], v[120:123], v[116:119]
    v_mfma_f32_16x16x32_bf16 v[44:47], a[192:195], v[100:103], 0
    ds_read_b128 v[96:99], v1 offset:50176
    v_mfma_f32_16x16x32_bf16 v[60:63], a[196:199], v[100:103], 0
    v_mfma_f32_16x16x32_bf16 v[76:79], a[200:203], v[100:103], 0
    s_waitcnt lgkmcnt(3)
    v_mfma_f32_16x16x32_bf16 v[32:35], a[204:207], v[104:107], v[32:35]
    v_mfma_f32_16x16x32_bf16 v[48:51], a[208:211], v[104:107], v[48:51]
    v_mfma_f32_16x16x32_bf16 v[64:67], a[212:215], v[104:107], v[64:67]
    s_waitcnt lgkmcnt(2)
    v_mfma_f32_16x16x32_bf16 v[108:111], a[204:207], v[120:123], v[108:111]
    v_mfma_f32_16x16x32_bf16 v[36:39], a[204:207], v[88:91], v[36:39]
    v_mfma_f32_16x16x32_bf16 v[52:55], a[208:211], v[88:91], v[52:55]
    v_mfma_f32_16x16x32_bf16 v[68:71], a[212:215], v[88:91], v[68:71]
    s_waitcnt lgkmcnt(1)
    v_mfma_f32_16x16x32_bf16 v[112:115], a[208:211], v[120:123], v[112:115]
    v_mfma_f32_16x16x32_bf16 v[40:43], a[204:207], v[92:95], v[40:43]
    v_mfma_f32_16x16x32_bf16 v[56:59], a[208:211], v[92:95], v[56:59]
    v_mfma_f32_16x16x32_bf16 v[72:75], a[212:215], v[92:95], v[72:75]
    s_waitcnt lgkmcnt(0)
    v_mfma_f32_16x16x32_bf16 v[116:119], a[212:215], v[120:123], v[116:119]
    v_mfma_f32_16x16x32_bf16 v[44:47], a[204:207], v[96:99], v[44:47]
    v_mfma_f32_16x16x32_bf16 v[60:63], a[208:211], v[96:99], v[60:63]
    v_mfma_f32_16x16x32_bf16 v[76:79], a[212:215], v[96:99], v[76:79]
    s_bfe_u32 s3, s56, 196612
    s_lshl_b32 s3, s3, 11
    s_add_u32 m0, s44, 2048
    s_add_u32 s57, s3, s58
LF_poll_8:
    buffer_load_dword v11, v6, s[16:19], s39 offen sc1
    s_sub_u32 s46, s46, 1
    s_cbranch_scc1 L_end
    s_waitcnt vmcnt(0)
    v_cmp_gt_i32 vcc, 2, v11
    s_cbranch_vccnz LF_poll_8
    buffer_load_dwordx4 v1, s[16:19], s57 offen offset:0 sc1 lds
    buffer_load_dwordx4 v1, s[16:19], s57 offen offset:1024 sc1 lds
    s_bfe_u32 s3, s56, 196616
    s_lshl_b32 s3, s3, 11
    s_add_u32 m0, s44, 4096
    s_add_u32 s57, s3, s58
    buffer_load_dwordx4 v1, s[16:19], s57 offen offset:0 sc1 lds
    buffer_load_dwordx4 v1, s[16:19], s57 offen offset:1024 sc1 lds
    s_bfe_u32 s3, s56, 196620
    s_lshl_b32 s3, s3, 11
    s_add_u32 m0, s44, 6144
    s_add_u32 s57, s3, s58
    buffer_load_dwordx4 v1, s[16:19], s57 offen offset:0 sc1 lds
    buffer_load_dwordx4 v1, s[16:19], s57 offen offset:1024 sc1 lds
    s_waitcnt vmcnt(5)
    s_barrier
    ds_read_b128 v[88:91], v1 offset:2048
    ds_read_b128 v[92:95], v1 offset:18432
    ds_read_b128 v[96:99], v1 offset:34816
    ds_read_b128 v[100:103], v1 offset:51200
    s_waitcnt lgkmcnt(3)
    v_mfma_f32_16x16x32_bf16 v[32:35], a[216:219], v[88:91], v[32:35]
    s_waitcnt vmcnt(4)
    s_barrier
    ds_read_b128 v[104:107], v1 offset:3072
    v_mfma_f32_16x16x32_bf16 v[48:51], a[220:223], v[88:91], v[48:51]
    s_bfe_u32 s3, s56, 196624
    s_lshl_b32 s3, s3, 11
    s_add_u32 m0, s44, 8192
    s_add_u32 s57, s3, s58
    buffer_load_dwordx4 v1, s[16:19], s57 offen offset:0 sc1 lds
    v_mfma_f32_16x16x32_bf16 v[64:67], a[224:227], v[88:91], v[64:67]
    s_waitcnt lgkmcnt(3)
    v_mfma_f32_16x16x32_bf16 v[36:39], a[216:219], v[92:95], v[36:39]
    ds_read_b128 v[88:91], v1 offset:19456
    v_mfma_f32_16x16x32_bf16 v[52:55], a[220:223], v[92:95], v[52:55]
    buffer_load_dwordx4 v1, s[16:19], s57 offen offset:1024 sc1 lds
    v_mfma_f32_16x16x32_bf16 v[68:71], a[224:227], v[92:95], v[68:71]
    s_waitcnt lgkmcnt(3)
    v_mfma_f32_16x16x32_bf16 v[40:43], a[216:219], v[96:99], v[40:43]
    ds_read_b128 v[92:95], v1 offset:35840
    v_mfma_f32_16x16x32_bf16 v[56:59], a[220:223], v[96:99], v[56:59]
    s_bfe_u32 s3, s56, 196628
    s_lshl_b32 s3, s3, 11
    s_add_u32 m0, s44, 10240
    s_add_u32 s57, s3, s58
    buffer_load_dwordx4 v1, s[16:19], s57 offen offset:0 sc1 lds
    v_mfma_f32_16x16x32_bf16 v[72:75], a[224:227], v[96:99], v[72:75]
    s_waitcnt lgkmcnt(3)
    v_mfma_f32_16x16x32_bf16 v[44:47], a[216:219], v[100:103], v[44:47]
    ds_read_b128 v[96:99], v1 offset:52224
    v_mfma_f32_16x16x32_bf16 v[60:63], a[220:223], v[100:103], v[60:63]
    buffer_load_dwordx4 v1, s[16:19], s57 offen offset:1024 sc1 lds
    v_mfma_f32_16x16x32_bf16 v[76:79], a[224:227], v[100:103], v[76:79]
    s_waitcnt lgkmcnt(3)
    v_mfma_f32_16x16x32_bf16 v[32:35], a[228:231], v[104:107], v[32:35]
    s_waitcnt vmcnt(6)
    s_barrier
    ds_read_b128 v[100:103], v1 offset:4096
    v_mfma_f32_16x16x32_bf16 v[48:51], a[232:235], v[104:107], v[48:51]
    s_bfe_u32 s3, s56, 196632
    s_lshl_b32 s3, s3, 11
    s_add_u32 m0, s44, 12288
    s_add_u32 s57, s3, s58
    buffer_load_dwordx4 v1, s[16:19], s57 offen offset:0 sc1 lds
    v_mfma_f32_16x16x32_bf16 v[64:67], a[236:239], v[104:107], v[64:67]
    s_waitcnt lgkmcnt(3)
    v_mfma_f32_16x16x32_bf16 v[36:39], a[228:231], v[88:91], v[36:39]
    ds_read_b128 v[104:107], v1 offset:20480
    v_mfma_f32_16x16x32_bf16 v[52:55], a[232:235], v[88:91], v[52:55]
    buffer_load_dwordx4 v1, s[16:19], s57 offen offset:1024 sc1 lds
    v_mfma_f32_16x16x32_bf16 v[68:71], a[236:239], v[88:91], v[68:71]
    s_waitcnt lgkmcnt(3)
    v_mfma_f32_16x16x32_bf16 v[40:43], a[228:231], v[92:95], v[40:43]
    ds_read_b128 v[88:91], v1 offset:36864
    v_mfma_f32_16x16x32_bf16 v[56:59], a[232:235], v[92:95], v[56:59]
    s_bfe_u32 s3, s56, 196636
    s_lshl_b32 s3, s3, 11
    s_add_u32 m0, s44, 14336
    s_add_u32 s57, s3, s58
    buffer_load_dwordx4 v1, s[16:19], s57 offen offset:0 sc1 lds
    v_mfma_f32_16x16x32_bf16 v[72:75], a[236:239], v[92:95], v[72:75]
    s_waitcnt lgkmcnt(3)
    v_mfma_f32_16x16x32_bf16 v[44:47], a[228:231], v[96:99], v[44:47]
    ds_read_b128 v[92:95], v1 offset:53248
    v_mfma_f32_16x16x32_bf16 v[60:63], a[232:235], v[96:99], v[60:63]
    buffer_load_dwordx4 v1, s[16:19], s57 offen offset:1024 sc1 lds
    v_mfma_f32_16x16x32_bf16 v[76:79], a[236:239], v[96:99], v[76:79]
    s_waitcnt lgkmcnt(3)
    v_mfma_f32_16x16x32_bf16 v[32:35], a[240:243], v[100:103], v[32:35]
    ds_read_b128 v[96:99], v1 offset:5120
    v_mfma_f32_16x16x32_bf16 v[48:51], a[244:247], v[100:103], v[48:51]
    buffer_load_dwordx4 v[80:83], v8, s[16:19], s37 offen offset:0 sc1
L_pad3:
    s_cbranch_execz L_pad7
    v_mfma_f32_16x16x32_bf16 v[64:67], a[248:251], v[100:103], v[64:67]
    s_waitcnt lgkmcnt(3)
    v_mfma_f32_16x16x32_bf16 v[36:39], a[240:243], v[104:107], v[36:39]
    ds_read_b128 v[100:103], v1 offset:21504
    v_mfma_f32_16x16x32_bf16 v[52:55], a[244:247], v[104:107], v[52:55]
    buffer_load_dwordx4 v[84:87], v8, s[16:19], s37 offen offset:1024 sc1
    v_mfma_f32_16x16x32_bf16 v[68:71], a[248:251], v[104:107], v[68:71]
    s_waitcnt lgkmcnt(3)
    v_mfma_f32_16x16x32_bf16 v[40:43], a[240:243], v[88:91], v[40:43]
    ds_read_b128 v[104:107], v1 offset:37888
    v_mfma_f32_16x16x32_bf16 v[56:59], a[244:247], v[88:91], v[56:59]
    v_mfma_f32_16x16x32_bf16 v[72:75], a[248:251], v[88:91], v[72:75]
    s_waitcnt lgkmcnt(3)
    s_lshl2_add_u32 s3, s5, s6
    v_lshlrev_b32 v11, 3, v1
    s_mulk_i32 s3, 3456
    s_add_u32 s3, s3, s35
    s_add_u32 s3, s3, 0x10000
    s_mov_b64 exec, 0x7ffffff
    buffer_load_dword v14, v11, s[16:19], s3 offen sc1
    s_mov_b64 exec, -1
    v_mfma_f32_16x16x32_bf16 v[44:47], a[240:243], v[92:95], v[44:47]
    ds_read_b128 v[88:91], v1 offset:54272
    v_mfma_f32_16x16x32_bf16 v[60:63], a[244:247], v[92:95], v[60:63]
    buffer_load_dwordx4 v[224:227], v4, s[20:23], s31 offen offset:1024
    v_mfma_f32_16x16x32_bf16 v[76:79], a[248:251], v[92:95], v[76:79]
    s_waitcnt lgkmcnt(3)
    v_mfma_f32_16x16x32_bf16 v[32:35], a[252:255], v[96:99], v[32:35]
    s_waitcnt vmcnt(12)
    s_barrier
    ds_read_b128 v[92:95], v1 offset:6144
    v_mfma_f32_16x16x32_bf16 v[48:51], v[128:131], v[96:99], v[48:51]
    buffer_load_dwordx4 v[228:231], v4, s[20:23], s32 offen offset:1024
    v_mfma_f32_16x16x32_bf16 v[64:67], v[132:135], v[96:99], v[64:67]
    s_waitcnt lgkmcnt(3)
    v_mfma_f32_16x16x32_bf16 v[36:39], a[252:255], v[100:103], v[36:39]
    ds_read_b128 v[96:99], v1 offset:22528
    v_mfma_f32_16x16x32_bf16 v[52:55], v[128:131], v[100:103], v[52:55]
    v_mfma_f32_16x16x32_bf16 v[68:71], v[132:135], v[100:103], v[68:71]
    s_waitcnt lgkmcnt(3)
    v_mfma_f32_16x16x32_bf16 v[40:43], a[252:255], v[104:107], v[40:43]
    ds_read_b128 v[100:103], v1 offset:38912
    v_mfma_f32_16x16x32_bf16 v[56:59], v[128:131], v[104:107], v[56:59]
    s_bfe_u32 s55, s56, 196636
    v_lshl_add_u32 v4, s55, 11, v1
    buffer_load_dwordx4 v[232:235], v4, s[20:23], s30 offen offset:0
    v_mfma_f32_16x16x32_bf16 v[72:75], v[132:135], v[104:107], v[72:75]
    s_waitcnt lgkmcnt(3)
    v_mfma_f32_16x16x32_bf16 v[44:47], a[252:255], v[88:91], v[44:47]
    ds_read_b128 v[104:107], v1 offset:55296
    v_mfma_f32_16x16x32_bf16 v[60:63], v[128:131], v[88:91], v[60:63]
    buffer_load_dwordx4 v[236:239], v4, s[20:23], s31 offen offset:0
    v_mfma_f32_16x16x32_bf16 v[76:79], v[132:135], v[88:91], v[76:79]
    s_waitcnt lgkmcnt(3)
    v_mfma_f32_16x16x32_bf16 v[32:35], v[136:139], v[92:95], v[32:35]
    ds_read_b128 v[88:91], v1 offset:7168
    v_mfma_f32_16x16x32_bf16 v[48:51], v[140:143], v[92:95], v[48:51]
    v_mfma_f32_16x16x32_bf16 v[64:67], v[144:147], v[92:95], v[64:67]
    s_waitcnt lgkmcnt(3)
    v_mfma_f32_16x16x32_bf16 v[36:39], v[136:139], v[96:99], v[36:39]
    ds_read_b128 v[92:95], v1 offset:23552
    v_mfma_f32_16x16x32_bf16 v[52:55], v[140:143], v[96:99], v[52:55]
    buffer_load_dwordx4 v[240:243], v4, s[20:23], s32 offen offset:0
    v_mfma_f32_16x16x32_bf16 v[68:71], v[144:147], v[96:99], v[68:71]
    s_waitcnt lgkmcnt(3)
    v_mfma_f32_16x16x32_bf16 v[40:43], v[136:139], v[100:103], v[40:43]
    ds_read_b128 v[96:99], v1 offset:39936
    v_mfma_f32_16x16x32_bf16 v[56:59], v[140:143], v[100:103], v[56:59]
    buffer_load_dwordx4 v[244:247], v4, s[20:23], s30 offen offset:1024
    v_mfma_f32_16x16x32_bf16 v[72:75], v[144:147], v[100:103], v[72:75]
    s_waitcnt lgkmcnt(3)
    v_mfma_f32_16x16x32_bf16 v[44:47], v[136:139], v[104:107], v[44:47]
    ds_read_b128 v[100:103], v1 offset:56320
    v_mfma_f32_16x16x32_bf16 v[60:63], v[140:143], v[104:107], v[60:63]
    v_mfma_f32_16x16x32_bf16 v[76:79], v[144:147], v[104:107], v[76:79]
    s_waitcnt lgkmcnt(3)
    v_mfma_f32_16x16x32_bf16 v[32:35], v[148:151], v[88:91], v[32:35]
    s_waitcnt vmcnt(13)
    s_barrier
    ds_read_b128 v[104:107], v1 offset:8192
    v_mfma_f32_16x16x32_bf16 v[48:51], v[152:155], v[88:91], v[48:51]
    buffer_load_dwordx4 v[248:251], v4, s[20:23], s31 offen offset:1024
    v_mfma_f32_16x16x32_bf16 v[64:67], v[156:159], v[88:91], v[64:67]
    s_waitcnt lgkmcnt(3)
    v_mfma_f32_16x16x32_bf16 v[36:39], v[148:151], v[92:95], v[36:39]
    ds_read_b128 v[88:91], v1 offset:24576
    v_mfma_f32_16x16x32_bf16 v[52:55], v[152:155], v[92:95], v[52:55]
    buffer_load_dwordx4 v[252:255], v4, s[20:23], s32 offen offset:1024
    v_mfma_f32_16x16x32_bf16 v[68:71], v[156:159], v[92:95], v[68:71]
    s_waitcnt lgkmcnt(3)
    v_mfma_f32_16x16x32_bf16 v[40:43], v[148:151], v[96:99], v[40:43]
    ds_read_b128 v[92:95], v1 offset:40960
    v_mfma_f32_16x16x32_bf16 v[56:59], v[152:155], v[96:99], v[56:59]
    v_mfma_f32_16x16x32_bf16 v[72:75], v[156:159], v[96:99], v[72:75]
    s_waitcnt lgkmcnt(3)
    v_mfma_f32_16x16x32_bf16 v[44:47], v[148:151], v[100:103], v[44:47]
    ds_read_b128 v[96:99], v1 offset:57344
    v_mfma_f32_16x16x32_bf16 v[60:63], v[152:155], v[100:103], v[60:63]
    buffer_load_dwordx4 a[192:195], v1, s[16:19], s33 offen offset:0
    v_mfma_f32_16x16x32_bf16 v[76:79], v[156:159], v[100:103], v[76:79]
    s_waitcnt lgkmcnt(3)
    v_mfma_f32_16x16x32_bf16 v[32:35], v[160:163], v[104:107], v[32:35]
    ds_read_b128 v[100:103], v1 offset:9216
    v_mfma_f32_16x16x32_bf16 v[48:51], v[164:167], v[104:107], v[48:51]
    buffer_load_dwordx4 a[196:199], v1, s[16:19], s33 offen offset:1024
    v_mfma_f32_16x16x32_bf16 v[64:67], v[168:171], v[104:107], v[64:67]
    s_waitcnt lgkmcnt(3)
    v_mfma_f32_16x16x32_bf16 v[108:111], v[160:163], v[120:123], v[108:111]
    v_mfma_f32_16x16x32_bf16 v[36:39], v[160:163], v[88:91], v[36:39]
    ds_read_b128 v[104:107], v1 offset:25600
    v_mfma_f32_16x16x32_bf16 v[52:55], v[164:167], v[88:91], v[52:55]
    v_mfma_f32_16x16x32_bf16 v[68:71], v[168:171], v[88:91], v[68:71]
    s_waitcnt lgkmcnt(3)
    v_mfma_f32_16x16x32_bf16 v[112:115], v[164:167], v[120:123], v[112:115]
    v_mfma_f32_16x16x32_bf16 v[40:43], v[160:163], v[92:95], v[40:43]
    ds_read_b128 v[88:91], v1 offset:41984
    v_mfma_f32_16x16x32_bf16 v[56:59], v[164:167], v[92:95], v[56:59]
    buffer_load_dwordx4 a[200:203], v1, s[16:19], s33 offen offset:2048
    v_mfma_f32_16x16x32_bf16 v[72:75], v[168:171], v[92:95], v[72:75]
    s_waitcnt lgkmcnt(3)
    s_waitcnt vmcnt(12)
    v_add_f32 v80, v80, v82
    v_mfma_f32_16x16x32_bf16 v[116:119], v[168:171], v[120:123], v[116:119]
    v_add_f32 v81, v81, v83
    v_add_f32 v84, v84, v86
    v_mfma_f32_16x16x32_bf16 v[44:47], v[160:163], v[96:99], v[44:47]
    ds_read_b128 v[92:95], v1 offset:58368
    v_add_f32 v85, v85, v87
    v_mfma_f32_16x16x32_bf16 v[60:63], v[164:167], v[96:99], v[60:63]
    buffer_load_dwordx4 a[204:207], v1, s[16:19], s33 offen offset:3072
    v_mfma_f32_16x16x32_bf16 v[76:79], v[168:171], v[96:99], v[76:79]
    s_waitcnt lgkmcnt(3)
    v_add_f32 v80, v80, v84
    v_add_f32 v81, v81, v85
    v_mfma_f32_16x16x32_bf16 v[32:35], v[172:175], v[100:103], v[32:35]
    ds_read_b128 v[96:99], v1 offset:10240
    v_lshl_add_u32 v82, s6, 7, v9
    v_mfma_f32_16x16x32_bf16 v[48:51], v[176:179], v[100:103], v[48:51]
    v_lshrrev_b32 v83, 1, v82
    v_mfma_f32_16x16x32_bf16 v[64:67], v[180:183], v[100:103], v[64:67]
    s_waitcnt lgkmcnt(3)
    v_permlane32_swap_b32 v80, v81
    v_mfma_f32_16x16x32_bf16 v[108:111], v[172:175], v[120:123], v[108:111]
    v_add_f32 v84, v80, v81
    v_add_f32 v85, v80, v81
    v_mfma_f32_16x16x32_bf16 v[36:39], v[172:175], v[104:107], v[36:39]
    ds_read_b128 v[100:103], v1 offset:26624
    v_add_u32 v83, 80896, v83
    v_mfma_f32_16x16x32_bf16 v[52:55], v[176:179], v[104:107], v[52:55]
    s_add_u32 s55, s33, 4096
    buffer_load_dwordx4 a[208:211], v1, s[16:19], s55 offen offset:0
    v_mfma_f32_16x16x32_bf16 v[68:71], v[180:183], v[104:107], v[68:71]
    s_waitcnt lgkmcnt(3)
    v_permlane16_swap_b32 v84, v85
    v_mfma_f32_16x16x32_bf16 v[112:115], v[176:179], v[120:123], v[112:115]
    v_add_f32 v80, v84, v85
    v_add_f32 v81, v84, v85
    v_mfma_f32_16x16x32_bf16 v[40:43], v[172:175], v[88:91], v[40:43]
    ds_read_b128 v[104:107], v1 offset:11264
    v_mfma_f32_16x16x32_bf16 v[56:59], v[176:179], v[88:91], v[56:59]
    buffer_load_dwordx4 a[212:215], v1, s[16:19], s55 offen offset:1024
    v_mfma_f32_16x16x32_bf16 v[72:75], v[180:183], v[88:91], v[72:75]
    s_waitcnt lgkmcnt(3)
    v_permlane32_swap_b32 v80, v81
    v_mfma_f32_16x16x32_bf16 v[116:119], v[180:183], v[120:123], v[116:119]
    v_mul_f32 v80, 0xbb000000, v80
    v_mul_f32 v81, 0x3b000000, v81
    v_mfma_f32_16x16x32_bf16 v[44:47], v[172:175], v[92:95], v[44:47]
    ds_read_b128 v[88:91], v1 offset:27648
    v_fma_f32 v81, -v80, v80, v81
    v_mfma_f32_16x16x32_bf16 v[60:63], v[176:179], v[92:95], v[60:63]
    v_max_f32 v81, 0, v81
    v_add_f32 v81, 0x3727c5ac, v81
    v_mfma_f32_16x16x32_bf16 v[76:79], v[180:183], v[92:95], v[76:79]
    s_waitcnt lgkmcnt(3)
    v_rsq_f32 v81, v81
    v_mfma_f32_16x16x32_bf16 v[32:35], v[184:187], v[96:99], v[32:35]
    s_barrier
    ds_read_b128 v[92:95], v1 offset:12288
    v_mfma_f32_16x16x32_bf16 v[48:51], v[188:191], v[96:99], v[48:51]
    buffer_load_dwordx4 a[216:219], v1, s[16:19], s55 offen offset:2048
    v_mfma_f32_16x16x32_bf16 v[64:67], v[192:195], v[96:99], v[64:67]
    s_waitcnt lgkmcnt(3)
    ds_write_b64 v82, v[80:81]
    v_mfma_f32_16x16x32_bf16 v[108:111], v[184:187], v[120:123], v[108:111]
    ds_write2_b32 v83, v80, v81 offset0:0 offset1:128
    v_mfma_f32_16x16x32_bf16 v[112:115], v[188:191], v[120:123], v[112:115]
    s_waitcnt lgkmcnt(0)
    s_barrier
    ds_read_b64 v[80:81], v9 offset:0
    ds_read_b64 v[82:83], v9 offset:128
    ds_read_b64 v[84:85], v9 offset:256
    ds_read_b64 v[86:87], v9 offset:384
    v_mfma_f32_16x16x32_bf16 v[36:39], v[184:187], v[100:103], v[36:39]
    ds_read_b128 v[96:99], v1 offset:28672
    v_mfma_f32_16x16x32_bf16 v[52:55], v[188:191], v[100:103], v[52:55]
    buffer_load_dwordx4 a[220:223], v1, s[16:19], s55 offen offset:3072
    v_mfma_f32_16x16x32_bf16 v[68:71], v[192:195], v[100:103], v[68:71]
    v_mfma_f32_16x16x32_bf16 v[116:119], v[192:195], v[120:123], v[116:119]
    v_mfma_f32_16x16x32_bf16 v[32:35], v[196:199], v[104:107], v[32:35]
    ds_read_b128 v[100:103], v1 offset:13312
    v_mfma_f32_16x16x32_bf16 v[48:51], v[200:203], v[104:107], v[48:51]
    v_mfma_f32_16x16x32_bf16 v[64:67], v[204:207], v[104:107], v[64:67]
    v_mfma_f32_16x16x32_bf16 v[108:111], v[196:199], v[120:123], v[108:111]
    v_mfma_f32_16x16x32_bf16 v[112:115], v[200:203], v[120:123], v[112:115]
    v_mfma_f32_16x16x32_bf16 v[36:39], v[196:199], v[88:91], v[36:39]
    ds_read_b128 v[104:107], v1 offset:29696
    v_mfma_f32_16x16x32_bf16 v[52:55], v[200:203], v[88:91], v[52:55]
    s_add_u32 s55, s33, 8192
    buffer_load_dwordx4 a[224:227], v1, s[16:19], s55 offen offset:0
    v_mfma_f32_16x16x32_bf16 v[68:71], v[204:207], v[88:91], v[68:71]
    v_mfma_f32_16x16x32_bf16 v[116:119], v[204:207], v[120:123], v[116:119]
    v_mfma_f32_16x16x32_bf16 v[32:35], v[208:211], v[92:95], v[32:35]
    ds_read_b128 v[88:91], v1 offset:14336
    v_mfma_f32_16x16x32_bf16 v[48:51], v[212:215], v[92:95], v[48:51]
    buffer_load_dwordx4 a[228:231], v1, s[16:19], s55 offen offset:1024
    v_mfma_f32_16x16x32_bf16 v[64:67], v[216:219], v[92:95], v[64:67]
    s_waitcnt lgkmcnt(3)
    v_mfma_f32_16x16x32_bf16 v[108:111], v[208:211], v[120:123], v[108:111]
    v_mfma_f32_16x16x32_bf16 v[112:115], v[212:215], v[120:123], v[112:115]
    v_mfma_f32_16x16x32_bf16 v[36:39], v[208:211], v[96:99], v[36:39]
    ds_read_b128 v[92:95], v1 offset:30720
    v_mfma_f32_16x16x32_bf16 v[52:55], v[212:215], v[96:99], v[52:55]
    v_mfma_f32_16x16x32_bf16 v[68:71], v[216:219], v[96:99], v[68:71]
    s_waitcnt lgkmcnt(3)
    v_mfma_f32_16x16x32_bf16 v[116:119], v[216:219], v[120:123], v[116:119]
    v_mfma_f32_16x16x32_bf16 v[32:35], v[220:223], v[100:103], v[32:35]
    ds_read_b128 v[96:99], v1 offset:15360
    s_waitcnt vmcnt(17)
    v_mfma_f32_16x16x32_bf16 v[48:51], v[224:227], v[100:103], v[48:51]
    buffer_load_dwordx4 a[232:235], v1, s[16:19], s55 offen offset:2048
    s_waitcnt vmcnt(17)
    v_mfma_f32_16x16x32_bf16 v[64:67], v[228:231], v[100:103], v[64:67]
    s_waitcnt lgkmcnt(3)
    v_mfma_f32_16x16x32_bf16 v[108:111], v[220:223], v[120:123], v[108:111]
    v_mfma_f32_16x16x32_bf16 v[112:115], v[224:227], v[120:123], v[112:115]
    v_mfma_f32_16x16x32_bf16 v[36:39], v[220:223], v[104:107], v[36:39]
    ds_read_b128 v[100:103], v1 offset:31744
    v_mfma_f32_16x16x32_bf16 v[52:55], v[224:227], v[104:107], v[52:55]
    buffer_load_dwordx4 a[236:239], v1, s[16:19], s55 offen offset:3072
    v_mfma_f32_16x16x32_bf16 v[68:71], v[228:231], v[104:107], v[68:71]
    s_waitcnt lgkmcnt(3)
    v_mfma_f32_16x16x32_bf16 v[116:119], v[228:231], v[120:123], v[116:119]
    s_waitcnt vmcnt(17)
    v_mfma_f32_16x16x32_bf16 v[32:35], v[232:235], v[88:91], v[32:35]
    ds_read_b128 v[104:107], v1 offset:43008
    s_waitcnt vmcnt(16)
    v_mfma_f32_16x16x32_bf16 v[48:51], v[236:239], v[88:91], v[48:51]
    s_waitcnt vmcnt(15)
    v_mfma_f32_16x16x32_bf16 v[64:67], v[240:243], v[88:91], v[64:67]
    s_waitcnt lgkmcnt(3)
    v_mfma_f32_16x16x32_bf16 v[108:111], v[232:235], v[120:123], v[108:111]
    v_mfma_f32_16x16x32_bf16 v[112:115], v[236:239], v[120:123], v[112:115]
    v_mfma_f32_16x16x32_bf16 v[36:39], v[232:235], v[92:95], v[36:39]
    ds_read_b128 v[88:91], v1 offset:59392
    v_mfma_f32_16x16x32_bf16 v[52:55], v[236:239], v[92:95], v[52:55]
    s_add_u32 s55, s33, 12288
    buffer_load_dwordx4 a[240:243], v1, s[16:19], s55 offen offset:0
    v_mfma_f32_16x16x32_bf16 v[68:71], v[240:243], v[92:95], v[68:71]
    s_waitcnt lgkmcnt(3)
    v_mfma_f32_16x16x32_bf16 v[116:119], v[240:243], v[120:123], v[116:119]
    s_waitcnt vmcnt(15)
    v_mfma_f32_16x16x32_bf16 v[32:35], v[244:247], v[96:99], v[32:35]
    ds_read_b128 v[92:95], v1 offset:44032
    s_waitcnt vmcnt(14)
    v_mfma_f32_16x16x32_bf16 v[48:51], v[248:251], v[96:99], v[48:51]
    buffer_load_dwordx4 a[244:247], v1, s[16:19], s55 offen offset:1024
    s_waitcnt vmcnt(14)
    v_mfma_f32_16x16x32_bf16 v[64:67], v[252:255], v[96:99], v[64:67]
    s_waitcnt lgkmcnt(3)
    v_mfma_f32_16x16x32_bf16 v[108:111], v[244:247], v[120:123], v[108:111]
    v_mfma_f32_16x16x32_bf16 v[112:115], v[248:251], v[120:123], v[112:115]
    v_mfma_f32_16x16x32_bf16 v[36:39], v[244:247], v[100:103], v[36:39]
    ds_read_b128 v[96:99], v1 offset:60416
    v_mfma_f32_16x16x32_bf16 v[52:55], v[248:251], v[100:103], v[52:55]
    v_mfma_f32_16x16x32_bf16 v[68:71], v[252:255], v[100:103], v[68:71]
    s_waitcnt lgkmcnt(3)
    v_mfma_f32_16x16x32_bf16 v[116:119], v[252:255], v[120:123], v[116:119]
    v_mfma_f32_16x16x32_bf16 v[40:43], v[184:187], v[104:107], v[40:43]
    ds_read_b128 v[100:103], v1 offset:45056
    v_mfma_f32_16x16x32_bf16 v[56:59], v[188:191], v[104:107], v[56:59]
    buffer_load_dwordx4 a[248:251], v1, s[16:19], s55 offen offset:2048
    v_mfma_f32_16x16x32_bf16 v[72:75], v[192:195], v[104:107], v[72:75]
    s_waitcnt lgkmcnt(3)
    v_mfma_f32_16x16x32_bf16 v[44:47], v[184:187], v[88:91], v[44:47]
    ds_read_b128 v[104:107], v1 offset:61440
    v_mfma_f32_16x16x32_bf16 v[60:63], v[188:191], v[88:91], v[60:63]
    buffer_load_dwordx4 a[252:255], v1, s[16:19], s55 offen offset:3072
    v_mfma_f32_16x16x32_bf16 v[76:79], v[192:195], v[88:91], v[76:79]
    s_waitcnt lgkmcnt(3)
    v_fmac_f32 v32, v108, v80
    v_fmac_f32 v33, v109, v80
    v_mfma_f32_16x16x32_bf16 v[40:43], v[196:199], v[92:95], v[40:43]
    ds_read_b128 v[88:91], v1 offset:46080
    v_fmac_f32 v34, v110, v80
    v_mfma_f32_16x16x32_bf16 v[56:59], v[200:203], v[92:95], v[56:59]
    v_fmac_f32 v35, v111, v80
    v_cvt_pk_bf16_f32 v120, v32, v33
    v_mfma_f32_16x16x32_bf16 v[72:75], v[204:207], v[92:95], v[72:75]
    s_waitcnt lgkmcnt(3)
    v_cvt_pk_bf16_f32 v121, v34, v35
    v_fmac_f32 v36, v108, v82
    v_mfma_f32_16x16x32_bf16 v[44:47], v[196:199], v[96:99], v[44:47]
    ds_read_b128 v[92:95], v1 offset:62464
    v_fmac_f32 v37, v109, v82
    v_mfma_f32_16x16x32_bf16 v[60:63], v[200:203], v[96:99], v[60:63]
    s_add_u32 s55, s33, 16384
    buffer_load_dwordx4 v[128:131], v1, s[16:19], s55 offen offset:0
    v_mfma_f32_16x16x32_bf16 v[76:79], v[204:207], v[96:99], v[76:79]
    s_waitcnt lgkmcnt(3)
    v_fmac_f32 v38, v110, v82
    v_fmac_f32 v39, v111, v82
    v_mfma_f32_16x16x32_bf16 v[40:43], v[208:211], v[100:103], v[40:43]
    ds_read_b128 v[96:99], v1 offset:47104
    v_cvt_pk_bf16_f32 v122, v36, v37
    v_mfma_f32_16x16x32_bf16 v[56:59], v[212:215], v[100:103], v[56:59]
    buffer_load_dwordx4 v[132:135], v1, s[16:19], s55 offen offset:1024
    v_mfma_f32_16x16x32_bf16 v[72:75], v[216:219], v[100:103], v[72:75]
    s_waitcnt lgkmcnt(3)
    v_cvt_pk_bf16_f32 v123, v38, v39
    v_pk_max_i16 v120, v120, 0
    v_mfma_f32_16x16x32_bf16 v[44:47], v[208:211], v[104:107], v[44:47]
    ds_read_b128 v[100:103], v1 offset:63488
    v_pk_max_i16 v122, v122, 0
    v_mfma_f32_16x16x32_bf16 v[60:63], v[212:215], v[104:107], v[60:63]
    v_pk_max_i16 v121, v121, 0
    v_pk_max_i16 v123, v123, 0
    v_mfma_f32_16x16x32_bf16 v[76:79], v[216:219], v[104:107], v[76:79]
    s_waitcnt lgkmcnt(3)
    v_permlane16_swap_b32 v120, v122
    v_mfma_f32_16x16x32_bf16 v[40:43], v[220:223], v[88:91], v[40:43]
    ds_read_b128 v[104:107], v1 offset:48128
    v_mfma_f32_16x16x32_bf16 v[56:59], v[224:227], v[88:91], v[56:59]
    buffer_load_dwordx4 v[136:139], v1, s[16:19], s55 offen offset:2048
    v_mfma_f32_16x16x32_bf16 v[72:75], v[228:231], v[88:91], v[72:75]
    s_waitcnt lgkmcnt(3)
    v_permlane16_swap_b32 v121, v123
    v_mfma_f32_16x16x32_bf16 v[44:47], v[220:223], v[92:95], v[44:47]
    ds_read_b128 v[88:91], v1 offset:64512
    v_mfma_f32_16x16x32_bf16 v[60:63], v[224:227], v[92:95], v[60:63]
    buffer_load_dwordx4 v[140:143], v1, s[16:19], s55 offen offset:3072
    v_mfma_f32_16x16x32_bf16 v[76:79], v[228:231], v[92:95], v[76:79]
    s_waitcnt lgkmcnt(3)
    buffer_store_dwordx4 v[120:123], v1, s[16:19], s99 offen offset:0
    v_mfma_f32_16x16x32_bf16 v[40:43], v[232:235], v[96:99], v[40:43]
    v_fmac_f32 v48, v112, v80
    v_fmac_f32 v49, v113, v80
    v_mfma_f32_16x16x32_bf16 v[56:59], v[236:239], v[96:99], v[56:59]
    v_fmac_f32 v50, v114, v80
    v_fmac_f32 v51, v115, v80
    v_mfma_f32_16x16x32_bf16 v[72:75], v[240:243], v[96:99], v[72:75]
    s_waitcnt lgkmcnt(2)
    v_cvt_pk_bf16_f32 v124, v48, v49
    v_cvt_pk_bf16_f32 v125, v50, v51
    v_mfma_f32_16x16x32_bf16 v[44:47], v[232:235], v[100:103], v[44:47]
    v_fmac_f32 v52, v112, v82
    v_fmac_f32 v53, v113, v82
    v_mfma_f32_16x16x32_bf16 v[60:63], v[236:239], v[100:103], v[60:63]
    s_add_u32 s55, s33, 20480
    buffer_load_dwordx4 v[144:147], v1, s[16:19], s55 offen offset:0
    v_mfma_f32_16x16x32_bf16 v[76:79], v[240:243], v[100:103], v[76:79]
    s_waitcnt lgkmcnt(1)
    v_fmac_f32 v54, v114, v82
    v_fmac_f32 v55, v115, v82
    v_mfma_f32_16x16x32_bf16 v[40:43], v[244:247], v[104:107], v[40:43]
    v_cvt_pk_bf16_f32 v126, v52, v53
    v_cvt_pk_bf16_f32 v127, v54, v55
    v_mfma_f32_16x16x32_bf16 v[56:59], v[248:251], v[104:107], v[56:59]
    buffer_load_dwordx4 v[148:151], v1, s[16:19], s55 offen offset:1024
    v_mfma_f32_16x16x32_bf16 v[72:75], v[252:255], v[104:107], v[72:75]
    s_waitcnt lgkmcnt(0)
    v_pk_max_i16 v124, v124, 0
    v_pk_max_i16 v126, v126, 0
    v_mfma_f32_16x16x32_bf16 v[44:47], v[244:247], v[88:91], v[44:47]
    v_pk_max_i16 v125, v125, 0
    v_pk_max_i16 v127, v127, 0
    v_mfma_f32_16x16x32_bf16 v[60:63], v[248:251], v[88:91], v[60:63]
    v_permlane16_swap_b32 v124, v126
    v_mfma_f32_16x16x32_bf16 v[76:79], v[252:255], v[88:91], v[76:79]
    v_permlane16_swap_b32 v125, v127
    buffer_store_dwordx4 v[124:127], v1, s[16:19], s100 offen offset:1024
    v_fmac_f32 v64, v116, v80
    v_fmac_f32 v65, v117, v80
    v_fmac_f32 v66, v118, v80
    v_fmac_f32 v67, v119, v80
    v_cvt_pk_bf16_f32 v120, v64, v65
    v_cvt_pk_bf16_f32 v121, v66, v67
    v_fmac_f32 v68, v116, v82
    v_fmac_f32 v69, v117, v82
    v_fmac_f32 v70, v118, v82
    v_fmac_f32_e64 v71, v119, v82
    v_cvt_pk_bf16_f32 v122, v68, v69
    v_cvt_pk_bf16_f32 v123, v70, v71
    v_pk_max_i16 v120, v120, 0
    v_pk_max_i16 v122, v122, 0
    v_pk_max_i16 v121, v121, 0
    v_pk_max_i16 v123, v123, 0
    v_permlane16_swap_b32 v120, v122
    s_nop 0
    v_permlane16_swap_b32_e64 v121, v123
    buffer_store_dwordx4 v[120:123], v1, s[16:19], s60 offen offset:2048
    v_pk_fma_f32 v[40:41], v[108:109], v[84:85], v[40:41] op_sel:[0,0,0] op_sel_hi:[1,0,1]
    v_pk_fma_f32 v[42:43], v[110:111], v[84:85], v[42:43] op_sel:[0,0,0] op_sel_hi:[1,0,1]
    v_cvt_pk_bf16_f32 v88, v40, v41
    v_cvt_pk_bf16_f32 v89, v42, v43
    v_pk_fma_f32 v[44:45], v[108:109], v[86:87], v[44:45] op_sel:[0,0,0] op_sel_hi:[1,0,1]
    v_pk_fma_f32 v[46:47], v[110:111], v[86:87], v[46:47] op_sel:[0,0,0] op_sel_hi:[1,0,1]
    v_cvt_pk_bf16_f32 v90, v44, v45
    v_cvt_pk_bf16_f32 v91, v46, v47
    v_pk_max_i16 v88, v88, 0
    v_pk_max_i16 v90, v90, 0
    v_pk_max_i16 v89, v89, 0
    v_pk_max_i16 v91, v91, 0
    v_permlane16_swap_b32 v88, v90
    s_nop 0
    v_permlane16_swap_b32_e64 v89, v91
    buffer_store_dwordx4 v[88:91], v1, s[16:19], s100 offen offset:0
    v_pk_fma_f32 v[56:57], v[112:113], v[84:85], v[56:57] op_sel:[0,0,0] op_sel_hi:[1,0,1]
    v_pk_fma_f32 v[58:59], v[114:115], v[84:85], v[58:59] op_sel:[0,0,0] op_sel_hi:[1,0,1]
    v_cvt_pk_bf16_f32 v92, v56, v57
    v_cvt_pk_bf16_f32 v93, v58, v59
    v_pk_fma_f32 v[60:61], v[112:113], v[86:87], v[60:61] op_sel:[0,0,0] op_sel_hi:[1,0,1]
    v_pk_fma_f32 v[62:63], v[114:115], v[86:87], v[62:63] op_sel:[0,0,0] op_sel_hi:[1,0,1]
    v_cvt_pk_bf16_f32 v94, v60, v61
    v_cvt_pk_bf16_f32 v95, v62, v63
    v_pk_max_i16 v92, v92, 0
    v_pk_max_i16 v94, v94, 0
    v_pk_max_i16 v93, v93, 0
    v_pk_max_i16 v95, v95, 0
    v_permlane16_swap_b32 v92, v94
    s_nop 0
    v_permlane16_swap_b32_e64 v93, v95
    buffer_store_dwordx4 v[92:95], v1, s[16:19], s99 offen offset:1024
    v_pk_fma_f32 v[72:73], v[116:117], v[84:85], v[72:73] op_sel:[0,0,0] op_sel_hi:[1,0,1]
    v_pk_fma_f32 v[74:75], v[118:119], v[84:85], v[74:75] op_sel:[0,0,0] op_sel_hi:[1,0,1]
    v_cvt_pk_bf16_f32 v96, v72, v73
    v_cvt_pk_bf16_f32 v97, v74, v75
    v_pk_fma_f32 v[76:77], v[116:117], v[86:87], v[76:77] op_sel:[0,0,0] op_sel_hi:[1,0,1]
    v_pk_fma_f32 v[78:79], v[118:119], v[86:87], v[78:79] op_sel:[0,0,0] op_sel_hi:[1,0,1]
    v_cvt_pk_bf16_f32 v98, v76, v77
    v_cvt_pk_bf16_f32 v99, v78, v79
    v_pk_max_i16 v96, v96, 0
    v_pk_max_i16 v98, v98, 0
    v_pk_max_i16 v97, v97, 0
    v_pk_max_i16 v99, v99, 0
    v_permlane16_swap_b32 v96, v98
    s_nop 0
    v_permlane16_swap_b32_e64 v97, v99
    buffer_store_dwordx4 v[96:99], v1, s[16:19], s61 offen offset:2048
    buffer_load_dwordx4 v[152:155], v1, s[16:19], s55 offen offset:2048
    buffer_load_dwordx4 v[156:159], v1, s[16:19], s55 offen offset:3072
    s_add_u32 s55, s33, 24576
    buffer_load_dwordx4 v[160:163], v1, s[16:19], s55 offen offset:0
    buffer_load_dwordx4 v[164:167], v1, s[16:19], s55 offen offset:1024
    buffer_load_dwordx4 v[168:171], v1, s[16:19], s55 offen offset:2048
    buffer_load_dwordx4 v[172:175], v1, s[16:19], s55 offen offset:3072
    s_add_u32 s55, s33, 28672
    buffer_load_dwordx4 v[176:179], v1, s[16:19], s55 offen offset:0
    buffer_load_dwordx4 v[180:183], v1, s[16:19], s55 offen offset:1024
    buffer_load_dwordx4 v[184:187], v1, s[16:19], s55 offen offset:2048
    buffer_load_dwordx4 v[188:191], v1, s[16:19], s55 offen offset:3072
    v_mov_b32 v11, 3
    s_mov_b64 exec, 1
    s_waitcnt vmcnt(10)
    buffer_store_dword v11, off, s[16:19], s40
    s_mov_b64 exec, -1
    s_add_u32 s55, s33, 32768
    buffer_load_dwordx4 v[192:195], v1, s[16:19], s55 offen offset:0
    buffer_load_dwordx4 v[196:199], v1, s[16:19], s55 offen offset:1024
    buffer_load_dwordx4 v[200:203], v1, s[16:19], s55 offen offset:2048
    buffer_load_dwordx4 v[204:207], v1, s[16:19], s55 offen offset:3072
    s_add_u32 s55, s33, 36864
    buffer_load_dwordx4 v[208:211], v1, s[16:19], s55 offen offset:0
    buffer_load_dwordx4 v[212:215], v1, s[16:19], s55 offen offset:1024
    buffer_load_dwordx4 v[216:219], v1, s[16:19], s55 offen offset:2048
    buffer_load_dwordx4 v[220:223], v1, s[16:19], s55 offen offset:3072
    s_add_u32 s55, s33, 40960
    buffer_load_dwordx4 v[224:227], v1, s[16:19], s55 offen offset:0
    buffer_load_dwordx4 v[228:231], v1, s[16:19], s55 offen offset:1024
    s_mul_i32 s3, s6, 192
    s_add_u32 s3, s3, 1792
    v_add_u32_e64 v13, s3, v10
    s_mov_b32 exec_lo, 0x10001
    s_mov_b32 exec_hi, 0x10001
    ds_write_b128 v13, v[108:111] offset:0
    ds_write_b128 v13, v[112:115] offset:64
    ds_write_b128 v13, v[116:119] offset:128
    s_mov_b64 exec, -1
    v_lshl_add_u32 v11, s25, 7, v6
    v_add_u32 v11, 161280, v11
    ds_read_b32 v14, v11
    s_lshl_b32 s44, s6, 11
    s_add_u32 s57, s35, s44
    s_cmp_ge_u32 s6, 2
    s_cselect_b32 s58, 134217728, s57
    v_lshl_add_u32 v12, s6, 12, v2
    v_xor_b32 v13, 0x1000, v12
    s_lshl3_add_u32 s3, s6, 196608
    s_bfe_u32 s3, s56, s3
    s_lshl_b32 s3, s3, 11
    s_add_u32 s97, s3, s43
    s_lshl3_add_u32 s3, s6, 196612
    s_bfe_u32 s3, s56, s3
    s_lshl_b32 s3, s3, 11
    s_add_u32 s98, s3, s43
    v_and_b32 v124, 0x300, v1
    v_add_u32 v124, v124, v1
    buffer_load_dword v11, v6, s[16:19], s39 offen sc1
    buffer_load_dwordx4 v[232:235], v1, s[16:19], s55 offen offset:2048
    s_waitcnt vmcnt(1)
    v_cmp_gt_i32 vcc, 3, v11
    s_cbranch_vccnz LF_spin_10
LF_got_11:
    s_add_u32 m0, s44, 0
    s_nop 0
    buffer_load_dwordx4 v1, s[16:19], s57 offen offset:0 sc1 lds
    buffer_load_dwordx4 v1, s[16:19], s57 offen offset:1024 sc1 lds
    s_add_u32 s54, s57, 8192
    s_add_u32 m0, s44, 8192
    s_nop 0
    buffer_load_dwordx4 v1, s[16:19], s54 offen offset:0 sc1 lds
    buffer_load_dwordx4 v1, s[16:19], s54 offen offset:1024 sc1 lds
    s_add_u32 s54, s57, 16384
    s_add_u32 m0, s44, 16384
    s_nop 0
    buffer_load_dwordx4 v1, s[16:19], s54 offen offset:0 sc1 lds
    buffer_load_dwordx4 v1, s[16:19], s54 offen offset:1024 sc1 lds
    s_waitcnt vmcnt(4)
    s_barrier
    ds_read_b128 v[64:67], v3 offset:0
    ds_read_b128 v[68:71], v3 offset:2048
    ds_read_b128 v[72:75], v3 offset:4096
    ds_read_b128 v[76:79], v3 offset:6144
    s_add_u32 s54, s57, 24576
    s_add_u32 m0, s44, 24576
    s_nop 0
    buffer_load_dwordx4 v1, s[16:19], s54 offen offset:0 sc1 lds
    buffer_load_dwordx4 v1, s[16:19], s54 offen offset:1024 sc1 lds
    s_add_u32 s54, s57, 32768
    s_add_u32 m0, s44, 32768
    s_nop 0
    buffer_load_dwordx4 v1, s[16:19], s54 offen offset:0 sc1 lds
    buffer_load_dwordx4 v1, s[16:19], s54 offen offset:1024 sc1 lds
    s_waitcnt lgkmcnt(3)
    v_mfma_f32_32x32x16_bf16 v[48:63], a[192:195], v[64:67], 0
    s_add_u32 s54, s57, 40960
    s_add_u32 m0, s44, 40960
    s_nop 0
    buffer_load_dwordx4 v1, s[16:19], s54 offen offset:0 sc1 lds
    s_waitcnt lgkmcnt(2)
    v_mfma_f32_32x32x16_bf16 v[48:63], a[196:199], v[68:71], v[48:63]
    s_waitcnt vmcnt(7)
    s_barrier
    ds_read_b128 v[80:83], v3 offset:8192
    ds_read_b128 v[84:87], v3 offset:10240
    s_waitcnt lgkmcnt(3)
    v_mfma_f32_32x32x16_bf16 v[48:63], a[200:203], v[72:75], v[48:63]
    ds_read_b128 v[88:91], v3 offset:12288
    ds_read_b128 v[92:95], v3 offset:14336
    s_waitcnt lgkmcnt(4)
    v_mfma_f32_32x32x16_bf16 v[48:63], a[204:207], v[76:79], v[48:63]
    buffer_load_dwordx4 v1, s[16:19], s54 offen offset:1024 sc1 lds
    s_waitcnt lgkmcnt(3)
    v_mfma_f32_32x32x16_bf16 v[48:63], a[208:211], v[80:83], v[48:63]
    s_add_u32 s54, s57, 49152
    s_add_u32 m0, s44, 49152
    s_nop 0
    buffer_load_dwordx4 v1, s[16:19], s54 offen offset:0 sc1 lds
    s_waitcnt lgkmcnt(2)
    v_mfma_f32_32x32x16_bf16 v[48:63], a[212:215], v[84:87], v[48:63]
    s_waitcnt vmcnt(7)
    s_barrier
    ds_read_b128 v[64:67], v3 offset:16384
    ds_read_b128 v[68:71], v3 offset:18432
    s_waitcnt lgkmcnt(3)
    v_mfma_f32_32x32x16_bf16 v[48:63], a[216:219], v[88:91], v[48:63]
    ds_read_b128 v[72:75], v3 offset:20480
    ds_read_b128 v[76:79], v3 offset:22528
    s_waitcnt lgkmcnt(4)
    v_mfma_f32_32x32x16_bf16 v[48:63], a[220:223], v[92:95], v[48:63]
    buffer_load_dwordx4 v1, s[16:19], s54 offen offset:1024 sc1 lds
    s_waitcnt lgkmcnt(3)
    v_mfma_f32_32x32x16_bf16 v[48:63], a[224:227], v[64:67], v[48:63]
    s_add_u32 s54, s57, 57344
    s_add_u32 m0, s44, 57344
    s_nop 0
    buffer_load_dwordx4 v1, s[16:19], s54 offen offset:0 sc1 lds
    s_waitcnt lgkmcnt(2)
    v_mfma_f32_32x32x16_bf16 v[48:63], a[228:231], v[68:71], v[48:63]
    s_waitcnt vmcnt(7)
    s_barrier
    ds_read_b128 v[80:83], v3 offset:24576
    ds_read_b128 v[84:87], v3 offset:26624
L_pad4:
    s_cbranch_execz L_pad8
    s_waitcnt lgkmcnt(3)
    v_mfma_f32_32x32x16_bf16 v[48:63], a[232:235], v[72:75], v[48:63]
    ds_read_b128 v[88:91], v3 offset:28672
    ds_read_b128 v[92:95], v3 offset:30720
    s_waitcnt lgkmcnt(4)
    v_mfma_f32_32x32x16_bf16 v[48:63], a[236:239], v[76:79], v[48:63]
    buffer_load_dwordx4 v1, s[16:19], s54 offen offset:1024 sc1 lds
    s_waitcnt lgkmcnt(3)
    v_mfma_f32_32x32x16_bf16 v[48:63], a[240:243], v[80:83], v[48:63]
    s_add_u32 s54, s57, 65536
    s_add_u32 m0, s44, 0
    s_nop 0
    buffer_load_dwordx4 v1, s[16:19], s54 offen offset:0 sc1 lds
    s_waitcnt lgkmcnt(2)
    v_mfma_f32_32x32x16_bf16 v[48:63], a[244:247], v[84:87], v[48:63]
    s_waitcnt vmcnt(7)
    s_barrier
    ds_read_b128 v[64:67], v3 offset:32768
    ds_read_b128 v[68:71], v3 offset:34816
    s_waitcnt lgkmcnt(3)
    v_mfma_f32_32x32x16_bf16 v[48:63], a[248:251], v[88:91], v[48:63]
    ds_read_b128 v[72:75], v3 offset:36864
    ds_read_b128 v[76:79], v3 offset:38912
    s_waitcnt lgkmcnt(4)
    v_mfma_f32_32x32x16_bf16 v[48:63], a[252:255], v[92:95], v[48:63]
    buffer_load_dwordx4 v1, s[16:19], s54 offen offset:1024 sc1 lds
    s_waitcnt lgkmcnt(3)
    v_mfma_f32_32x32x16_bf16 v[48:63], v[128:131], v[64:67], v[48:63]
    s_add_u32 s54, s57, 73728
    s_add_u32 m0, s44, 8192
    s_nop 0
    buffer_load_dwordx4 v1, s[16:19], s54 offen offset:0 sc1 lds
    s_waitcnt lgkmcnt(2)
    v_mfma_f32_32x32x16_bf16 v[48:63], v[132:135], v[68:71], v[48:63]
    s_waitcnt vmcnt(7)
    s_barrier
    ds_read_b128 v[80:83], v3 offset:40960
    ds_read_b128 v[84:87], v3 offset:43008
    s_waitcnt lgkmcnt(3)
    v_mfma_f32_32x32x16_bf16 v[48:63], v[136:139], v[72:75], v[48:63]
    ds_read_b128 v[88:91], v3 offset:45056
    ds_read_b128 v[92:95], v3 offset:47104
    s_waitcnt lgkmcnt(4)
    v_mfma_f32_32x32x16_bf16 v[48:63], v[140:143], v[76:79], v[48:63]
    buffer_load_dwordx4 v1, s[16:19], s54 offen offset:1024 sc1 lds
    s_waitcnt lgkmcnt(3)
    v_mfma_f32_32x32x16_bf16 v[48:63], v[144:147], v[80:83], v[48:63]
    s_add_u32 s54, s57, 81920
    s_add_u32 m0, s44, 16384
    s_nop 0
    buffer_load_dwordx4 v1, s[16:19], s54 offen offset:0 sc1 lds
    s_waitcnt lgkmcnt(2)
    v_mfma_f32_32x32x16_bf16 v[48:63], v[148:151], v[84:87], v[48:63]
    s_waitcnt vmcnt(7)
    s_barrier
    ds_read_b128 v[64:67], v3 offset:49152
    ds_read_b128 v[68:71], v3 offset:51200
    s_waitcnt lgkmcnt(3)
    v_mfma_f32_32x32x16_bf16 v[48:63], v[152:155], v[88:91], v[48:63]
    ds_read_b128 v[72:75], v3 offset:53248
    ds_read_b128 v[76:79], v3 offset:55296
    s_waitcnt lgkmcnt(4)
    v_mfma_f32_32x32x16_bf16 v[48:63], v[156:159], v[92:95], v[48:63]
    buffer_load_dwordx4 v1, s[16:19], s54 offen offset:1024 sc1 lds
    s_waitcnt lgkmcnt(3)
    v_mfma_f32_32x32x16_bf16 v[48:63], v[160:163], v[64:67], v[48:63]
    s_add_u32 s54, s57, 90112
    s_add_u32 m0, s44, 24576
    s_nop 0
    buffer_load_dwordx4 v1, s[16:19], s54 offen offset:0 sc1 lds
    s_waitcnt lgkmcnt(2)
    v_mfma_f32_32x32x16_bf16 v[48:63], v[164:167], v[68:71], v[48:63]
    s_waitcnt vmcnt(7)
    s_barrier
    ds_read_b128 v[80:83], v3 offset:57344
    ds_read_b128 v[84:87], v3 offset:59392
    s_waitcnt lgkmcnt(3)
    v_mfma_f32_32x32x16_bf16 v[48:63], v[168:171], v[72:75], v[48:63]
    ds_read_b128 v[88:91], v3 offset:61440
    ds_read_b128 v[92:95], v3 offset:63488
    s_waitcnt lgkmcnt(4)
    v_mfma_f32_32x32x16_bf16 v[48:63], v[172:175], v[76:79], v[48:63]
    buffer_load_dwordx4 v1, s[16:19], s54 offen offset:1024 sc1 lds
    s_waitcnt lgkmcnt(3)
    v_mfma_f32_32x32x16_bf16 v[48:63], v[176:179], v[80:83], v[48:63]
    s_add_u32 s54, s57, 98304
    s_add_u32 m0, s44, 32768
    s_nop 0
    buffer_load_dwordx4 v1, s[16:19], s54 offen offset:0 sc1 lds
    s_waitcnt lgkmcnt(2)
    v_mfma_f32_32x32x16_bf16 v[48:63], v[180:183], v[84:87], v[48:63]
    s_waitcnt vmcnt(7)
    s_barrier
    ds_read_b128 v[64:67], v3 offset:0
    ds_read_b128 v[68:71], v3 offset:2048
    s_waitcnt lgkmcnt(3)
    v_mfma_f32_32x32x16_bf16 v[48:63], v[184:187], v[88:91], v[48:63]
    ds_read_b128 v[72:75], v3 offset:4096
    ds_read_b128 v[76:79], v3 offset:6144
    s_waitcnt lgkmcnt(4)
    v_mfma_f32_32x32x16_bf16 v[48:63], v[188:191], v[92:95], v[48:63]
    buffer_load_dwordx4 v1, s[16:19], s54 offen offset:1024 sc1 lds
    s_waitcnt lgkmcnt(3)
    v_mfma_f32_32x32x16_bf16 v[48:63], v[192:195], v[64:67], v[48:63]
    s_add_u32 s54, s57, 106496
    s_add_u32 m0, s44, 40960
    s_nop 0
    buffer_load_dwordx4 v1, s[16:19], s54 offen offset:0 sc1 lds
    s_waitcnt lgkmcnt(2)
    v_mfma_f32_32x32x16_bf16 v[48:63], v[196:199], v[68:71], v[48:63]
    s_waitcnt vmcnt(7)
    s_barrier
    ds_read_b128 v[80:83], v3 offset:8192
    ds_read_b128 v[84:87], v3 offset:10240
    s_waitcnt lgkmcnt(3)
    v_mfma_f32_32x32x16_bf16 v[48:63], v[200:203], v[72:75], v[48:63]
    ds_read_b128 v[88:91], v3 offset:12288
    ds_read_b128 v[92:95], v3 offset:14336
    s_waitcnt lgkmcnt(4)
    v_mfma_f32_32x32x16_bf16 v[48:63], v[204:207], v[76:79], v[48:63]
    buffer_load_dwordx4 v1, s[16:19], s54 offen offset:1024 sc1 lds
    s_waitcnt lgkmcnt(3)
    v_mfma_f32_32x32x16_bf16 v[48:63], v[208:211], v[80:83], v[48:63]
    s_add_u32 s54, s57, 114688
    s_add_u32 m0, s44, 49152
    s_nop 0
    buffer_load_dwordx4 v1, s[16:19], s54 offen offset:0 sc1 lds
    s_waitcnt lgkmcnt(2)
    v_mfma_f32_32x32x16_bf16 v[48:63], v[212:215], v[84:87], v[48:63]
    s_waitcnt vmcnt(7)
    s_barrier
    ds_read_b128 v[64:67], v3 offset:16384
    ds_read_b128 v[68:71], v3 offset:18432
    s_waitcnt lgkmcnt(3)
    v_mfma_f32_32x32x16_bf16 v[48:63], v[216:219], v[88:91], v[48:63]
    ds_read_b128 v[72:75], v3 offset:20480
    ds_read_b128 v[76:79], v3 offset:22528
    s_waitcnt lgkmcnt(4)
    v_mfma_f32_32x32x16_bf16 v[48:63], v[220:223], v[92:95], v[48:63]
    buffer_load_dwordx4 v1, s[16:19], s54 offen offset:1024 sc1 lds
    s_waitcnt lgkmcnt(3)
    v_mfma_f32_32x32x16_bf16 v[48:63], v[224:227], v[64:67], v[48:63]
    s_add_u32 s54, s57, 122880
    s_add_u32 m0, s44, 57344
    s_nop 0
    buffer_load_dwordx4 v1, s[16:19], s54 offen offset:0 sc1 lds
    s_waitcnt lgkmcnt(2)
    v_mfma_f32_32x32x16_bf16 v[48:63], v[228:231], v[68:71], v[48:63]
    s_waitcnt vmcnt(7)
    s_barrier
    ds_read_b128 v[80:83], v3 offset:24576
    ds_read_b128 v[84:87], v3 offset:26624
    s_waitcnt lgkmcnt(3)
    v_mfma_f32_32x32x16_bf16 v[48:63], v[232:235], v[72:75], v[48:63]
    ds_read_b128 v[88:91], v3 offset:28672
    ds_read_b128 v[92:95], v3 offset:30720
    s_waitcnt lgkmcnt(4)
    v_mfma_f32_32x32x16_bf16 v[32:47], a[192:195], v[76:79], 0
    buffer_load_dwordx4 v1, s[16:19], s54 offen offset:1024 sc1 lds
    s_waitcnt lgkmcnt(3)
    v_mfma_f32_32x32x16_bf16 v[32:47], a[196:199], v[80:83], v[32:47]
    s_add_u32 s54, s57, 131072
    s_add_u32 m0, s44, 0
    s_nop 0
    buffer_load_dwordx4 v1, s[16:19], s54 offen offset:0 sc1 lds
    s_nop 0
    v_cvt_pk_bf16_f32 v48, v48, v49
    v_cvt_pk_bf16_f32 v49, v50, v51
    s_waitcnt lgkmcnt(2)
    v_mfma_f32_32x32x16_bf16 v[32:47], a[200:203], v[84:87], v[32:47]
    s_waitcnt vmcnt(7)
    s_barrier
    ds_read_b128 v[64:67], v3 offset:32768
    ds_read_b128 v[68:71], v3 offset:34816
    v_cvt_pk_bf16_f32 v50, v52, v53
    s_waitcnt lgkmcnt(3)
    v_mfma_f32_32x32x16_bf16 v[32:47], a[204:207], v[88:91], v[32:47]
    ds_read_b128 v[72:75], v3 offset:36864
    ds_read_b128 v[76:79], v3 offset:38912
    v_cvt_pk_bf16_f32 v51, v54, v55
    v_cvt_pk_bf16_f32 v52, v56, v57
    v_cvt_pk_bf16_f32 v53, v58, v59
    s_waitcnt lgkmcnt(4)
    v_mfma_f32_32x32x16_bf16 v[32:47], a[208:211], v[92:95], v[32:47]
    buffer_load_dwordx4 v1, s[16:19], s54 offen offset:1024 sc1 lds
    v_cvt_pk_bf16_f32 v54, v60, v61
    v_cvt_pk_bf16_f32 v55, v62, v63
    s_waitcnt lgkmcnt(3)
    v_mfma_f32_32x32x16_bf16 v[32:47], a[212:215], v[64:67], v[32:47]
    s_add_u32 s54, s57, 139264
    s_add_u32 m0, s44, 8192
    s_nop 0
    buffer_load_dwordx4 v1, s[16:19], s54 offen offset:0 sc1 lds
    s_waitcnt lgkmcnt(2)
    v_mfma_f32_32x32x16_bf16 v[32:47], a[216:219], v[68:71], v[32:47]
    s_waitcnt vmcnt(7)
    s_barrier
    ds_read_b128 v[80:83], v3 offset:40960
    ds_read_b128 v[84:87], v3 offset:43008
    s_waitcnt lgkmcnt(3)
    v_mfma_f32_32x32x16_bf16 v[32:47], a[220:223], v[72:75], v[32:47]
    ds_read_b128 v[88:91], v3 offset:45056
    ds_read_b128 v[92:95], v3 offset:47104
    s_waitcnt lgkmcnt(4)
    v_mfma_f32_32x32x16_bf16 v[32:47], a[224:227], v[76:79], v[32:47]
    buffer_load_dwordx4 v1, s[16:19], s54 offen offset:1024 sc1 lds
    s_waitcnt lgkmcnt(3)
    v_mfma_f32_32x32x16_bf16 v[32:47], a[228:231], v[80:83], v[32:47]
    s_add_u32 s54, s57, 147456
    s_add_u32 m0, s44, 16384
    s_nop 0
    buffer_load_dwordx4 v1, s[16:19], s54 offen offset:0 sc1 lds
    s_waitcnt lgkmcnt(2)
    v_mfma_f32_32x32x16_bf16 v[32:47], a[232:235], v[84:87], v[32:47]
    s_waitcnt vmcnt(7)
    s_barrier
    ds_read_b128 v[64:67], v3 offset:49152
    ds_read_b128 v[68:71], v3 offset:51200
    s_waitcnt lgkmcnt(3)
    v_mfma_f32_32x32x16_bf16 v[32:47], a[236:239], v[88:91], v[32:47]
    ds_read_b128 v[72:75], v3 offset:53248
    ds_read_b128 v[76:79], v3 offset:55296
    s_waitcnt lgkmcnt(4)
    v_mfma_f32_32x32x16_bf16 v[32:47], a[240:243], v[92:95], v[32:47]
    buffer_load_dwordx4 v1, s[16:19], s54 offen offset:1024 sc1 lds
    s_waitcnt lgkmcnt(3)
    v_mfma_f32_32x32x16_bf16 v[32:47], a[244:247], v[64:67], v[32:47]
    s_add_u32 s54, s57, 155648
    s_add_u32 m0, s44, 24576
    s_nop 0
    buffer_load_dwordx4 v1, s[16:19], s54 offen offset:0 sc1 lds
    s_waitcnt lgkmcnt(2)
    v_mfma_f32_32x32x16_bf16 v[32:47], a[248:251], v[68:71], v[32:47]
    s_waitcnt vmcnt(7)
    s_barrier
    ds_read_b128 v[80:83], v3 offset:57344
    ds_read_b128 v[84:87], v3 offset:59392
    s_waitcnt lgkmcnt(3)
    v_mfma_f32_32x32x16_bf16 v[32:47], a[252:255], v[72:75], v[32:47]
    ds_read_b128 v[88:91], v3 offset:61440
    ds_read_b128 v[92:95], v3 offset:63488
    s_waitcnt lgkmcnt(4)
    v_mfma_f32_32x32x16_bf16 v[32:47], v[128:131], v[76:79], v[32:47]
    buffer_load_dwordx4 v1, s[16:19], s54 offen offset:1024 sc1 lds
    s_waitcnt lgkmcnt(3)
    v_mfma_f32_32x32x16_bf16 v[32:47], v[132:135], v[80:83], v[32:47]
    s_add_u32 s54, s57, 163840
    s_add_u32 m0, s44, 32768
    s_nop 0
    buffer_load_dwordx4 v1, s[16:19], s54 offen offset:0 sc1 lds
    s_waitcnt lgkmcnt(2)
    v_mfma_f32_32x32x16_bf16 v[32:47], v[136:139], v[84:87], v[32:47]
    s_waitcnt vmcnt(7)
    s_barrier
    ds_read_b128 v[64:67], v3 offset:0
    ds_read_b128 v[68:71], v3 offset:2048
    s_waitcnt lgkmcnt(3)
    v_mfma_f32_32x32x16_bf16 v[32:47], v[140:143], v[88:91], v[32:47]
    ds_read_b128 v[72:75], v3 offset:4096
    ds_read_b128 v[76:79], v3 offset:6144
    s_waitcnt lgkmcnt(4)
    v_mfma_f32_32x32x16_bf16 v[32:47], v[144:147], v[92:95], v[32:47]
    buffer_load_dwordx4 v1, s[16:19], s54 offen offset:1024 sc1 lds
    s_waitcnt lgkmcnt(3)
    v_mfma_f32_32x32x16_bf16 v[32:47], v[148:151], v[64:67], v[32:47]
    s_add_u32 s54, s58, 172032
    s_add_u32 m0, s44, 40960
    s_nop 0
    buffer_load_dwordx4 v1, s[16:19], s54 offen offset:0 sc1 lds
    s_waitcnt lgkmcnt(2)
    v_mfma_f32_32x32x16_bf16 v[32:47], v[152:155], v[68:71], v[32:47]
    s_waitcnt vmcnt(7)
    s_barrier
    ds_read_b128 v[80:83], v3 offset:8192
    ds_read_b128 v[84:87], v3 offset:10240
    s_waitcnt lgkmcnt(3)
    v_mfma_f32_32x32x16_bf16 v[32:47], v[156:159], v[72:75], v[32:47]
    ds_read_b128 v[88:91], v3 offset:12288
    ds_read_b128 v[92:95], v3 offset:14336
    s_waitcnt lgkmcnt(4)
    v_mfma_f32_32x32x16_bf16 v[32:47], v[160:163], v[76:79], v[32:47]
    buffer_load_dwordx4 v1, s[16:19], s54 offen offset:1024 sc1 lds
    s_waitcnt lgkmcnt(3)
    v_mfma_f32_32x32x16_bf16 v[32:47], v[164:167], v[80:83], v[32:47]
    s_waitcnt lgkmcnt(2)
    v_mfma_f32_32x32x16_bf16 v[32:47], v[168:171], v[84:87], v[32:47]
    s_waitcnt vmcnt(6)
    s_barrier
    ds_read_b128 v[64:67], v3 offset:16384
    ds_read_b128 v[68:71], v3 offset:18432
    s_waitcnt lgkmcnt(3)
    v_mfma_f32_32x32x16_bf16 v[32:47], v[172:175], v[88:91], v[32:47]
    ds_read_b128 v[72:75], v3 offset:20480
    ds_read_b128 v[76:79], v3 offset:22528
    s_waitcnt lgkmcnt(4)
    v_mfma_f32_32x32x16_bf16 v[32:47], v[176:179], v[92:95], v[32:47]
    s_waitcnt lgkmcnt(3)
    v_mfma_f32_32x32x16_bf16 v[32:47], v[180:183], v[64:67], v[32:47]
    s_waitcnt lgkmcnt(2)
    v_mfma_f32_32x32x16_bf16 v[32:47], v[184:187], v[68:71], v[32:47]
    s_waitcnt vmcnt(4)
    s_barrier
    ds_read_b128 v[80:83], v3 offset:24576
    ds_read_b128 v[84:87], v3 offset:26624
    s_waitcnt lgkmcnt(3)
    v_mfma_f32_32x32x16_bf16 v[32:47], v[188:191], v[72:75], v[32:47]
    ds_read_b128 v[88:91], v3 offset:28672
    ds_read_b128 v[92:95], v3 offset:30720
    s_waitcnt lgkmcnt(4)
    v_mfma_f32_32x32x16_bf16 v[32:47], v[192:195], v[76:79], v[32:47]
    ds_write_b128 v12, v[48:51] offset:0
    s_waitcnt lgkmcnt(4)
    v_mfma_f32_32x32x16_bf16 v[32:47], v[196:199], v[80:83], v[32:47]
    ds_write_b128 v12, v[52:55] offset:1024
    s_waitcnt lgkmcnt(4)
    v_mfma_f32_32x32x16_bf16 v[32:47], v[200:203], v[84:87], v[32:47]
    s_waitcnt lgkmcnt(0)
    s_waitcnt vmcnt(2)
    s_barrier
    ds_read_b128 v[64:67], v3 offset:32768
    ds_read_b128 v[68:71], v3 offset:34816
    v_mfma_f32_32x32x16_bf16 v[32:47], v[204:207], v[88:91], v[32:47]
    ds_read_b128 v[72:75], v3 offset:36864
    ds_read_b128 v[76:79], v3 offset:38912
    v_mfma_f32_32x32x16_bf16 v[32:47], v[208:211], v[92:95], v[32:47]
    ds_read_b128 v[56:59], v13 offset:0
    ds_read_b128 v[60:63], v13 offset:1024
    s_waitcnt lgkmcnt(5)
    v_mfma_f32_32x32x16_bf16 v[32:47], v[212:215], v[64:67], v[32:47]
    s_waitcnt lgkmcnt(0)
    v_lshlrev_b32 v48, 16, v56
    v_and_b32 v49, 0xffff0000, v56
    v_lshlrev_b32 v50, 16, v57
    v_and_b32 v51, 0xffff0000, v57
    v_lshlrev_b32 v52, 16, v58
    v_and_b32 v53, 0xffff0000, v58
    v_mfma_f32_32x32x16_bf16 v[32:47], v[216:219], v[68:71], v[32:47]
    s_waitcnt vmcnt(0)
    s_barrier
    ds_read_b128 v[80:83], v3 offset:40960
    ds_read_b128 v[84:87], v3 offset:43008
    v_lshlrev_b32 v54, 16, v59
    v_mfma_f32_32x32x16_bf16 v[32:47], v[220:223], v[72:75], v[32:47]
    v_and_b32 v55, 0xffff0000, v59
    v_lshlrev_b32 v56, 16, v60
    v_and_b32 v57, 0xffff0000, v60
    v_lshlrev_b32 v58, 16, v61
    v_and_b32 v59, 0xffff0000, v61
    v_lshlrev_b32 v60, 16, v62
    v_mfma_f32_32x32x16_bf16 v[32:47], v[224:227], v[76:79], v[32:47]
    v_and_b32 v61, 0xffff0000, v62
    v_lshlrev_b32 v62, 16, v63
    v_and_b32 v63, 0xffff0000, v63
    v_fmac_f32 v16, v14, v48
    v_fmac_f32 v17, v14, v49
    v_fmac_f32 v18, v14, v50
    s_waitcnt lgkmcnt(1)
    v_mfma_f32_32x32x16_bf16 v[32:47], v[228:231], v[80:83], v[32:47]
    v_fmac_f32 v19, v14, v51
    v_fmac_f32 v20, v14, v52
    v_fmac_f32 v21, v14, v53
    v_fmac_f32 v22, v14, v54
    v_fmac_f32 v23, v14, v55
    v_fmac_f32 v24, v14, v56
    s_waitcnt lgkmcnt(0)
    v_mfma_f32_32x32x16_bf16 v[32:47], v[232:235], v[84:87], v[32:47]
    v_fmac_f32 v25, v14, v57
    v_fmac_f32 v26, v14, v58
    v_fmac_f32 v27, v14, v59
    v_fmac_f32 v28, v14, v60
    v_fmac_f32 v29, v14, v61
    v_fmac_f32 v30, v14, v62
    v_fmac_f32 v31, v14, v63
    s_nop 4
    s_nop 0
    v_pk_fma_f32 v[16:17], v[32:33], v[14:15], v[16:17] op_sel:[0,0,0] op_sel_hi:[1,0,1]
    v_pk_fma_f32 v[18:19], v[34:35], v[14:15], v[18:19] op_sel:[0,0,0] op_sel_hi:[1,0,1]
    v_pk_fma_f32 v[20:21], v[36:37], v[14:15], v[20:21] op_sel:[0,0,0] op_sel_hi:[1,0,1]
    v_pk_fma_f32 v[22:23], v[38:39], v[14:15], v[22:23] op_sel:[0,0,0] op_sel_hi:[1,0,1]
    v_cvt_pk_bf16_f32 v64, v16, v17
    v_cvt_pk_bf16_f32 v65, v18, v19
    v_cvt_pk_bf16_f32 v66, v20, v21
    v_cvt_pk_bf16_f32 v67, v22, v23
    buffer_store_dwordx4 v[64:67], v5, s[16:19], s47 offen offset:0
    v_pk_fma_f32 v[24:25], v[40:41], v[14:15], v[24:25] op_sel:[0,0,0] op_sel_hi:[1,0,1]
    v_pk_fma_f32 v[26:27], v[42:43], v[14:15], v[26:27] op_sel:[0,0,0] op_sel_hi:[1,0,1]
    v_pk_fma_f32 v[28:29], v[44:45], v[14:15], v[28:29] op_sel:[0,0,0] op_sel_hi:[1,0,1]
    v_pk_fma_f32 v[30:31], v[46:47], v[14:15], v[30:31] op_sel:[0,0,0] op_sel_hi:[1,0,1]
    v_cvt_pk_bf16_f32 v68, v24, v25
    v_cvt_pk_bf16_f32 v69, v26, v27
    v_cvt_pk_bf16_f32 v70, v28, v29
    v_cvt_pk_bf16_f32 v71, v30, v31
    buffer_store_dwordx4 v[68:71], v5, s[16:19], s47 offen offset:512
    v_pk_add_f32 v[12:13], v[16:17], v[18:19]
    v_pk_mul_f32 v[78:79], v[16:17], v[16:17]
    v_pk_fma_f32 v[78:79], v[18:19], v[18:19], v[78:79]
    v_pk_add_f32 v[12:13], v[12:13], v[20:21]
    v_pk_fma_f32 v[78:79], v[20:21], v[20:21], v[78:79]
    v_pk_add_f32 v[12:13], v[12:13], v[22:23]
    v_pk_fma_f32 v[78:79], v[22:23], v[22:23], v[78:79]
    v_pk_add_f32 v[12:13], v[12:13], v[24:25]
    v_pk_fma_f32 v[78:79], v[24:25], v[24:25], v[78:79]
    v_pk_add_f32 v[12:13], v[12:13], v[26:27]
    v_pk_fma_f32 v[78:79], v[26:27], v[26:27], v[78:79]
    v_pk_add_f32 v[12:13], v[12:13], v[28:29]
    v_pk_fma_f32 v[78:79], v[28:29], v[28:29], v[78:79]
    v_pk_add_f32 v[12:13], v[12:13], v[30:31]
    v_pk_fma_f32 v[78:79], v[30:31], v[30:31], v[78:79]
    v_add_f32 v12, v12, v13
    v_add_f32 v14, v78, v79
    s_nop 1
    v_permlane32_swap_b32 v12, v14
    v_add_f32 v14, v12, v14
    buffer_store_dword v14, v7, s[16:19], s36 offen
    ds_write_b128 v0, v[64:67] offset:0
    ds_write_b128 v0, v[68:71] offset:512
    s_lshl_b32 s44, s6, 14
    s_add_u32 s58, s34, s44
    s_waitcnt lgkmcnt(0)
    s_barrier
    ds_read_b128 v[88:91], v1 offset:0
    ds_read_b128 v[92:95], v1 offset:16384
    ds_read_b128 v[96:99], v1 offset:32768
    ds_read_b128 v[100:103], v1 offset:49152
    s_waitcnt lgkmcnt(3)
    v_mfma_f32_16x16x32_bf16 v[32:35], a[0:3], v[88:91], 0
    ds_read_b128 v[104:107], v1 offset:1024
    v_mov_b32 v248, 0x3f803f80
    v_mfma_f32_16x16x32_bf16 v[48:51], a[4:7], v[88:91], 0
    v_mov_b32 v249, 0x3f803f80
    v_mov_b32 v250, 0x3f803f80
    v_mfma_f32_16x16x32_bf16 v[72:75], v[88:91], a[8:11], 0
    s_waitcnt lgkmcnt(3)
    v_mov_b32 v251, 0x3f803f80
    s_mul_i32 s3, s6, 192
    v_mfma_f32_16x16x32_bf16 v[36:39], a[0:3], v[92:95], 0
    ds_read_b128 v[88:91], v1 offset:17408
    s_add_u32 s3, s3, 1024
    v_mfma_f32_16x16x32_bf16 v[52:55], a[4:7], v[92:95], 0
    v_mov_b32 v11, 4
    s_mov_b64 exec, 1
    s_waitcnt vmcnt(0)
    buffer_store_dword v11, off, s[16:19], s40
    s_mov_b64 exec, -1
    v_mfma_f32_16x16x32_bf16 v[76:79], v[92:95], a[8:11], 0
    s_waitcnt lgkmcnt(3)
    v_add_u32 v13, s3, v10
    s_add_u32 s3, s3, 81024
    v_mfma_f32_16x16x32_bf16 v[40:43], a[0:3], v[96:99], 0
    ds_read_b128 v[92:95], v1 offset:33792
    v_lshrrev_b32 v12, 1, v9
    v_mfma_f32_16x16x32_bf16 v[56:59], a[4:7], v[96:99], 0
    v_add_u32 v12, s3, v12
    v_mfma_f32_16x16x32_bf16 v[80:83], v[96:99], a[8:11], 0
    s_waitcnt lgkmcnt(3)
    ds_read_b128 v[236:239], v13 offset:0
    v_mfma_f32_16x16x32_bf16 v[44:47], a[0:3], v[100:103], 0
    ds_read_b128 v[96:99], v1 offset:50176
    v_mfma_f32_16x16x32_bf16 v[60:63], a[4:7], v[100:103], 0
    ds_read_b128 v[240:243], v13 offset:64
    v_mfma_f32_16x16x32_bf16 v[84:87], v[100:103], a[8:11], 0
    s_waitcnt lgkmcnt(5)
    ds_read_b32 v244, v12
    v_mfma_f32_16x16x32_bf16 v[32:35], a[12:15], v[104:107], v[32:35]
    v_mfma_f32_16x16x32_bf16 v[48:51], a[16:19], v[104:107], v[48:51]
    v_mfma_f32_16x16x32_bf16 v[72:75], v[104:107], a[20:23], v[72:75]
    s_waitcnt lgkmcnt(5)
    v_mfma_f32_16x16x32_bf16 v[36:39], a[12:15], v[88:91], v[36:39]
    v_mfma_f32_16x16x32_bf16 v[52:55], a[16:19], v[88:91], v[52:55]
    v_mfma_f32_16x16x32_bf16 v[76:79], v[88:91], a[20:23], v[76:79]
    s_waitcnt lgkmcnt(4)
    v_mfma_f32_16x16x32_bf16 v[40:43], a[12:15], v[92:95], v[40:43]
    v_mfma_f32_16x16x32_bf16 v[56:59], a[16:19], v[92:95], v[56:59]
    buffer_load_dword v11, v6, s[16:19], s39 offen sc1
    v_mfma_f32_16x16x32_bf16 v[80:83], v[92:95], a[20:23], v[80:83]
    s_waitcnt lgkmcnt(2)
    v_mfma_f32_16x16x32_bf16 v[44:47], a[12:15], v[96:99], v[44:47]
    v_mfma_f32_16x16x32_bf16 v[60:63], a[16:19], v[96:99], v[60:63]
    v_mfma_f32_16x16x32_bf16 v[84:87], v[96:99], a[20:23], v[84:87]
    s_bfe_u32 s3, s56, 196612
    s_lshl_b32 s3, s3, 11
    s_add_u32 m0, s44, 2048
    s_add_u32 s57, s3, s58
    s_waitcnt vmcnt(0)
    v_cmp_gt_i32 vcc, 4, v11
    s_cbranch_vccnz LF_spin_13
LF_got_14:
    buffer_load_dwordx4 v1, s[16:19], s57 offen offset:0 sc1 lds
    buffer_load_dwordx4 v1, s[16:19], s57 offen offset:1024 sc1 lds
    s_bfe_u32 s3, s56, 196616
    s_lshl_b32 s3, s3, 11
    s_add_u32 m0, s44, 4096
    s_add_u32 s57, s3, s58
    buffer_load_dwordx4 v1, s[16:19], s57 offen offset:0 sc1 lds
    s_waitcnt vmcnt(2)
    s_barrier
    ds_read_b128 v[88:91], v1 offset:2048
    ds_read_b128 v[92:95], v1 offset:18432
    ds_read_b128 v[96:99], v1 offset:34816
    ds_read_b128 v[100:103], v1 offset:51200
    s_waitcnt lgkmcnt(3)
    v_mfma_f32_16x16x32_bf16 v[32:35], a[24:27], v[88:91], v[32:35]
    s_waitcnt vmcnt(1)
    s_barrier
    ds_read_b128 v[104:107], v1 offset:3072
    v_mfma_f32_16x16x32_bf16 v[48:51], a[28:31], v[88:91], v[48:51]
    buffer_load_dwordx4 v1, s[16:19], s57 offen offset:1024 sc1 lds
    v_mfma_f32_16x16x32_bf16 v[72:75], v[88:91], a[32:35], v[72:75]
    s_waitcnt lgkmcnt(3)
    v_mov_b32 v11, 0xffff
    v_mov_b32 v12, 0xffff0000
    v_mfma_f32_16x16x32_bf16 v[36:39], a[24:27], v[92:95], v[36:39]
    ds_read_b128 v[88:91], v1 offset:19456
    v_cndmask_b32 v11, v11, v12, s[48:49]
    v_mfma_f32_16x16x32_bf16 v[52:55], a[28:31], v[92:95], v[52:55]
    s_bfe_u32 s3, s56, 196620
    s_lshl_b32 s3, s3, 11
    s_add_u32 m0, s44, 6144
    s_add_u32 s57, s3, s58
    buffer_load_dwordx4 v1, s[16:19], s57 offen offset:0 sc1 lds
    v_mfma_f32_16x16x32_bf16 v[76:79], v[92:95], a[32:35], v[76:79]
    s_waitcnt lgkmcnt(3)
    v_cndmask_b32 v252, v11, 0, s[50:51]
    v_cndmask_b32 v253, v11, 0, s[52:53]
    v_mfma_f32_16x16x32_bf16 v[40:43], a[24:27], v[96:99], v[40:43]
    ds_read_b128 v[92:95], v1 offset:35840
    v_cndmask_b32 v254, 0, v11, s[50:51]
    v_mfma_f32_16x16x32_bf16 v[56:59], a[28:31], v[96:99], v[56:59]
    s_mov_b32 exec_lo, 0xffff0000
    s_mov_b32 exec_hi, 0xffff0000
    buffer_store_dwordx4 v[64:67], v5, s[16:19], s42 offen offset:0 sc1
    s_mov_b64 exec, -1
    v_mfma_f32_16x16x32_bf16 v[80:83], v[96:99], a[32:35], v[80:83]
    s_waitcnt lgkmcnt(3)
    v_cndmask_b32 v255, 0, v11, s[52:53]
    v_mfma_f32_16x16x32_bf16 v[44:47], a[24:27], v[100:103], v[44:47]
    ds_read_b128 v[96:99], v1 offset:52224
    v_mfma_f32_16x16x32_bf16 v[60:63], a[28:31], v[100:103], v[60:63]
    s_mov_b32 exec_lo, 0xffff0000
    s_mov_b32 exec_hi, 0xffff0000
    buffer_store_dwordx4 v[68:71], v5, s[16:19], s42 offen offset:512 sc1
    s_mov_b64 exec, -1
    v_mfma_f32_16x16x32_bf16 v[84:87], v[100:103], a[32:35], v[84:87]
    s_waitcnt lgkmcnt(3)
    v_mfma_f32_16x16x32_bf16 v[32:35], a[36:39], v[104:107], v[32:35]
    s_waitcnt vmcnt(4)
    s_barrier
    ds_read_b128 v[100:103], v1 offset:4096
    v_mfma_f32_16x16x32_bf16 v[48:51], a[40:43], v[104:107], v[48:51]
    s_mov_b32 exec_lo, 0xffff0000
    s_mov_b32 exec_hi, 0xffff0000
    buffer_store_dword v14, v7, s[16:19], s96 offen offset:2048 sc1
    s_mov_b64 exec, -1
    v_mfma_f32_16x16x32_bf16 v[72:75], v[104:107], a[44:47], v[72:75]
    s_waitcnt lgkmcnt(3)
    v_mfma_f32_16x16x32_bf16 v[36:39], a[36:39], v[88:91], v[36:39]
    ds_read_b128 v[104:107], v1 offset:20480
    v_mfma_f32_16x16x32_bf16 v[52:55], a[40:43], v[88:91], v[52:55]
    buffer_load_dwordx4 v1, s[16:19], s57 offen offset:1024 sc1 lds
    v_mfma_f32_16x16x32_bf16 v[76:79], v[88:91], a[44:47], v[76:79]
    s_waitcnt lgkmcnt(3)
    v_mfma_f32_16x16x32_bf16 v[40:43], a[36:39], v[92:95], v[40:43]
    ds_read_b128 v[88:91], v1 offset:36864
    v_mfma_f32_16x16x32_bf16 v[56:59], a[40:43], v[92:95], v[56:59]
    s_bfe_u32 s3, s56, 196624
    s_lshl_b32 s3, s3, 11
    s_add_u32 m0, s44, 8192
    s_add_u32 s57, s3, s58
    buffer_load_dwordx4 v1, s[16:19], s57 offen offset:0 sc1 lds
    v_mfma_f32_16x16x32_bf16 v[80:83], v[92:95], a[44:47], v[80:83]
    s_waitcnt lgkmcnt(3)
    v_mfma_f32_16x16x32_bf16 v[44:47], a[36:39], v[96:99], v[44:47]
    ds_read_b128 v[92:95], v1 offset:53248
    v_mfma_f32_16x16x32_bf16 v[60:63], a[40:43], v[96:99], v[60:63]
    v_mfma_f32_16x16x32_bf16 v[84:87], v[96:99], a[44:47], v[84:87]
    s_waitcnt lgkmcnt(3)
    v_mfma_f32_16x16x32_bf16 v[32:35], a[48:51], v[100:103], v[32:35]
    s_waitcnt vmcnt(5)
    s_barrier
    ds_read_b128 v[96:99], v1 offset:5120
    v_mfma_f32_16x16x32_bf16 v[48:51], a[52:55], v[100:103], v[48:51]
    buffer_load_dwordx4 v1, s[16:19], s57 offen offset:1024 sc1 lds
    v_mfma_f32_16x16x32_bf16 v[72:75], v[100:103], a[56:59], v[72:75]
    s_waitcnt lgkmcnt(3)
    v_mfma_f32_16x16x32_bf16 v[36:39], a[48:51], v[104:107], v[36:39]
    ds_read_b128 v[100:103], v1 offset:21504
    v_mfma_f32_16x16x32_bf16 v[52:55], a[52:55], v[104:107], v[52:55]
    s_bfe_u32 s3, s56, 196628
    s_lshl_b32 s3, s3, 11
    s_add_u32 m0, s44, 10240
    s_add_u32 s57, s3, s58
    buffer_load_dwordx4 v1, s[16:19], s57 offen offset:0 sc1 lds
    v_mfma_f32_16x16x32_bf16 v[76:79], v[104:107], a[56:59], v[76:79]
    s_waitcnt lgkmcnt(3)
    v_mfma_f32_16x16x32_bf16 v[40:43], a[48:51], v[88:91], v[40:43]
    ds_read_b128 v[104:107], v1 offset:37888
    v_mfma_f32_16x16x32_bf16 v[56:59], a[52:55], v[88:91], v[56:59]
    buffer_load_dwordx4 v1, s[16:19], s57 offen offset:1024 sc1 lds
    v_mfma_f32_16x16x32_bf16 v[80:83], v[88:91], a[56:59], v[80:83]
    s_waitcnt lgkmcnt(3)
    v_mfma_f32_16x16x32_bf16 v[44:47], a[48:51], v[92:95], v[44:47]
    ds_read_b128 v[88:91], v1 offset:54272
    v_mfma_f32_16x16x32_bf16 v[60:63], a[52:55], v[92:95], v[60:63]
    v_mfma_f32_16x16x32_bf16 v[84:87], v[92:95], a[56:59], v[84:87]
    s_waitcnt lgkmcnt(3)
    v_mfma_f32_16x16x32_bf16 v[32:35], a[60:63], v[96:99], v[32:35]
    ds_read_b128 v[92:95], v1 offset:6144
    v_mfma_f32_16x16x32_bf16 v[48:51], a[64:67], v[96:99], v[48:51]
    s_bfe_u32 s3, s56, 196632
    s_lshl_b32 s3, s3, 11
    s_add_u32 m0, s44, 12288
    s_add_u32 s57, s3, s58
    buffer_load_dwordx4 v1, s[16:19], s57 offen offset:0 sc1 lds
    v_mfma_f32_16x16x32_bf16 v[72:75], v[96:99], a[68:71], v[72:75]
    s_waitcnt lgkmcnt(3)
    v_mfma_f32_16x16x32_bf16 v[36:39], a[60:63], v[100:103], v[36:39]
    ds_read_b128 v[96:99], v1 offset:22528
    v_mfma_f32_16x16x32_bf16 v[52:55], a[64:67], v[100:103], v[52:55]
    buffer_load_dwordx4 v1, s[16:19], s57 offen offset:1024 sc1 lds
    v_mfma_f32_16x16x32_bf16 v[76:79], v[100:103], a[68:71], v[76:79]
L_pad5:
    s_cbranch_execz L_body
    s_waitcnt lgkmcnt(3)
    v_mfma_f32_16x16x32_bf16 v[40:43], a[60:63], v[104:107], v[40:43]
    ds_read_b128 v[100:103], v1 offset:38912
    v_mfma_f32_16x16x32_bf16 v[56:59], a[64:67], v[104:107], v[56:59]
    s_bfe_u32 s3, s56, 196636
    s_lshl_b32 s3, s3, 11
    s_add_u32 m0, s44, 14336
    s_add_u32 s57, s3, s58
    buffer_load_dwordx4 v1, s[16:19], s57 offen offset:0 sc1 lds
    v_mfma_f32_16x16x32_bf16 v[80:83], v[104:107], a[68:71], v[80:83]
    s_waitcnt lgkmcnt(3)
    v_mfma_f32_16x16x32_bf16 v[44:47], a[60:63], v[88:91], v[44:47]
    ds_read_b128 v[104:107], v1 offset:55296
    v_mfma_f32_16x16x32_bf16 v[60:63], a[64:67], v[88:91], v[60:63]
    v_mfma_f32_16x16x32_bf16 v[84:87], v[88:91], a[68:71], v[84:87]
    s_waitcnt lgkmcnt(3)
    v_mfma_f32_16x16x32_bf16 v[32:35], a[72:75], v[92:95], v[32:35]
    s_waitcnt vmcnt(4)
    s_barrier
    ds_read_b128 v[88:91], v1 offset:7168
    v_mfma_f32_16x16x32_bf16 v[48:51], a[76:79], v[92:95], v[48:51]
    buffer_load_dwordx4 v1, s[16:19], s57 offen offset:1024 sc1 lds
    v_mfma_f32_16x16x32_bf16 v[72:75], v[92:95], a[80:83], v[72:75]
    s_waitcnt lgkmcnt(3)
    v_mfma_f32_16x16x32_bf16 v[36:39], a[72:75], v[96:99], v[36:39]
    ds_read_b128 v[92:95], v1 offset:23552
    v_mfma_f32_16x16x32_bf16 v[52:55], a[76:79], v[96:99], v[52:55]
    buffer_load_dwordx4 v[108:111], v8, s[16:19], s37 offen offset:0 sc1
    v_mfma_f32_16x16x32_bf16 v[76:79], v[96:99], a[80:83], v[76:79]
    s_waitcnt lgkmcnt(3)
    v_mfma_f32_16x16x32_bf16 v[40:43], a[72:75], v[100:103], v[40:43]
    ds_read_b128 v[96:99], v1 offset:39936
    v_mfma_f32_16x16x32_bf16 v[56:59], a[76:79], v[100:103], v[56:59]
    buffer_load_dwordx4 v[112:115], v8, s[16:19], s37 offen offset:1024 sc1
    v_mfma_f32_16x16x32_bf16 v[80:83], v[100:103], a[80:83], v[80:83]
    s_waitcnt lgkmcnt(3)
    v_mfma_f32_16x16x32_bf16 v[44:47], a[72:75], v[104:107], v[44:47]
    ds_read_b128 v[100:103], v1 offset:56320
    v_mfma_f32_16x16x32_bf16 v[60:63], a[76:79], v[104:107], v[60:63]
    buffer_load_dwordx4 v[16:19], v1, s[16:19], s97 offen offset:0 sc1
    v_mfma_f32_16x16x32_bf16 v[84:87], v[104:107], a[80:83], v[84:87]
    s_waitcnt lgkmcnt(3)
    v_mfma_f32_16x16x32_bf16 v[32:35], a[84:87], v[88:91], v[32:35]
    ds_read_b128 v[104:107], v1 offset:8192
    v_mfma_f32_16x16x32_bf16 v[48:51], a[88:91], v[88:91], v[48:51]
    buffer_load_dwordx4 v[20:23], v1, s[16:19], s97 offen offset:1024 sc1
    v_mfma_f32_16x16x32_bf16 v[72:75], v[88:91], a[92:95], v[72:75]
    s_waitcnt lgkmcnt(3)
    v_mfma_f32_16x16x32_bf16 v[36:39], a[84:87], v[92:95], v[36:39]
    ds_read_b128 v[88:91], v1 offset:24576
    v_mfma_f32_16x16x32_bf16 v[52:55], a[88:91], v[92:95], v[52:55]
    buffer_load_dwordx4 v[24:27], v1, s[16:19], s98 offen offset:0 sc1
    v_mfma_f32_16x16x32_bf16 v[76:79], v[92:95], a[92:95], v[76:79]
    s_waitcnt lgkmcnt(3)
    v_mfma_f32_16x16x32_bf16 v[40:43], a[84:87], v[96:99], v[40:43]
    ds_read_b128 v[92:95], v1 offset:40960
    v_mfma_f32_16x16x32_bf16 v[56:59], a[88:91], v[96:99], v[56:59]
    buffer_load_dwordx4 v[28:31], v1, s[16:19], s98 offen offset:1024 sc1
    v_mfma_f32_16x16x32_bf16 v[80:83], v[96:99], a[92:95], v[80:83]
    s_waitcnt lgkmcnt(3)
    v_mfma_f32_16x16x32_bf16 v[44:47], a[84:87], v[100:103], v[44:47]
    ds_read_b128 v[96:99], v1 offset:57344
    v_mfma_f32_16x16x32_bf16 v[60:63], a[88:91], v[100:103], v[60:63]
    buffer_load_dwordx4 v[116:119], v124, s[16:19], s38 offen offset:2048 sc1
    v_mfma_f32_16x16x32_bf16 v[84:87], v[100:103], a[92:95], v[84:87]
    s_waitcnt lgkmcnt(3)
    v_mfma_f32_16x16x32_bf16 v[32:35], a[96:99], v[104:107], v[32:35]
    ds_read_b128 v[100:103], v1 offset:9216
    v_mfma_f32_16x16x32_bf16 v[48:51], a[100:103], v[104:107], v[48:51]
    buffer_load_dwordx4 v[120:123], v124, s[16:19], s38 offen offset:2304 sc1
    v_mfma_f32_16x16x32_bf16 v[72:75], v[104:107], a[104:107], v[72:75]
    s_waitcnt lgkmcnt(3)
    v_mfma_f32_16x16x32_bf16 v[36:39], a[96:99], v[88:91], v[36:39]
    ds_read_b128 v[104:107], v1 offset:25600
    v_mfma_f32_16x16x32_bf16 v[52:55], a[100:103], v[88:91], v[52:55]
    v_mfma_f32_16x16x32_bf16 v[76:79], v[88:91], a[104:107], v[76:79]
    s_waitcnt lgkmcnt(3)
    v_mfma_f32_16x16x32_bf16 v[40:43], a[96:99], v[92:95], v[40:43]
    ds_read_b128 v[88:91], v1 offset:41984
    v_mfma_f32_16x16x32_bf16 v[56:59], a[100:103], v[92:95], v[56:59]
    s_bfe_u32 s55, s56, 196608
    v_lshl_add_u32 v4, s55, 11, v1
    buffer_load_dwordx4 a[0:3], v4, s[20:23], s30 offen offset:0
    v_mfma_f32_16x16x32_bf16 v[80:83], v[92:95], a[104:107], v[80:83]
    s_waitcnt lgkmcnt(3)
    v_mfma_f32_16x16x32_bf16 v[44:47], a[96:99], v[96:99], v[44:47]
    ds_read_b128 v[92:95], v1 offset:58368
    v_mfma_f32_16x16x32_bf16 v[60:63], a[100:103], v[96:99], v[60:63]
    v_mfma_f32_16x16x32_bf16 v[84:87], v[96:99], a[104:107], v[84:87]
    s_waitcnt lgkmcnt(3)
    v_mfma_f32_16x16x32_bf16 v[32:35], a[108:111], v[100:103], v[32:35]
    ds_read_b128 v[96:99], v1 offset:10240
    v_mfma_f32_16x16x32_bf16 v[48:51], a[112:115], v[100:103], v[48:51]
    buffer_load_dwordx4 a[12:15], v4, s[20:23], s31 offen offset:0
    v_mfma_f32_16x16x32_bf16 v[72:75], v[100:103], a[116:119], v[72:75]
    s_waitcnt lgkmcnt(3)
    v_mfma_f32_16x16x32_bf16 v[36:39], a[108:111], v[104:107], v[36:39]
    ds_read_b128 v[100:103], v1 offset:26624
    v_mfma_f32_16x16x32_bf16 v[52:55], a[112:115], v[104:107], v[52:55]
    v_mfma_f32_16x16x32_bf16 v[76:79], v[104:107], a[116:119], v[76:79]
    s_waitcnt lgkmcnt(3)
    v_mfma_f32_16x16x32_bf16 v[40:43], a[108:111], v[88:91], v[40:43]
    ds_read_b128 v[104:107], v1 offset:43008
    v_mfma_f32_16x16x32_bf16 v[56:59], a[112:115], v[88:91], v[56:59]
    buffer_load_dwordx4 a[24:27], v4, s[20:23], s32 offen offset:0
    v_mfma_f32_16x16x32_bf16 v[80:83], v[88:91], a[116:119], v[80:83]
    s_waitcnt lgkmcnt(3)
    v_mfma_f32_16x16x32_bf16 v[44:47], a[108:111], v[92:95], v[44:47]
    ds_read_b128 v[88:91], v1 offset:59392
    v_mfma_f32_16x16x32_bf16 v[60:63], a[112:115], v[92:95], v[60:63]
    v_mfma_f32_16x16x32_bf16 v[84:87], v[92:95], a[116:119], v[84:87]
    s_waitcnt lgkmcnt(3)
    v_mfma_f32_16x16x32_bf16 v[32:35], a[120:123], v[96:99], v[32:35]
    s_waitcnt vmcnt(11)
    s_barrier
    ds_read_b128 v[92:95], v1 offset:11264
    v_mfma_f32_16x16x32_bf16 v[48:51], a[124:127], v[96:99], v[48:51]
    buffer_load_dwordx4 a[36:39], v4, s[20:23], s30 offen offset:1024
    v_mfma_f32_16x16x32_bf16 v[72:75], v[96:99], a[128:131], v[72:75]
    s_waitcnt lgkmcnt(3)
    v_mfma_f32_16x16x32_bf16 v[36:39], a[120:123], v[100:103], v[36:39]
    ds_read_b128 v[96:99], v1 offset:27648
    v_mfma_f32_16x16x32_bf16 v[52:55], a[124:127], v[100:103], v[52:55]
    v_mfma_f32_16x16x32_bf16 v[76:79], v[100:103], a[128:131], v[76:79]
    s_waitcnt lgkmcnt(3)
    v_mfma_f32_16x16x32_bf16 v[40:43], a[120:123], v[104:107], v[40:43]
    ds_read_b128 v[100:103], v1 offset:44032
    v_mfma_f32_16x16x32_bf16 v[56:59], a[124:127], v[104:107], v[56:59]
    buffer_load_dwordx4 a[48:51], v4, s[20:23], s31 offen offset:1024
    v_mfma_f32_16x16x32_bf16 v[80:83], v[104:107], a[128:131], v[80:83]
    s_waitcnt lgkmcnt(3)
    v_mfma_f32_16x16x32_bf16 v[44:47], a[120:123], v[88:91], v[44:47]
    ds_read_b128 v[104:107], v1 offset:60416
    v_mfma_f32_16x16x32_bf16 v[60:63], a[124:127], v[88:91], v[60:63]
    v_mfma_f32_16x16x32_bf16 v[84:87], v[88:91], a[128:131], v[84:87]
    s_waitcnt lgkmcnt(3)
    v_mfma_f32_16x16x32_bf16 v[32:35], a[132:135], v[92:95], v[32:35]
    ds_read_b128 v[88:91], v1 offset:12288
    v_mfma_f32_16x16x32_bf16 v[48:51], a[136:139], v[92:95], v[48:51]
    buffer_load_dwordx4 a[60:63], v4, s[20:23], s32 offen offset:1024
    v_mfma_f32_16x16x32_bf16 v[72:75], v[92:95], a[140:143], v[72:75]
    s_waitcnt lgkmcnt(3)
    v_mfma_f32_16x16x32_bf16 v[36:39], a[132:135], v[96:99], v[36:39]
    ds_read_b128 v[92:95], v1 offset:28672
    v_mfma_f32_16x16x32_bf16 v[52:55], a[136:139], v[96:99], v[52:55]
    v_mfma_f32_16x16x32_bf16 v[76:79], v[96:99], a[140:143], v[76:79]
    s_waitcnt lgkmcnt(3)
    v_mfma_f32_16x16x32_bf16 v[40:43], a[132:135], v[100:103], v[40:43]
    ds_read_b128 v[96:99], v1 offset:45056
    v_mfma_f32_16x16x32_bf16 v[56:59], a[136:139], v[100:103], v[56:59]
    s_bfe_u32 s55, s56, 196612
    v_lshl_add_u32 v4, s55, 11, v1
    buffer_load_dwordx4 a[72:75], v4, s[20:23], s30 offen offset:0
    v_mfma_f32_16x16x32_bf16 v[80:83], v[100:103], a[140:143], v[80:83]
    s_waitcnt lgkmcnt(3)
    v_mfma_f32_16x16x32_bf16 v[44:47], a[132:135], v[104:107], v[44:47]
    ds_read_b128 v[100:103], v1 offset:61440
    v_mfma_f32_16x16x32_bf16 v[60:63], a[136:139], v[104:107], v[60:63]
    v_mfma_f32_16x16x32_bf16 v[84:87], v[104:107], a[140:143], v[84:87]
    s_waitcnt lgkmcnt(3)
    v_mfma_f32_16x16x32_bf16 v[32:35], a[144:147], v[88:91], v[32:35]
    ds_read_b128 v[104:107], v1 offset:13312
    v_mfma_f32_16x16x32_bf16 v[48:51], a[148:151], v[88:91], v[48:51]
    buffer_load_dwordx4 a[84:87], v4, s[20:23], s31 offen offset:0
    v_mfma_f32_16x16x32_bf16 v[72:75], v[88:91], a[152:155], v[72:75]
    s_waitcnt lgkmcnt(3)
    s_waitcnt vmcnt(8)
    v_max3_u32 v11, v16, v17, v18
    v_mfma_f32_16x16x32_bf16 v[36:39], a[144:147], v[92:95], v[36:39]
    ds_read_b128 v[88:91], v1 offset:29696
    v_max3_u32 v11, v11, v19, v20
    v_mfma_f32_16x16x32_bf16 v[52:55], a[148:151], v[92:95], v[52:55]
    v_max3_u32 v11, v11, v21, v22
    v_max3_u32 v11, v11, v23, v24
    v_mfma_f32_16x16x32_bf16 v[76:79], v[92:95], a[152:155], v[76:79]
    s_waitcnt lgkmcnt(3)
    v_max3_u32 v11, v11, v25, v26
    v_max3_u32 v11, v11, v27, v28
    v_mfma_f32_16x16x32_bf16 v[40:43], a[144:147], v[96:99], v[40:43]
    ds_read_b128 v[92:95], v1 offset:46080
    v_max3_u32 v11, v11, v29, v30
    v_mfma_f32_16x16x32_bf16 v[56:59], a[148:151], v[96:99], v[56:59]
    buffer_load_dwordx4 a[96:99], v4, s[20:23], s32 offen offset:0
    v_mfma_f32_16x16x32_bf16 v[80:83], v[96:99], a[152:155], v[80:83]
    s_waitcnt lgkmcnt(3)
    v_max3_u32 v11, v11, v31, v116
    v_max3_u32 v11, v11, v117, v118
    v_mfma_f32_16x16x32_bf16 v[44:47], a[144:147], v[100:103], v[44:47]
    ds_read_b128 v[96:99], v1 offset:62464
    v_max3_u32 v11, v11, v119, v120
    v_mfma_f32_16x16x32_bf16 v[60:63], a[148:151], v[100:103], v[60:63]
    v_max3_u32 v11, v11, v121, v122
    v_max_u32 v11, v11, v123
    v_mfma_f32_16x16x32_bf16 v[84:87], v[100:103], a[152:155], v[84:87]
    s_waitcnt lgkmcnt(3)
    v_lshl_add_u32 v13, s6, 12, v2
    v_mfma_f32_16x16x32_bf16 v[32:35], a[156:159], v[104:107], v[32:35]
    ds_read_b128 v[100:103], v1 offset:14336
    v_mfma_f32_16x16x32_bf16 v[48:51], a[160:163], v[104:107], v[48:51]
    buffer_load_dwordx4 a[108:111], v4, s[20:23], s30 offen offset:1024
    v_mfma_f32_16x16x32_bf16 v[72:75], v[104:107], a[164:167], v[72:75]
    s_waitcnt lgkmcnt(3)
    v_cmp_eq_u32 vcc, -1, v11
    s_cbranch_vccnz LF_retry_15
LF_got_16:
    v_mfma_f32_16x16x32_bf16 v[36:39], a[156:159], v[88:91], v[36:39]
    ds_read_b128 v[104:107], v1 offset:30720
    v_mfma_f32_16x16x32_bf16 v[52:55], a[160:163], v[88:91], v[52:55]
    ds_write_b128 v13, v[16:19] offset:0
    v_mfma_f32_16x16x32_bf16 v[76:79], v[88:91], a[164:167], v[76:79]
    s_waitcnt lgkmcnt(4)
    v_add_f32 v108, v108, v110
    v_add_f32 v109, v109, v111
    v_mfma_f32_16x16x32_bf16 v[40:43], a[156:159], v[92:95], v[40:43]
    ds_read_b128 v[88:91], v1 offset:47104
    v_mfma_f32_16x16x32_bf16 v[56:59], a[160:163], v[92:95], v[56:59]
    buffer_load_dwordx4 a[120:123], v4, s[20:23], s31 offen offset:1024
    v_mfma_f32_16x16x32_bf16 v[80:83], v[92:95], a[164:167], v[80:83]
    s_waitcnt lgkmcnt(4)
    ds_write_b128 v13, v[20:23] offset:1024
    v_mfma_f32_16x16x32_bf16 v[44:47], a[156:159], v[96:99], v[44:47]
    ds_read_b128 v[92:95], v1 offset:63488
    v_add_f32 v112, v112, v114
    v_mfma_f32_16x16x32_bf16 v[60:63], a[160:163], v[96:99], v[60:63]
    v_add_f32 v113, v113, v115
    v_mfma_f32_16x16x32_bf16 v[84:87], v[96:99], a[164:167], v[84:87]
    s_waitcnt lgkmcnt(5)
    ds_write_b128 v13, v[24:27] offset:2048
    v_mfma_f32_16x16x32_bf16 v[32:35], a[168:171], v[100:103], v[32:35]
    ds_read_b128 v[96:99], v1 offset:15360
    v_add_f32 v108, v108, v112
    v_mfma_f32_16x16x32_bf16 v[48:51], a[172:175], v[100:103], v[48:51]
    buffer_load_dwordx4 a[132:135], v4, s[20:23], s32 offen offset:1024
    v_mfma_f32_16x16x32_bf16 v[72:75], v[100:103], a[176:179], v[72:75]
    s_waitcnt lgkmcnt(6)
    v_add_f32 v109, v109, v113
    v_mfma_f32_16x16x32_bf16 v[36:39], a[168:171], v[104:107], v[36:39]
    ds_read_b128 v[100:103], v1 offset:31744
    v_mfma_f32_16x16x32_bf16 v[52:55], a[172:175], v[104:107], v[52:55]
    ds_write_b128 v13, v[28:31] offset:3072
    v_mfma_f32_16x16x32_bf16 v[76:79], v[104:107], a[176:179], v[76:79]
    s_waitcnt lgkmcnt(6)
    v_add_f32 v116, v116, v118
    v_add_f32 v117, v117, v119
    v_mfma_f32_16x16x32_bf16 v[40:43], a[168:171], v[88:91], v[40:43]
    ds_read_b128 v[104:107], v1 offset:48128
    v_add_f32 v120, v120, v122
    v_mfma_f32_16x16x32_bf16 v[56:59], a[172:175], v[88:91], v[56:59]
    s_bfe_u32 s55, s56, 196616
    v_lshl_add_u32 v4, s55, 11, v1
    buffer_load_dwordx4 a[144:147], v4, s[20:23], s30 offen offset:0
    v_mfma_f32_16x16x32_bf16 v[80:83], v[88:91], a[176:179], v[80:83]
    s_waitcnt lgkmcnt(5)
    v_add_f32 v121, v121, v123
    v_add_f32 v116, v116, v120
    v_mfma_f32_16x16x32_bf16 v[44:47], a[168:171], v[92:95], v[44:47]
    ds_read_b128 v[88:91], v1 offset:64512
    v_add_f32 v117, v117, v121
    v_mfma_f32_16x16x32_bf16 v[60:63], a[172:175], v[92:95], v[60:63]
    v_lshl_add_u32 v110, s6, 7, v9
    v_add_u32 v111, 512, v9
    v_mfma_f32_16x16x32_bf16 v[84:87], v[92:95], a[176:179], v[84:87]
    s_waitcnt lgkmcnt(4)
    v_permlane32_swap_b32 v108, v116
    v_mfma_f32_16x16x32_bf16 v[32:35], a[180:183], v[96:99], v[32:35]
    s_waitcnt lgkmcnt(2)
    s_barrier
    ds_read_b128 v[92:95], v2 offset:0
    v_mfma_f32_16x16x32_bf16 v[48:51], a[184:187], v[96:99], v[48:51]
    buffer_load_dwordx4 a[156:159], v4, s[20:23], s31 offen offset:0
    v_mfma_f32_16x16x32_bf16 v[72:75], v[96:99], a[188:191], v[72:75]
    v_permlane32_swap_b32 v109, v117
    v_mfma_f32_16x16x32_bf16 v[36:39], a[180:183], v[100:103], v[36:39]
    ds_read_b128 v[96:99], v2 offset:1024
    v_add_f32 v112, v108, v116
    v_mfma_f32_16x16x32_bf16 v[52:55], a[184:187], v[100:103], v[52:55]
    v_add_f32 v113, v109, v117
    v_mfma_f32_16x16x32_bf16 v[76:79], v[100:103], a[188:191], v[76:79]
    s_waitcnt lgkmcnt(3)
    v_permlane32_swap_b32 v110, v111
    v_mfma_f32_16x16x32_bf16 v[40:43], a[180:183], v[104:107], v[40:43]
    ds_read_b128 v[100:103], v2 offset:2048
    v_mfma_f32_16x16x32_bf16 v[56:59], a[184:187], v[104:107], v[56:59]
    buffer_load_dwordx4 a[168:171], v4, s[20:23], s32 offen offset:0
    v_mfma_f32_16x16x32_bf16 v[80:83], v[104:107], a[188:191], v[80:83]
    s_waitcnt lgkmcnt(3)
    v_permlane16_swap_b32 v112, v113
    v_mfma_f32_16x16x32_bf16 v[44:47], a[180:183], v[88:91], v[44:47]
    ds_read_b128 v[104:107], v2 offset:3072
    v_add_f32 v108, v112, v113
    v_mfma_f32_16x16x32_bf16 v[60:63], a[184:187], v[88:91], v[60:63]
    v_add_f32 v109, v112, v113
    v_lshrrev_b32 v111, 1, v110
    v_mfma_f32_16x16x32_bf16 v[84:87], v[88:91], a[188:191], v[84:87]
    s_waitcnt lgkmcnt(3)
    v_add_u32 v111, 80896, v111
    v_mfma_f32_16x16x32_bf16 v[64:67], a[4:7], v[92:95], 0
    ds_read_b128 v[88:91], v2 offset:4096
    v_mfma_f32_16x16x32_bf16 v[68:71], v[92:95], a[8:11], 0
    s_waitcnt lgkmcnt(3)
    v_permlane16_swap_b32 v108, v109
    v_mfma_f32_16x16x32_bf16 v[64:67], a[16:19], v[96:99], v[64:67]
    ds_read_b128 v[92:95], v2 offset:5120
    v_mul_f32 v108, 0xbb000000, v108
    v_mfma_f32_16x16x32_bf16 v[68:71], v[96:99], a[20:23], v[68:71]
    s_waitcnt lgkmcnt(3)
    buffer_load_dwordx4 a[180:183], v4, s[20:23], s30 offen offset:1024
    v_mfma_f32_16x16x32_bf16 v[64:67], a[28:31], v[100:103], v[64:67]
    ds_read_b128 v[96:99], v2 offset:6144
    v_mul_f32 v109, 0x3b000000, v109
    v_mfma_f32_16x16x32_bf16 v[68:71], v[100:103], a[32:35], v[68:71]
    s_waitcnt lgkmcnt(3)
    v_fma_f32 v109, -v108, v108, v109
    v_max_f32 v109, 0, v109
    v_mfma_f32_16x16x32_bf16 v[64:67], a[40:43], v[104:107], v[64:67]
    ds_read_b128 v[100:103], v2 offset:7168
    v_add_f32 v109, 0x3727c5ac, v109
    v_mfma_f32_16x16x32_bf16 v[68:71], v[104:107], a[44:47], v[68:71]
    s_waitcnt lgkmcnt(3)
    buffer_load_dwordx4 a[4:7], v4, s[20:23], s31 offen offset:1024
    v_mfma_f32_16x16x32_bf16 v[64:67], a[52:55], v[88:91], v[64:67]
    ds_read_b128 v[104:107], v2 offset:8192
    v_mfma_f32_16x16x32_bf16 v[68:71], v[88:91], a[56:59], v[68:71]
    s_waitcnt lgkmcnt(3)
    v_rsq_f32 v109, v109
    v_mfma_f32_16x16x32_bf16 v[64:67], a[64:67], v[92:95], v[64:67]
    ds_read_b128 v[88:91], v2 offset:9216
    v_mfma_f32_16x16x32_bf16 v[68:71], v[92:95], a[68:71], v[68:71]
    s_waitcnt lgkmcnt(3)
    buffer_load_dwordx4 a[8:11], v4, s[20:23], s32 offen offset:1024
    v_mfma_f32_16x16x32_bf16 v[64:67], a[76:79], v[96:99], v[64:67]
    ds_read_b128 v[92:95], v2 offset:10240
    v_mfma_f32_16x16x32_bf16 v[68:71], v[96:99], a[80:83], v[68:71]
    s_waitcnt lgkmcnt(3)
    ds_write_b64 v110, v[108:109]
    v_mfma_f32_16x16x32_bf16 v[64:67], a[88:91], v[100:103], v[64:67]
    ds_read_b128 v[96:99], v2 offset:11264
    v_mfma_f32_16x16x32_bf16 v[68:71], v[100:103], a[92:95], v[68:71]
    s_waitcnt lgkmcnt(4)
    s_bfe_u32 s55, s56, 196620
    v_lshl_add_u32 v4, s55, 11, v1
    buffer_load_dwordx4 a[16:19], v4, s[20:23], s30 offen offset:0
    v_mfma_f32_16x16x32_bf16 v[64:67], a[100:103], v[104:107], v[64:67]
    ds_read_b128 v[100:103], v2 offset:12288
    v_mfma_f32_16x16x32_bf16 v[68:71], v[104:107], a[104:107], v[68:71]
    s_waitcnt lgkmcnt(4)
    ds_write2_b32 v111, v108, v109 offset0:0 offset1:128
    v_mfma_f32_16x16x32_bf16 v[64:67], a[112:115], v[88:91], v[64:67]
    ds_read_b128 v[104:107], v2 offset:13312
    v_mfma_f32_16x16x32_bf16 v[68:71], v[88:91], a[116:119], v[68:71]
    s_waitcnt lgkmcnt(5)
    buffer_load_dwordx4 a[20:23], v4, s[20:23], s31 offen offset:0
    v_mfma_f32_16x16x32_bf16 v[64:67], a[124:127], v[92:95], v[64:67]
    ds_read_b128 v[88:91], v2 offset:14336
    v_mfma_f32_16x16x32_bf16 v[68:71], v[92:95], a[128:131], v[68:71]
    s_waitcnt lgkmcnt(4)
    s_waitcnt lgkmcnt(0)
    s_barrier
    v_mfma_f32_16x16x32_bf16 v[64:67], a[136:139], v[96:99], v[64:67]
    ds_read_b128 v[92:95], v2 offset:15360
    v_mfma_f32_16x16x32_bf16 v[68:71], v[96:99], a[140:143], v[68:71]
    buffer_load_dwordx4 a[28:31], v4, s[20:23], s32 offen offset:0
    v_mfma_f32_16x16x32_bf16 v[64:67], a[148:151], v[100:103], v[64:67]
    ds_read_b128 v[108:111], v10 offset:256
    v_mfma_f32_16x16x32_bf16 v[68:71], v[100:103], a[152:155], v[68:71]
    ds_read_b128 v[112:115], v10 offset:768
    v_mfma_f32_16x16x32_bf16 v[64:67], a[160:163], v[104:107], v[64:67]
    ds_read_b128 v[116:119], v10 offset:0
    v_mfma_f32_16x16x32_bf16 v[68:71], v[104:107], a[164:167], v[68:71]
    buffer_load_dwordx4 a[32:35], v4, s[20:23], s30 offen offset:1024
    v_mfma_f32_16x16x32_bf16 v[64:67], a[172:175], v[88:91], v[64:67]
    ds_read_b128 v[120:123], v10 offset:512
    v_mfma_f32_16x16x32_bf16 v[68:71], v[88:91], a[176:179], v[68:71]
    s_waitcnt lgkmcnt(4)
    ds_read_b128 v[124:127], v10 offset:704
    v_mfma_f32_16x16x32_bf16 v[64:67], a[184:187], v[92:95], v[64:67]
    ds_read_b64 v[16:17], v9 offset:0
    v_mfma_f32_16x16x32_bf16 v[68:71], v[92:95], a[188:191], v[68:71]
    s_nop 0
    buffer_load_dwordx4 a[40:43], v4, s[20:23], s31 offen offset:1024
    ds_read_b64 v[18:19], v9 offset:128
    ds_read_b64 v[20:21], v9 offset:256
    ds_read_b64 v[22:23], v9 offset:384
    ds_read_b64 v[24:25], v9 offset:512
    ds_read_b128 v[88:91], v10 offset:64
    ds_read_b128 v[92:95], v10 offset:576
    ds_read_b128 v[96:99], v10 offset:128
    ds_read_b128 v[100:103], v10 offset:640
    ds_read_b128 v[104:107], v10 offset:192
    s_lshl2_add_u32 s3, s5, s6
    s_lshl_b32 s3, s3, 10
    s_add_u32 s3, s3, s35
    s_lshl_b32 s58, s25, 15
    s_xor_b32 s57, s58, 0x8000
    s_add_u32 s57, s57, s3
    s_add_u32 s58, s58, s3
    s_waitcnt lgkmcnt(5)
    s_nop 0
    v_pk_fma_f32 v[32:33], v[236:237], v[16:17], v[32:33] op_sel:[0,0,0] op_sel_hi:[1,0,1]
    v_pk_fma_f32 v[34:35], v[238:239], v[16:17], v[34:35] op_sel:[0,0,0] op_sel_hi:[1,0,1]
    v_cvt_pk_bf16_f32 v32, v32, v33
    v_cvt_pk_bf16_f32 v33, v34, v35
    v_pk_fma_f32 v[36:37], v[236:237], v[18:19], v[36:37] op_sel:[0,0,0] op_sel_hi:[1,0,1]
    v_pk_fma_f32 v[38:39], v[238:239], v[18:19], v[38:39] op_sel:[0,0,0] op_sel_hi:[1,0,1]
    v_cvt_pk_bf16_f32 v36, v36, v37
    v_cvt_pk_bf16_f32 v37, v38, v39
    v_pk_fma_f32 v[40:41], v[236:237], v[20:21], v[40:41] op_sel:[0,0,0] op_sel_hi:[1,0,1]
    v_pk_fma_f32 v[42:43], v[238:239], v[20:21], v[42:43] op_sel:[0,0,0] op_sel_hi:[1,0,1]
    v_cvt_pk_bf16_f32 v40, v40, v41
    v_cvt_pk_bf16_f32 v41, v42, v43
    v_pk_fma_f32 v[44:45], v[236:237], v[22:23], v[44:45] op_sel:[0,0,0] op_sel_hi:[1,0,1]
    v_pk_fma_f32 v[46:47], v[238:239], v[22:23], v[46:47] op_sel:[0,0,0] op_sel_hi:[1,0,1]
    v_cvt_pk_bf16_f32 v44, v44, v45
    v_cvt_pk_bf16_f32 v45, v46, v47
    v_pk_fma_f32 v[68:69], v[108:109], v[244:245], v[68:69] op_sel:[0,0,0] op_sel_hi:[1,0,1]
    v_pk_fma_f32 v[70:71], v[110:111], v[244:245], v[70:71] op_sel:[0,0,0] op_sel_hi:[1,0,1]
    v_pk_mul_f32 v[68:69], v[68:69], v[112:113]
    v_pk_mul_f32 v[70:71], v[70:71], v[114:115]
    v_cvt_pk_bf16_f32 v68, v68, v69
    v_cvt_pk_bf16_f32 v69, v70, v71
    buffer_load_dwordx4 a[44:47], v4, s[20:23], s32 offen offset:1024
    v_pk_fma_f32 v[72:73], v[116:117], v[244:245], v[72:73] op_sel:[0,0,0] op_sel_hi:[1,0,1]
    v_pk_fma_f32 v[74:75], v[118:119], v[244:245], v[74:75] op_sel:[0,0,0] op_sel_hi:[1,0,1]
    v_pk_mul_f32 v[72:73], v[72:73], v[120:121]
    v_pk_mul_f32 v[74:75], v[74:75], v[122:123]
    v_cvt_pk_bf16_f32 v70, v72, v73
    v_cvt_pk_bf16_f32 v71, v74, v75
    s_waitcnt lgkmcnt(0)
    s_nop 0
    v_pk_fma_f32 v[76:77], v[88:89], v[244:245], v[76:77] op_sel:[0,0,0] op_sel_hi:[1,0,1]
    v_pk_fma_f32 v[78:79], v[90:91], v[244:245], v[78:79] op_sel:[0,0,0] op_sel_hi:[1,0,1]
    v_pk_mul_f32 v[76:77], v[76:77], v[92:93]
    v_pk_mul_f32 v[78:79], v[78:79], v[94:95]
    v_cvt_pk_bf16_f32 v72, v76, v77
    v_cvt_pk_bf16_f32 v73, v78, v79
    v_pk_fma_f32 v[80:81], v[96:97], v[244:245], v[80:81] op_sel:[0,0,0] op_sel_hi:[1,0,1]
    v_pk_fma_f32 v[82:83], v[98:99], v[244:245], v[82:83] op_sel:[0,0,0] op_sel_hi:[1,0,1]
    v_pk_mul_f32 v[80:81], v[80:81], v[100:101]
    v_pk_mul_f32 v[82:83], v[82:83], v[102:103]
    v_cvt_pk_bf16_f32 v74, v80, v81
    v_cvt_pk_bf16_f32 v75, v82, v83
    s_bfe_u32 s55, s56, 196624
    v_lshl_add_u32 v4, s55, 11, v1
    buffer_load_dwordx4 a[52:55], v4, s[20:23], s30 offen offset:0
    v_pk_fma_f32 v[84:85], v[104:105], v[244:245], v[84:85] op_sel:[0,0,0] op_sel_hi:[1,0,1]
    v_pk_fma_f32 v[86:87], v[106:107], v[244:245], v[86:87] op_sel:[0,0,0] op_sel_hi:[1,0,1]
    v_pk_mul_f32 v[84:85], v[84:85], v[124:125]
    v_pk_mul_f32 v[86:87], v[86:87], v[126:127]
    v_cvt_pk_bf16_f32 v76, v84, v85
    v_cvt_pk_bf16_f32 v77, v86, v87
    v_pk_fma_f32 v[64:65], v[240:241], v[24:25], v[64:65] op_sel:[0,0,0] op_sel_hi:[1,0,1]
    v_pk_fma_f32 v[66:67], v[242:243], v[24:25], v[66:67] op_sel:[0,0,0] op_sel_hi:[1,0,1]
    v_pk_mul_f32 v[64:65], v[64:65], v[24:25] op_sel:[0,1] op_sel_hi:[1,1]
    v_pk_mul_f32 v[66:67], v[66:67], v[24:25] op_sel:[0,1] op_sel_hi:[1,1]
    v_cvt_pk_bf16_f32 v64, v64, v65
    v_cvt_pk_bf16_f32 v65, v66, v67
    v_pk_fma_f32 v[48:49], v[240:241], v[16:17], v[48:49] op_sel:[0,0,0] op_sel_hi:[1,0,1]
    v_pk_fma_f32 v[50:51], v[242:243], v[16:17], v[50:51] op_sel:[0,0,0] op_sel_hi:[1,0,1]
    v_pk_mul_f32 v[48:49], v[48:49], v[16:17] op_sel:[0,1] op_sel_hi:[1,1]
    v_pk_mul_f32 v[50:51], v[50:51], v[16:17] op_sel:[0,1] op_sel_hi:[1,1]
    v_cvt_pk_bf16_f32 v48, v48, v49
    v_cvt_pk_bf16_f32 v49, v50, v51
    buffer_load_dwordx4 a[56:59], v4, s[20:23], s31 offen offset:0
    v_pk_fma_f32 v[52:53], v[240:241], v[18:19], v[52:53] op_sel:[0,0,0] op_sel_hi:[1,0,1]
    v_pk_fma_f32 v[54:55], v[242:243], v[18:19], v[54:55] op_sel:[0,0,0] op_sel_hi:[1,0,1]
    v_pk_mul_f32 v[52:53], v[52:53], v[18:19] op_sel:[0,1] op_sel_hi:[1,1]
    v_pk_mul_f32 v[54:55], v[54:55], v[18:19] op_sel:[0,1] op_sel_hi:[1,1]
    v_cvt_pk_bf16_f32 v52, v52, v53
    v_cvt_pk_bf16_f32 v53, v54, v55
    v_pk_fma_f32 v[56:57], v[240:241], v[20:21], v[56:57] op_sel:[0,0,0] op_sel_hi:[1,0,1]
    v_pk_fma_f32 v[58:59], v[242:243], v[20:21], v[58:59] op_sel:[0,0,0] op_sel_hi:[1,0,1]
    v_pk_mul_f32 v[56:57], v[56:57], v[20:21] op_sel:[0,1] op_sel_hi:[1,1]
    v_pk_mul_f32 v[58:59], v[58:59], v[20:21] op_sel:[0,1] op_sel_hi:[1,1]
    v_cvt_pk_bf16_f32 v56, v56, v57
    v_cvt_pk_bf16_f32 v57, v58, v59
    v_pk_fma_f32 v[60:61], v[240:241], v[22:23], v[60:61] op_sel:[0,0,0] op_sel_hi:[1,0,1]
    v_pk_fma_f32 v[62:63], v[242:243], v[22:23], v[62:63] op_sel:[0,0,0] op_sel_hi:[1,0,1]
    v_pk_mul_f32 v[60:61], v[60:61], v[22:23] op_sel:[0,1] op_sel_hi:[1,1]
    v_pk_mul_f32 v[62:63], v[62:63], v[22:23] op_sel:[0,1] op_sel_hi:[1,1]
    v_cvt_pk_bf16_f32 v60, v60, v61
    v_cvt_pk_bf16_f32 v61, v62, v63
    buffer_load_dwordx4 a[64:67], v4, s[20:23], s32 offen offset:0
    v_mfma_f32_16x16x16_bf16 v[88:91], v[48:49], v[32:33], 0
    v_mul_f32 v16, 0x3eb8aa3b, v17
    v_mul_f32 v18, 0x3eb8aa3b, v19
    v_mfma_f32_16x16x16_bf16 v[92:95], v[64:65], v[32:33], 0
    v_mul_f32 v20, 0x3eb8aa3b, v21
    v_mul_f32 v22, 0x3eb8aa3b, v23
    v_mfma_f32_16x16x16_bf16 v[96:99], v[52:53], v[36:37], 0
    buffer_load_dwordx4 a[68:71], v4, s[20:23], s30 offen offset:1024
    v_mfma_f32_16x16x16_bf16 v[100:103], v[48:49], v[36:37], 0
    v_cndmask_b32 v88, v88, v89, s[48:49]
    v_cndmask_b32 v89, v90, v91, s[48:49]
    v_mfma_f32_16x16x16_bf16 v[104:107], v[56:57], v[40:41], 0
    v_cndmask_b32 v92, v92, v93, s[48:49]
    v_cndmask_b32 v93, v94, v95, s[48:49]
    v_mfma_f32_16x16x16_bf16 v[108:111], v[52:53], v[40:41], 0
    v_min_f32 v92, s45, v92
    v_min_f32 v93, s45, v93
    v_mfma_f32_16x16x16_bf16 v[112:115], v[60:61], v[44:45], 0
    v_cndmask_b32 v88, v92, v88, s[50:51]
    v_cndmask_b32 v89, v93, v89, s[52:53]
    v_mfma_f32_16x16x16_bf16 v[116:119], v[56:57], v[44:45], 0
    v_max_f32_e64 v34, v88, v89
    v_cndmask_b32 v96, v96, v97, s[48:49]
    v_cndmask_b32 v97, v98, v99, s[48:49]
    v_cndmask_b32 v100, v100, v101, s[48:49]
    v_cndmask_b32 v101, v102, v103, s[48:49]
    v_cndmask_b32 v96, v100, v96, s[50:51]
    v_cndmask_b32 v97, v101, v97, s[52:53]
    v_max_f32 v38, v96, v97
    v_cndmask_b32 v104, v104, v105, s[48:49]
    v_cndmask_b32 v105, v106, v107, s[48:49]
    v_cndmask_b32 v108, v108, v109, s[48:49]
    v_permlane32_swap_b32 v34, v38
    v_cndmask_b32 v109, v110, v111, s[48:49]
    v_cndmask_b32 v104, v108, v104, s[50:51]
    v_cndmask_b32 v105, v109, v105, s[52:53]
    v_max_f32_e64 v42, v104, v105
    v_cndmask_b32 v112, v112, v113, s[48:49]
    v_cndmask_b32 v113, v114, v115, s[48:49]
    v_cndmask_b32 v116, v116, v117, s[48:49]
    v_cndmask_b32 v117, v118, v119, s[48:49]
    v_cndmask_b32 v112, v116, v112, s[50:51]
    v_cndmask_b32 v113, v117, v113, s[52:53]
    v_max_f32 v46, v112, v113
    v_max_f32 v120, v34, v38
    s_nop 0
    v_permlane32_swap_b32 v42, v46
    v_max_f32 v122, v42, v46
    buffer_load_dwordx4 a[76:79], v4, s[20:23], s31 offen offset:1024
    s_nop 0
    v_permlane16_swap_b32 v120, v122
    v_max_f32 v124, v120, v122
    v_max_f32 v126, v120, v122
    s_nop 1
    v_permlane16_swap_b32 v124, v126
    v_mov_b32 v125, v124
    v_mov_b32 v127, v126
    s_nop 0
    v_permlane32_swap_b32 v124, v125
    v_permlane32_swap_b32 v126, v127
    v_pk_add_f32 v[88:89], v[88:89], v[124:125] op_sel:[0,0] op_sel_hi:[1,0] neg_lo:[0,1] neg_hi:[0,1]
    v_pk_add_f32 v[96:97], v[96:97], v[124:125] op_sel:[0,1] op_sel_hi:[1,1] neg_lo:[0,1] neg_hi:[0,1]
    v_pk_add_f32 v[104:105], v[104:105], v[126:127] op_sel:[0,0] op_sel_hi:[1,0] neg_lo:[0,1] neg_hi:[0,1]
    v_pk_add_f32 v[112:113], v[112:113], v[126:127] op_sel:[0,1] op_sel_hi:[1,1] neg_lo:[0,1] neg_hi:[0,1]
    v_pk_mul_f32 v[88:89], v[88:89], v[16:17] op_sel:[0,0] op_sel_hi:[1,0]
    v_pk_mul_f32 v[96:97], v[96:97], v[18:19] op_sel:[0,0] op_sel_hi:[1,0]
    v_pk_mul_f32 v[104:105], v[104:105], v[20:21] op_sel:[0,0] op_sel_hi:[1,0]
    v_pk_mul_f32 v[112:113], v[112:113], v[22:23] op_sel:[0,0] op_sel_hi:[1,0]
    v_exp_f32 v88, v88
    v_exp_f32 v89, v89
    v_cvt_pk_bf16_f32 v88, v88, v88
    v_cvt_pk_bf16_f32 v89, v89, v89
    v_and_b32 v92, v252, v88
    v_and_b32 v94, v254, v88
    v_and_b32 v93, v253, v89
    v_and_b32 v95, v255, v89
    v_exp_f32 v96, v96
    v_exp_f32 v97, v97
    v_mfma_f32_16x16x32_bf16 v[48:51], v[248:251], v[92:95], 0
    v_cvt_pk_bf16_f32 v96, v96, v96
    v_cvt_pk_bf16_f32 v97, v97, v97
    v_mfma_f32_16x16x32_bf16 v[88:91], v[68:71], v[92:95], 0
    v_and_b32 v100, v252, v96
    v_and_b32 v102, v254, v96
    v_and_b32 v101, v253, v97
    v_and_b32 v103, v255, v97
    v_exp_f32 v104, v104
    v_exp_f32 v105, v105
    v_mfma_f32_16x16x32_bf16 v[52:55], v[248:251], v[100:103], 0
    v_cvt_pk_bf16_f32 v104, v104, v104
    v_cvt_pk_bf16_f32 v105, v105, v105
    v_mfma_f32_16x16x32_bf16 v[96:99], v[70:73], v[100:103], 0
    v_and_b32 v108, v252, v104
    v_and_b32 v110, v254, v104
    v_and_b32 v109, v253, v105
    v_and_b32 v111, v255, v105
    v_exp_f32 v112, v112
    v_exp_f32 v113, v113
    v_mfma_f32_16x16x32_bf16 v[56:59], v[248:251], v[108:111], 0
    v_cvt_pk_bf16_f32 v112, v112, v112
    v_cvt_pk_bf16_f32 v113, v113, v113
    v_mfma_f32_16x16x32_bf16 v[104:107], v[72:75], v[108:111], 0
L_pad6:
    s_cbranch_execz L_body
    v_and_b32 v116, v252, v112
    v_and_b32 v118, v254, v112
    v_and_b32 v117, v253, v113
    v_and_b32 v119, v255, v113
    v_rcp_f32 v48, v48
    v_rcp_f32 v52, v52
    v_mfma_f32_16x16x32_bf16 v[60:63], v[248:251], v[116:119], 0
    v_mul_f32 v88, v88, v48
    v_mul_f32 v89, v89, v48
    v_mfma_f32_16x16x32_bf16 v[112:115], v[74:77], v[116:119], 0
    v_mul_f32 v90, v90, v48
    v_mul_f32 v91, v91, v48
    v_cvt_pk_bf16_f32 v32, v88, v89
    v_cvt_pk_bf16_f32 v33, v90, v91
    v_mul_f32 v96, v96, v52
    v_mul_f32 v97, v97, v52
    v_mul_f32 v98, v98, v52
    v_mul_f32 v99, v99, v52
    v_cvt_pk_bf16_f32 v34, v96, v97
    v_cvt_pk_bf16_f32 v35, v98, v99
    v_rcp_f32 v56, v56
    v_rcp_f32 v60, v60
    v_permlane16_swap_b32 v32, v34
    v_permlane16_swap_b32 v33, v35
    buffer_store_dwordx4 v[32:35], v1, s[16:19], s57 offen
    v_mul_f32 v104, v104, v56
    v_mul_f32 v105, v105, v56
    v_mul_f32 v106, v106, v56
    v_mul_f32 v107, v107, v56
    v_mul_f32 v112, v112, v60
    v_mul_f32 v113, v113, v60
    v_mul_f32 v114, v114, v60
    v_mul_f32_e64 v115, v115, v60
    v_cvt_pk_bf16_f32 v40, v104, v105
    v_cvt_pk_bf16_f32 v42, v112, v113
    v_cvt_pk_bf16_f32 v41, v106, v107
    v_cvt_pk_bf16_f32 v43, v114, v115
    v_permlane16_swap_b32 v40, v42
    s_nop 0
    v_permlane16_swap_b32_e64 v41, v43
    buffer_store_dwordx4 v[40:43], v1, s[16:19], s58 offen
    v_add_u32 v11, 512, v0
    ds_read_b128 v[64:67], v0
    ds_read_b128 v[68:71], v11
    v_add_u32 v14, 0x8000, v15
    ds_read_b64_tr_b16 v[16:17], v14 offset:28672
    ds_read_b64_tr_b16 v[18:19], v14 offset:29184
    ds_read_b64_tr_b16 v[20:21], v14 offset:32768
    ds_read_b64_tr_b16 v[22:23], v14 offset:33280
    ds_read_b64_tr_b16 v[24:25], v14 offset:36864
    ds_read_b64_tr_b16 v[26:27], v14 offset:37376
    ds_read_b64_tr_b16 v[28:29], v15 offset:12288
    ds_read_b64_tr_b16 v[30:31], v15 offset:12800
    ds_read_b64_tr_b16 v[236:237], v15 offset:16384
    ds_read_b64_tr_b16 v[238:239], v15 offset:16896
    ds_read_b64_tr_b16 v[240:241], v15 offset:20480
    ds_read_b64_tr_b16 v[242:243], v15 offset:20992
    s_waitcnt lgkmcnt(12)
    v_lshlrev_b32 v32, 16, v64
    v_and_b32 v33, 0xffff0000, v64
    v_lshlrev_b32 v34, 16, v65
    v_and_b32 v35, 0xffff0000, v65
    v_lshlrev_b32 v36, 16, v66
    v_and_b32 v37, 0xffff0000, v66
    v_lshlrev_b32 v38, 16, v67
    v_and_b32 v39, 0xffff0000, v67
    v_lshlrev_b32 v40, 16, v68
    v_and_b32 v41, 0xffff0000, v68
    v_lshlrev_b32 v42, 16, v69
    v_and_b32 v43, 0xffff0000, v69
    v_lshlrev_b32 v44, 16, v70
    v_and_b32 v45, 0xffff0000, v70
    v_lshlrev_b32 v46, 16, v71
    v_and_b32 v47, 0xffff0000, v71
    v_mov_b32 v11, 5
    s_mov_b64 exec, 1
    s_waitcnt vmcnt(0)
    buffer_store_dword v11, off, s[16:19], s40
    s_mov_b64 exec, -1
    s_nop 0
    ds_read_b64_tr_b16 v[244:245], v15 offset:24576
    ds_read_b64_tr_b16 v[246:247], v15 offset:25088
    ds_read_b64_tr_b16 v[248:249], v15 offset:28672
    ds_read_b64_tr_b16 v[250:251], v15 offset:29184
    ds_read_b64_tr_b16 v[96:97], v14 offset:0
    ds_read_b64_tr_b16 v[98:99], v14 offset:512
    ds_read_b64_tr_b16 v[100:101], v14 offset:4096
    ds_read_b64_tr_b16 v[102:103], v14 offset:4608
    ds_read_b64_tr_b16 v[104:105], v14 offset:8192
    ds_read_b64_tr_b16 v[106:107], v14 offset:8704
    ds_read_b64_tr_b16 v[108:109], v14 offset:12288
    ds_read_b64_tr_b16 v[110:111], v14 offset:12800
    ds_read_b64_tr_b16 v[112:113], v14 offset:16384
    ds_read_b64_tr_b16 v[114:115], v14 offset:16896
    ds_read_b64_tr_b16 v[116:117], v14 offset:20480
    ds_read_b64_tr_b16 v[118:119], v14 offset:20992
    ds_read_b64_tr_b16 v[120:121], v14 offset:24576
    ds_read_b64_tr_b16 v[122:123], v14 offset:25088
    ds_read_b64_tr_b16 v[124:125], v14 offset:40960
    ds_read_b64_tr_b16 v[126:127], v14 offset:41472
    s_lshl_b32 s44, s6, 11
    s_add_u32 s57, s35, s44
    s_cmp_ge_u32 s6, 2
    s_cselect_b32 s58, 134217728, s57
    v_lshl_add_u32 v12, s6, 12, v2
    v_xor_b32 v13, 0x1000, v12
LF_poll_17:
    buffer_load_dword v11, v6, s[16:19], s39 offen sc1
    s_sub_u32 s46, s46, 1
    s_cbranch_scc1 L_end
    s_waitcnt vmcnt(0)
    v_cmp_gt_i32 vcc, 5, v11
    s_cbranch_vccnz LF_poll_17
    s_add_u32 m0, s44, 0
    s_nop 0
    buffer_load_dwordx4 v1, s[16:19], s57 offen offset:0 sc1 lds
    buffer_load_dwordx4 v1, s[16:19], s57 offen offset:1024 sc1 lds
    s_add_u32 s54, s57, 8192
    s_add_u32 m0, s44, 8192
    s_nop 0
    buffer_load_dwordx4 v1, s[16:19], s54 offen offset:0 sc1 lds
    buffer_load_dwordx4 v1, s[16:19], s54 offen offset:1024 sc1 lds
    s_add_u32 s54, s57, 16384
    s_add_u32 m0, s44, 16384
    s_nop 0
    buffer_load_dwordx4 v1, s[16:19], s54 offen offset:0 sc1 lds
    buffer_load_dwordx4 v1, s[16:19], s54 offen offset:1024 sc1 lds
    s_waitcnt vmcnt(4)
    s_barrier
    ds_read_b128 v[64:67], v3 offset:0
    ds_read_b128 v[68:71], v3 offset:2048
    ds_read_b128 v[72:75], v3 offset:4096
    ds_read_b128 v[76:79], v3 offset:6144
    s_add_u32 s54, s57, 24576
    s_add_u32 m0, s44, 24576
    s_nop 0
    buffer_load_dwordx4 v1, s[16:19], s54 offen offset:0 sc1 lds
    buffer_load_dwordx4 v1, s[16:19], s54 offen offset:1024 sc1 lds
    s_waitcnt lgkmcnt(3)
    v_mfma_f32_32x32x16_bf16 v[48:63], v[16:19], v[64:67], 0
    s_add_u32 s54, s57, 32768
    s_add_u32 m0, s44, 32768
    s_nop 0
    buffer_load_dwordx4 v1, s[16:19], s54 offen offset:0 sc1 lds
    s_waitcnt lgkmcnt(2)
    v_mfma_f32_32x32x16_bf16 v[48:63], v[20:23], v[68:71], v[48:63]
    s_waitcnt vmcnt(5)
    s_barrier
    ds_read_b128 v[80:83], v3 offset:8192
    ds_read_b128 v[84:87], v3 offset:10240
    s_waitcnt lgkmcnt(3)
    v_mfma_f32_32x32x16_bf16 v[48:63], v[24:27], v[72:75], v[48:63]
    ds_read_b128 v[88:91], v3 offset:12288
    ds_read_b128 v[92:95], v3 offset:14336
    s_waitcnt lgkmcnt(4)
    v_mfma_f32_32x32x16_bf16 v[48:63], v[28:31], v[76:79], v[48:63]
    buffer_load_dwordx4 v1, s[16:19], s54 offen offset:1024 sc1 lds
    s_waitcnt lgkmcnt(3)
    v_mfma_f32_32x32x16_bf16 v[48:63], v[236:239], v[80:83], v[48:63]
    s_add_u32 s54, s57, 40960
    s_add_u32 m0, s44, 40960
    s_nop 0
    buffer_load_dwordx4 v1, s[16:19], s54 offen offset:0 sc1 lds
    s_waitcnt lgkmcnt(2)
    v_mfma_f32_32x32x16_bf16 v[48:63], v[240:243], v[84:87], v[48:63]
    s_waitcnt vmcnt(5)
    s_barrier
    ds_read_b128 v[64:67], v3 offset:16384
    ds_read_b128 v[68:71], v3 offset:18432
    s_waitcnt lgkmcnt(3)
    v_mfma_f32_32x32x16_bf16 v[48:63], v[244:247], v[88:91], v[48:63]
    ds_read_b128 v[72:75], v3 offset:20480
    ds_read_b128 v[76:79], v3 offset:22528
    s_waitcnt lgkmcnt(4)
    v_mfma_f32_32x32x16_bf16 v[48:63], v[248:251], v[92:95], v[48:63]
    buffer_load_dwordx4 v1, s[16:19], s54 offen offset:1024 sc1 lds
    s_waitcnt lgkmcnt(3)
    v_mfma_f32_32x32x16_bf16 v[48:63], v[96:99], v[64:67], v[48:63]
    s_add_u32 s54, s57, 49152
    s_add_u32 m0, s44, 49152
    s_nop 0
    buffer_load_dwordx4 v1, s[16:19], s54 offen offset:0 sc1 lds
    s_waitcnt lgkmcnt(2)
    v_mfma_f32_32x32x16_bf16 v[48:63], v[100:103], v[68:71], v[48:63]
    s_waitcnt vmcnt(5)
    s_barrier
    ds_read_b128 v[80:83], v3 offset:24576
    ds_read_b128 v[84:87], v3 offset:26624
    s_waitcnt lgkmcnt(3)
    v_mfma_f32_32x32x16_bf16 v[48:63], v[104:107], v[72:75], v[48:63]
    ds_read_b128 v[88:91], v3 offset:28672
    ds_read_b128 v[92:95], v3 offset:30720
    s_waitcnt lgkmcnt(4)
    v_mfma_f32_32x32x16_bf16 v[48:63], v[108:111], v[76:79], v[48:63]
    buffer_load_dwordx4 v1, s[16:19], s54 offen offset:1024 sc1 lds
    s_waitcnt lgkmcnt(3)
    v_mfma_f32_32x32x16_bf16 v[48:63], v[112:115], v[80:83], v[48:63]
    s_add_u32 s54, s57, 57344
    s_add_u32 m0, s44, 57344
    s_nop 0
    buffer_load_dwordx4 v1, s[16:19], s54 offen offset:0 sc1 lds
    s_waitcnt lgkmcnt(2)
    v_mfma_f32_32x32x16_bf16 v[48:63], v[116:119], v[84:87], v[48:63]
    s_waitcnt vmcnt(5)
    s_barrier
    ds_read_b128 v[64:67], v3 offset:32768
    ds_read_b128 v[68:71], v3 offset:34816
    s_waitcnt lgkmcnt(3)
    v_mfma_f32_32x32x16_bf16 v[48:63], v[120:123], v[88:91], v[48:63]
    ds_read_b128 v[72:75], v3 offset:36864
    ds_read_b128 v[76:79], v3 offset:38912
    s_waitcnt lgkmcnt(4)
    v_mfma_f32_32x32x16_bf16 v[48:63], v[124:127], v[92:95], v[48:63]
    buffer_load_dwordx4 v1, s[16:19], s54 offen offset:1024 sc1 lds
    s_waitcnt lgkmcnt(3)
    v_mfma_f32_32x32x16_bf16 v[32:47], v[16:19], v[64:67], v[32:47]
    s_waitcnt lgkmcnt(2)
    v_mfma_f32_32x32x16_bf16 v[32:47], v[20:23], v[68:71], v[32:47]
    s_waitcnt vmcnt(4)
    s_barrier
    ds_read_b128 v[80:83], v3 offset:40960
    ds_read_b128 v[84:87], v3 offset:43008
    s_nop 2
    v_cvt_pk_bf16_f32 v48, v48, v49
    s_waitcnt lgkmcnt(3)
    v_mfma_f32_32x32x16_bf16 v[32:47], v[24:27], v[72:75], v[32:47]
    ds_read_b128 v[88:91], v3 offset:45056
    ds_read_b128 v[92:95], v3 offset:47104
    v_cvt_pk_bf16_f32 v49, v50, v51
    v_cvt_pk_bf16_f32 v50, v52, v53
    v_cvt_pk_bf16_f32 v51, v54, v55
    s_waitcnt lgkmcnt(4)
    v_mfma_f32_32x32x16_bf16 v[32:47], v[28:31], v[76:79], v[32:47]
    v_cvt_pk_bf16_f32 v52, v56, v57
    v_cvt_pk_bf16_f32 v53, v58, v59
    v_cvt_pk_bf16_f32 v54, v60, v61
    v_cvt_pk_bf16_f32 v55, v62, v63
    s_waitcnt lgkmcnt(3)
    v_mfma_f32_32x32x16_bf16 v[32:47], v[236:239], v[80:83], v[32:47]
    s_waitcnt lgkmcnt(2)
    v_mfma_f32_32x32x16_bf16 v[32:47], v[240:243], v[84:87], v[32:47]
    s_waitcnt vmcnt(2)
    s_barrier
    ds_read_b128 v[64:67], v3 offset:49152
    ds_read_b128 v[68:71], v3 offset:51200
    s_waitcnt lgkmcnt(3)
    v_mfma_f32_32x32x16_bf16 v[32:47], v[244:247], v[88:91], v[32:47]
    ds_read_b128 v[72:75], v3 offset:53248
    ds_read_b128 v[76:79], v3 offset:55296
    s_waitcnt lgkmcnt(4)
    v_mfma_f32_32x32x16_bf16 v[32:47], v[248:251], v[92:95], v[32:47]
    ds_write_b128 v12, v[48:51] offset:0
    s_waitcnt lgkmcnt(4)
    v_mfma_f32_32x32x16_bf16 v[32:47], v[96:99], v[64:67], v[32:47]
    ds_write_b128 v12, v[52:55] offset:1024
    buffer_load_dwordx4 a[80:83], v4, s[20:23], s32 offen offset:1024
    s_waitcnt lgkmcnt(4)
    v_mfma_f32_32x32x16_bf16 v[32:47], v[100:103], v[68:71], v[32:47]
    s_waitcnt lgkmcnt(0)
    s_waitcnt vmcnt(1)
    s_barrier
    ds_read_b128 v[80:83], v3 offset:57344
    ds_read_b128 v[84:87], v3 offset:59392
    v_mfma_f32_32x32x16_bf16 v[32:47], v[104:107], v[72:75], v[32:47]
    ds_read_b128 v[88:91], v3 offset:61440
    ds_read_b128 v[92:95], v3 offset:63488
    s_bfe_u32 s55, s56, 196628
    v_lshl_add_u32 v4, s55, 11, v1
    buffer_load_dwordx4 a[88:91], v4, s[20:23], s30 offen offset:0
    v_mfma_f32_32x32x16_bf16 v[32:47], v[108:111], v[76:79], v[32:47]
    ds_read_b128 v[56:59], v13 offset:0
    ds_read_b128 v[60:63], v13 offset:1024
    s_waitcnt lgkmcnt(5)
    v_mfma_f32_32x32x16_bf16 v[32:47], v[112:115], v[80:83], v[32:47]
    buffer_load_dwordx4 a[92:95], v4, s[20:23], s31 offen offset:0
    s_waitcnt lgkmcnt(0)
    v_lshlrev_b32 v48, 16, v56
    v_and_b32 v49, 0xffff0000, v56
    v_lshlrev_b32 v50, 16, v57
    v_mfma_f32_32x32x16_bf16 v[32:47], v[116:119], v[84:87], v[32:47]
    v_and_b32 v51, 0xffff0000, v57
    v_lshlrev_b32 v52, 16, v58
    v_and_b32 v53, 0xffff0000, v58
    v_lshlrev_b32 v54, 16, v59
    v_and_b32 v55, 0xffff0000, v59
    v_lshlrev_b32 v56, 16, v60
    v_mfma_f32_32x32x16_bf16 v[32:47], v[120:123], v[88:91], v[32:47]
    buffer_load_dwordx4 a[100:103], v4, s[20:23], s32 offen offset:0
    v_and_b32 v57, 0xffff0000, v60
    v_lshlrev_b32 v58, 16, v61
    v_and_b32 v59, 0xffff0000, v61
    v_lshlrev_b32 v60, 16, v62
    v_mfma_f32_32x32x16_bf16 v[32:47], v[124:127], v[92:95], v[32:47]
    v_and_b32 v61, 0xffff0000, v62
    v_lshlrev_b32 v62, 16, v63
    v_and_b32 v63, 0xffff0000, v63
    s_nop 8
    v_pk_add_f32 v[16:17], v[32:33], v[48:49]
    v_pk_add_f32 v[18:19], v[34:35], v[50:51]
    v_pk_add_f32 v[20:21], v[36:37], v[52:53]
    v_pk_add_f32 v[22:23], v[38:39], v[54:55]
    v_cvt_pk_bf16_f32 v80, v16, v17
    v_cvt_pk_bf16_f32 v81, v18, v19
    v_cvt_pk_bf16_f32 v82, v20, v21
    v_cvt_pk_bf16_f32 v83, v22, v23
    buffer_store_dwordx4 v[80:83], v5, s[16:19], s47 offen offset:0
    v_pk_add_f32 v[24:25], v[40:41], v[56:57]
    v_pk_add_f32 v[26:27], v[42:43], v[58:59]
    v_pk_add_f32 v[28:29], v[44:45], v[60:61]
    v_pk_add_f32 v[30:31], v[46:47], v[62:63]
    v_cvt_pk_bf16_f32 v84, v24, v25
    v_cvt_pk_bf16_f32 v85, v26, v27
    v_cvt_pk_bf16_f32 v86, v28, v29
    v_cvt_pk_bf16_f32 v87, v30, v31
    buffer_store_dwordx4 v[84:87], v5, s[16:19], s47 offen offset:512
    v_pk_add_f32 v[12:13], v[16:17], v[18:19]
    v_pk_mul_f32 v[78:79], v[16:17], v[16:17]
    v_pk_fma_f32 v[78:79], v[18:19], v[18:19], v[78:79]
    v_pk_add_f32 v[12:13], v[12:13], v[20:21]
    v_pk_fma_f32 v[78:79], v[20:21], v[20:21], v[78:79]
    v_pk_add_f32 v[12:13], v[12:13], v[22:23]
    v_pk_fma_f32 v[78:79], v[22:23], v[22:23], v[78:79]
    v_pk_add_f32 v[12:13], v[12:13], v[24:25]
    v_pk_fma_f32 v[78:79], v[24:25], v[24:25], v[78:79]
    v_pk_add_f32 v[12:13], v[12:13], v[26:27]
    v_pk_fma_f32 v[78:79], v[26:27], v[26:27], v[78:79]
    v_pk_add_f32 v[12:13], v[12:13], v[28:29]
    v_pk_fma_f32 v[78:79], v[28:29], v[28:29], v[78:79]
    v_pk_add_f32 v[12:13], v[12:13], v[30:31]
    v_pk_fma_f32 v[78:79], v[30:31], v[30:31], v[78:79]
    v_add_f32 v12, v12, v13
    v_add_f32 v14, v78, v79
    s_nop 1
    v_permlane32_swap_b32 v12, v14
    v_add_f32 v14, v12, v14
    buffer_store_dword v14, v7, s[16:19], s36 offen
    ds_write_b128 v0, v[80:83] offset:0
    ds_write_b128 v0, v[84:87] offset:512
    s_lshl_b32 s44, s6, 14
    s_add_u32 s58, s34, s44
    s_waitcnt lgkmcnt(0)
    s_barrier
    ds_read_b128 v[88:91], v1 offset:0
    ds_read_b128 v[92:95], v1 offset:16384
    ds_read_b128 v[96:99], v1 offset:32768
    ds_read_b128 v[100:103], v1 offset:49152
    s_waitcnt lgkmcnt(3)
    v_mfma_f32_16x16x32_bf16 v[32:35], a[0:3], v[88:91], 0
    ds_read_b128 v[104:107], v1 offset:1024
    s_mul_i32 s3, s6, 192
    v_mfma_f32_16x16x32_bf16 v[48:51], a[12:15], v[88:91], 0
    s_add_u32 s3, s3, 1792
    v_add_u32 v13, s3, v10
    v_mfma_f32_16x16x32_bf16 v[64:67], a[24:27], v[88:91], 0
    s_waitcnt lgkmcnt(3)
    ds_read_b128 v[108:111], v13 offset:0
    v_mfma_f32_16x16x32_bf16 v[36:39], a[0:3], v[92:95], 0
    ds_read_b128 v[88:91], v1 offset:17408
    v_mfma_f32_16x16x32_bf16 v[52:55], a[12:15], v[92:95], 0
    v_mov_b32 v11, 6
    s_mov_b64 exec, 1
    s_waitcnt vmcnt(0)
    buffer_store_dword v11, off, s[16:19], s40
    s_mov_b64 exec, -1
    v_mfma_f32_16x16x32_bf16 v[68:71], a[24:27], v[92:95], 0
    s_waitcnt lgkmcnt(4)
    ds_read_b128 v[112:115], v13 offset:64
    v_mfma_f32_16x16x32_bf16 v[40:43], a[0:3], v[96:99], 0
    ds_read_b128 v[92:95], v1 offset:33792
    v_mfma_f32_16x16x32_bf16 v[56:59], a[12:15], v[96:99], 0
    ds_read_b128 v[116:119], v13 offset:128
    v_mfma_f32_16x16x32_bf16 v[72:75], a[24:27], v[96:99], 0
    s_waitcnt lgkmcnt(6)
    v_mfma_f32_16x16x32_bf16 v[44:47], a[0:3], v[100:103], 0
    ds_read_b128 v[96:99], v1 offset:50176
    v_mfma_f32_16x16x32_bf16 v[60:63], a[12:15], v[100:103], 0
    v_mfma_f32_16x16x32_bf16 v[76:79], a[24:27], v[100:103], 0
    s_waitcnt lgkmcnt(6)
    v_mfma_f32_16x16x32_bf16 v[32:35], a[36:39], v[104:107], v[32:35]
    v_mfma_f32_16x16x32_bf16 v[48:51], a[48:51], v[104:107], v[48:51]
    v_mfma_f32_16x16x32_bf16 v[64:67], a[60:63], v[104:107], v[64:67]
    s_waitcnt lgkmcnt(4)
    v_mfma_f32_16x16x32_bf16 v[36:39], a[36:39], v[88:91], v[36:39]
    v_mfma_f32_16x16x32_bf16 v[52:55], a[48:51], v[88:91], v[52:55]
    v_mfma_f32_16x16x32_bf16 v[68:71], a[60:63], v[88:91], v[68:71]
    s_waitcnt lgkmcnt(2)
    v_mfma_f32_16x16x32_bf16 v[40:43], a[36:39], v[92:95], v[40:43]
    v_mfma_f32_16x16x32_bf16 v[56:59], a[48:51], v[92:95], v[56:59]
    buffer_load_dword v11, v6, s[16:19], s39 offen sc1
    v_mfma_f32_16x16x32_bf16 v[72:75], a[60:63], v[92:95], v[72:75]
    s_waitcnt lgkmcnt(0)
    v_mfma_f32_16x16x32_bf16 v[44:47], a[36:39], v[96:99], v[44:47]
    v_mfma_f32_16x16x32_bf16 v[60:63], a[48:51], v[96:99], v[60:63]
    v_mfma_f32_16x16x32_bf16 v[76:79], a[60:63], v[96:99], v[76:79]
    s_bfe_u32 s3, s56, 196612
    s_lshl_b32 s3, s3, 11
    s_add_u32 m0, s44, 2048
    s_add_u32 s57, s3, s58
    s_waitcnt vmcnt(0)
    v_cmp_gt_i32 vcc, 6, v11
    s_cbranch_vccnz LF_spin_19
LF_got_20:
    buffer_load_dwordx4 v1, s[16:19], s57 offen offset:0 sc1 lds
    buffer_load_dwordx4 v1, s[16:19], s57 offen offset:1024 sc1 lds
    s_bfe_u32 s3, s56, 196616
    s_lshl_b32 s3, s3, 11
    s_add_u32 m0, s44, 4096
    s_add_u32 s57, s3, s58
    buffer_load_dwordx4 v1, s[16:19], s57 offen offset:0 sc1 lds
    s_waitcnt vmcnt(2)
    s_barrier
    ds_read_b128 v[88:91], v1 offset:2048
    ds_read_b128 v[92:95], v1 offset:18432
    ds_read_b128 v[96:99], v1 offset:34816
    ds_read_b128 v[100:103], v1 offset:51200
    s_waitcnt lgkmcnt(3)
    v_mfma_f32_16x16x32_bf16 v[32:35], a[72:75], v[88:91], v[32:35]
    s_waitcnt vmcnt(1)
    s_barrier
    ds_read_b128 v[104:107], v1 offset:3072
    v_mfma_f32_16x16x32_bf16 v[48:51], a[84:87], v[88:91], v[48:51]
    buffer_load_dwordx4 v1, s[16:19], s57 offen offset:1024 sc1 lds
    v_mfma_f32_16x16x32_bf16 v[64:67], a[96:99], v[88:91], v[64:67]
    s_waitcnt lgkmcnt(3)
    v_mfma_f32_16x16x32_bf16 v[36:39], a[72:75], v[92:95], v[36:39]
    ds_read_b128 v[88:91], v1 offset:19456
    v_mfma_f32_16x16x32_bf16 v[52:55], a[84:87], v[92:95], v[52:55]
    s_bfe_u32 s3, s56, 196620
    s_lshl_b32 s3, s3, 11
    s_add_u32 m0, s44, 6144
    s_add_u32 s57, s3, s58
    buffer_load_dwordx4 v1, s[16:19], s57 offen offset:0 sc1 lds
    v_mfma_f32_16x16x32_bf16 v[68:71], a[96:99], v[92:95], v[68:71]
    s_waitcnt lgkmcnt(3)
    v_mfma_f32_16x16x32_bf16 v[40:43], a[72:75], v[96:99], v[40:43]
    ds_read_b128 v[92:95], v1 offset:35840
    v_mfma_f32_16x16x32_bf16 v[56:59], a[84:87], v[96:99], v[56:59]
    buffer_load_dwordx4 v1, s[16:19], s57 offen offset:1024 sc1 lds
    v_mfma_f32_16x16x32_bf16 v[72:75], a[96:99], v[96:99], v[72:75]
    s_waitcnt lgkmcnt(3)
    v_mfma_f32_16x16x32_bf16 v[44:47], a[72:75], v[100:103], v[44:47]
    ds_read_b128 v[96:99], v1 offset:52224
    v_mfma_f32_16x16x32_bf16 v[60:63], a[84:87], v[100:103], v[60:63]
    v_mfma_f32_16x16x32_bf16 v[76:79], a[96:99], v[100:103], v[76:79]
    s_waitcnt lgkmcnt(3)
    v_mfma_f32_16x16x32_bf16 v[32:35], a[108:111], v[104:107], v[32:35]
    s_waitcnt vmcnt(3)
    s_barrier
    ds_read_b128 v[100:103], v1 offset:4096
    v_mfma_f32_16x16x32_bf16 v[48:51], a[120:123], v[104:107], v[48:51]
    s_bfe_u32 s3, s56, 196624
    s_lshl_b32 s3, s3, 11
    s_add_u32 m0, s44, 8192
    s_add_u32 s57, s3, s58
    buffer_load_dwordx4 v1, s[16:19], s57 offen offset:0 sc1 lds
    v_mfma_f32_16x16x32_bf16 v[64:67], a[132:135], v[104:107], v[64:67]
    s_waitcnt lgkmcnt(3)
    v_mfma_f32_16x16x32_bf16 v[36:39], a[108:111], v[88:91], v[36:39]
    ds_read_b128 v[104:107], v1 offset:20480
    v_mfma_f32_16x16x32_bf16 v[52:55], a[120:123], v[88:91], v[52:55]
    buffer_load_dwordx4 v1, s[16:19], s57 offen offset:1024 sc1 lds
    v_mfma_f32_16x16x32_bf16 v[68:71], a[132:135], v[88:91], v[68:71]
    s_waitcnt lgkmcnt(3)
    v_mfma_f32_16x16x32_bf16 v[40:43], a[108:111], v[92:95], v[40:43]
    ds_read_b128 v[88:91], v1 offset:36864
    v_mfma_f32_16x16x32_bf16 v[56:59], a[120:123], v[92:95], v[56:59]
    s_bfe_u32 s3, s56, 196628
    s_lshl_b32 s3, s3, 11
    s_add_u32 m0, s44, 10240
    s_add_u32 s57, s3, s58
    buffer_load_dwordx4 v1, s[16:19], s57 offen offset:0 sc1 lds
    v_mfma_f32_16x16x32_bf16 v[72:75], a[132:135], v[92:95], v[72:75]
    s_waitcnt lgkmcnt(3)
    v_mfma_f32_16x16x32_bf16 v[44:47], a[108:111], v[96:99], v[44:47]
    ds_read_b128 v[92:95], v1 offset:53248
    v_mfma_f32_16x16x32_bf16 v[60:63], a[120:123], v[96:99], v[60:63]
    v_mfma_f32_16x16x32_bf16 v[76:79], a[132:135], v[96:99], v[76:79]
    s_waitcnt lgkmcnt(3)
    v_mfma_f32_16x16x32_bf16 v[32:35], a[144:147], v[100:103], v[32:35]
    s_waitcnt vmcnt(4)
    s_barrier
    ds_read_b128 v[96:99], v1 offset:5120
    v_mfma_f32_16x16x32_bf16 v[48:51], a[156:159], v[100:103], v[48:51]
    buffer_load_dwordx4 v1, s[16:19], s57 offen offset:1024 sc1 lds
    v_mfma_f32_16x16x32_bf16 v[64:67], a[168:171], v[100:103], v[64:67]
    s_waitcnt lgkmcnt(3)
    v_mfma_f32_16x16x32_bf16 v[36:39], a[144:147], v[104:107], v[36:39]
    ds_read_b128 v[100:103], v1 offset:21504
    v_mfma_f32_16x16x32_bf16 v[52:55], a[156:159], v[104:107], v[52:55]
    s_bfe_u32 s3, s56, 196632
    s_lshl_b32 s3, s3, 11
    s_add_u32 m0, s44, 12288
    s_add_u32 s57, s3, s58
    buffer_load_dwordx4 v1, s[16:19], s57 offen offset:0 sc1 lds
    v_mfma_f32_16x16x32_bf16 v[68:71], a[168:171], v[104:107], v[68:71]
    s_waitcnt lgkmcnt(3)
    v_mfma_f32_16x16x32_bf16 v[40:43], a[144:147], v[88:91], v[40:43]
    ds_read_b128 v[104:107], v1 offset:37888
    v_mfma_f32_16x16x32_bf16 v[56:59], a[156:159], v[88:91], v[56:59]
    buffer_load_dwordx4 v1, s[16:19], s57 offen offset:1024 sc1 lds
    v_mfma_f32_16x16x32_bf16 v[72:75], a[168:171], v[88:91], v[72:75]
    s_waitcnt lgkmcnt(3)
    v_mfma_f32_16x16x32_bf16 v[44:47], a[144:147], v[92:95], v[44:47]
    ds_read_b128 v[88:91], v1 offset:54272
    v_mfma_f32_16x16x32_bf16 v[60:63], a[156:159], v[92:95], v[60:63]
    v_mfma_f32_16x16x32_bf16 v[76:79], a[168:171], v[92:95], v[76:79]
    s_waitcnt lgkmcnt(3)
    v_mfma_f32_16x16x32_bf16 v[32:35], a[180:183], v[96:99], v[32:35]
    ds_read_b128 v[92:95], v1 offset:6144
    v_mfma_f32_16x16x32_bf16 v[48:51], a[4:7], v[96:99], v[48:51]
    s_bfe_u32 s3, s56, 196636
    s_lshl_b32 s3, s3, 11
    s_add_u32 m0, s44, 14336
    s_add_u32 s57, s3, s58
    buffer_load_dwordx4 v1, s[16:19], s57 offen offset:0 sc1 lds
    v_mfma_f32_16x16x32_bf16 v[64:67], a[8:11], v[96:99], v[64:67]
    s_waitcnt lgkmcnt(3)
    v_mfma_f32_16x16x32_bf16 v[36:39], a[180:183], v[100:103], v[36:39]
    ds_read_b128 v[96:99], v1 offset:22528
    v_mfma_f32_16x16x32_bf16 v[52:55], a[4:7], v[100:103], v[52:55]
    buffer_load_dwordx4 v1, s[16:19], s57 offen offset:1024 sc1 lds
    v_mfma_f32_16x16x32_bf16 v[68:71], a[8:11], v[100:103], v[68:71]
    s_waitcnt lgkmcnt(3)
    v_mfma_f32_16x16x32_bf16 v[40:43], a[180:183], v[104:107], v[40:43]
    ds_read_b128 v[100:103], v1 offset:38912
    v_mfma_f32_16x16x32_bf16 v[56:59], a[4:7], v[104:107], v[56:59]
    buffer_load_dwordx4 v[80:83], v8, s[16:19], s37 offen offset:0 sc1
    v_mfma_f32_16x16x32_bf16 v[72:75], a[8:11], v[104:107], v[72:75]
    s_waitcnt lgkmcnt(3)
    v_mfma_f32_16x16x32_bf16 v[44:47], a[180:183], v[88:91], v[44:47]
    ds_read_b128 v[104:107], v1 offset:55296
    v_mfma_f32_16x16x32_bf16 v[60:63], a[4:7], v[88:91], v[60:63]
    buffer_load_dwordx4 v[84:87], v8, s[16:19], s37 offen offset:1024 sc1
    v_mfma_f32_16x16x32_bf16 v[76:79], a[8:11], v[88:91], v[76:79]
    s_waitcnt lgkmcnt(3)
    v_mfma_f32_16x16x32_bf16 v[32:35], a[16:19], v[92:95], v[32:35]
    s_waitcnt vmcnt(6)
    s_barrier
    ds_read_b128 v[88:91], v1 offset:7168
    v_mfma_f32_16x16x32_bf16 v[48:51], a[20:23], v[92:95], v[48:51]
    v_mfma_f32_16x16x32_bf16 v[64:67], a[28:31], v[92:95], v[64:67]
    s_waitcnt lgkmcnt(3)
    v_mfma_f32_16x16x32_bf16 v[36:39], a[16:19], v[96:99], v[36:39]
    ds_read_b128 v[92:95], v1 offset:23552
    v_mfma_f32_16x16x32_bf16 v[52:55], a[20:23], v[96:99], v[52:55]
    buffer_load_dwordx4 a[104:107], v4, s[20:23], s30 offen offset:1024
    v_mfma_f32_16x16x32_bf16 v[68:71], a[28:31], v[96:99], v[68:71]
    s_waitcnt lgkmcnt(3)
    v_mfma_f32_16x16x32_bf16 v[40:43], a[16:19], v[100:103], v[40:43]
    ds_read_b128 v[96:99], v1 offset:39936
    v_mfma_f32_16x16x32_bf16 v[56:59], a[20:23], v[100:103], v[56:59]
    buffer_load_dwordx4 a[112:115], v4, s[20:23], s31 offen offset:1024
    v_mfma_f32_16x16x32_bf16 v[72:75], a[28:31], v[100:103], v[72:75]
    s_waitcnt lgkmcnt(3)
    v_mfma_f32_16x16x32_bf16 v[44:47], a[16:19], v[104:107], v[44:47]
    ds_read_b128 v[100:103], v1 offset:56320
    v_mfma_f32_16x16x32_bf16 v[60:63], a[20:23], v[104:107], v[60:63]
    buffer_load_dwordx4 a[116:119], v4, s[20:23], s32 offen offset:1024
    v_mfma_f32_16x16x32_bf16 v[76:79], a[28:31], v[104:107], v[76:79]
    s_waitcnt lgkmcnt(3)
    v_mfma_f32_16x16x32_bf16 v[32:35], a[32:35], v[88:91], v[32:35]
    ds_read_b128 v[104:107], v1 offset:8192
    v_mfma_f32_16x16x32_bf16 v[48:51], a[40:43], v[88:91], v[48:51]
    v_mfma_f32_16x16x32_bf16 v[64:67], a[44:47], v[88:91], v[64:67]
    s_waitcnt lgkmcnt(3)
    v_mfma_f32_16x16x32_bf16 v[36:39], a[32:35], v[92:95], v[36:39]
    ds_read_b128 v[88:91], v1 offset:24576
    v_mfma_f32_16x16x32_bf16 v[52:55], a[40:43], v[92:95], v[52:55]
    s_bfe_u32 s55, s56, 196632
    v_lshl_add_u32 v4, s55, 11, v1
    buffer_load_dwordx4 a[124:127], v4, s[20:23], s30 offen offset:0
    v_mfma_f32_16x16x32_bf16 v[68:71], a[44:47], v[92:95], v[68:71]
    s_waitcnt lgkmcnt(3)
    v_mfma_f32_16x16x32_bf16 v[40:43], a[32:35], v[96:99], v[40:43]
    ds_read_b128 v[92:95], v1 offset:40960
    v_mfma_f32_16x16x32_bf16 v[56:59], a[40:43], v[96:99], v[56:59]
    buffer_load_dwordx4 a[128:131], v4, s[20:23], s31 offen offset:0
    v_mfma_f32_16x16x32_bf16 v[72:75], a[44:47], v[96:99], v[72:75]
    s_waitcnt lgkmcnt(3)
    v_mfma_f32_16x16x32_bf16 v[44:47], a[32:35], v[100:103], v[44:47]
    ds_read_b128 v[96:99], v1 offset:57344
    v_mfma_f32_16x16x32_bf16 v[60:63], a[40:43], v[100:103], v[60:63]
    buffer_load_dwordx4 a[136:139], v4, s[20:23], s32 offen offset:0
    v_mfma_f32_16x16x32_bf16 v[76:79], a[44:47], v[100:103], v[76:79]
    s_waitcnt lgkmcnt(3)
    v_mfma_f32_16x16x32_bf16 v[32:35], a[52:55], v[104:107], v[32:35]
    ds_read_b128 v[100:103], v1 offset:9216
    v_mfma_f32_16x16x32_bf16 v[48:51], a[56:59], v[104:107], v[48:51]
    v_mfma_f32_16x16x32_bf16 v[64:67], a[64:67], v[104:107], v[64:67]
    s_waitcnt lgkmcnt(3)
    s_waitcnt vmcnt(6)
    v_add_f32 v80, v80, v82
    v_mfma_f32_16x16x32_bf16 v[36:39], a[52:55], v[88:91], v[36:39]
    ds_read_b128 v[104:107], v1 offset:25600
    v_add_f32 v81, v81, v83
    v_mfma_f32_16x16x32_bf16 v[52:55], a[56:59], v[88:91], v[52:55]
    buffer_load_dwordx4 a[140:143], v4, s[20:23], s30 offen offset:1024
    v_mfma_f32_16x16x32_bf16 v[68:71], a[64:67], v[88:91], v[68:71]
    s_waitcnt lgkmcnt(3)
    v_add_f32 v84, v84, v86
    v_add_f32 v85, v85, v87
    v_mfma_f32_16x16x32_bf16 v[40:43], a[52:55], v[92:95], v[40:43]
    ds_read_b128 v[88:91], v1 offset:41984
    v_add_f32 v80, v80, v84
    v_mfma_f32_16x16x32_bf16 v[56:59], a[56:59], v[92:95], v[56:59]
    buffer_load_dwordx4 a[148:151], v4, s[20:23], s31 offen offset:1024
    v_mfma_f32_16x16x32_bf16 v[72:75], a[64:67], v[92:95], v[72:75]
    s_waitcnt lgkmcnt(3)
    v_add_f32 v81, v81, v85
    v_lshl_add_u32 v82, s6, 7, v9
    v_mfma_f32_16x16x32_bf16 v[44:47], a[52:55], v[96:99], v[44:47]
    ds_read_b128 v[92:95], v1 offset:58368
L_pad7:
    s_cbranch_execz L_body
    v_lshrrev_b32 v83, 1, v82
    v_mfma_f32_16x16x32_bf16 v[60:63], a[56:59], v[96:99], v[60:63]
    buffer_load_dwordx4 a[152:155], v4, s[20:23], s32 offen offset:1024
    v_mfma_f32_16x16x32_bf16 v[76:79], a[64:67], v[96:99], v[76:79]
    s_waitcnt lgkmcnt(3)
    v_permlane32_swap_b32 v80, v81
    v_mfma_f32_16x16x32_bf16 v[32:35], a[68:71], v[100:103], v[32:35]
    ds_read_b128 v[96:99], v1 offset:10240
    v_add_f32 v84, v80, v81
    v_mfma_f32_16x16x32_bf16 v[48:51], a[76:79], v[100:103], v[48:51]
    v_add_f32 v85, v80, v81
    v_add_u32 v83, 80896, v83
    v_mfma_f32_16x16x32_bf16 v[64:67], a[80:83], v[100:103], v[64:67]
    s_waitcnt lgkmcnt(3)
    v_permlane16_swap_b32 v84, v85
    v_mfma_f32_16x16x32_bf16 v[36:39], a[68:71], v[104:107], v[36:39]
    ds_read_b128 v[100:103], v1 offset:26624
    v_add_f32 v80, v84, v85
    v_mfma_f32_16x16x32_bf16 v[52:55], a[76:79], v[104:107], v[52:55]
    s_bfe_u32 s55, s56, 196636
    v_lshl_add_u32 v4, s55, 11, v1
    buffer_load_dwordx4 a[160:163], v4, s[20:23], s30 offen offset:0
    v_mfma_f32_16x16x32_bf16 v[68:71], a[80:83], v[104:107], v[68:71]
    s_waitcnt lgkmcnt(3)
    v_add_f32 v81, v84, v85
    v_mfma_f32_16x16x32_bf16 v[40:43], a[68:71], v[88:91], v[40:43]
    ds_read_b128 v[104:107], v1 offset:11264
    v_mfma_f32_16x16x32_bf16 v[56:59], a[76:79], v[88:91], v[56:59]
    buffer_load_dwordx4 a[164:167], v4, s[20:23], s31 offen offset:0
    v_mfma_f32_16x16x32_bf16 v[72:75], a[80:83], v[88:91], v[72:75]
    s_waitcnt lgkmcnt(3)
    v_permlane32_swap_b32 v80, v81
    v_mfma_f32_16x16x32_bf16 v[44:47], a[68:71], v[92:95], v[44:47]
    ds_read_b128 v[88:91], v1 offset:27648
    v_mul_f32 v80, 0xbb000000, v80
    v_mfma_f32_16x16x32_bf16 v[60:63], a[76:79], v[92:95], v[60:63]
    buffer_load_dwordx4 a[172:175], v4, s[20:23], s32 offen offset:0
    v_mfma_f32_16x16x32_bf16 v[76:79], a[80:83], v[92:95], v[76:79]
    s_waitcnt lgkmcnt(3)
    v_mul_f32 v81, 0x3b000000, v81
    v_fma_f32 v81, -v80, v80, v81
    v_mfma_f32_16x16x32_bf16 v[32:35], a[88:91], v[96:99], v[32:35]
    s_barrier
    ds_read_b128 v[92:95], v1 offset:12288
    v_mfma_f32_16x16x32_bf16 v[48:51], a[92:95], v[96:99], v[48:51]
    v_max_f32 v81, 0, v81
    v_add_f32 v81, 0x3727c5ac, v81
    v_mfma_f32_16x16x32_bf16 v[64:67], a[100:103], v[96:99], v[64:67]
    s_waitcnt lgkmcnt(3)
    v_rsq_f32 v81, v81
    v_mfma_f32_16x16x32_bf16 v[36:39], a[88:91], v[100:103], v[36:39]
    ds_read_b128 v[96:99], v1 offset:28672
    v_mfma_f32_16x16x32_bf16 v[52:55], a[92:95], v[100:103], v[52:55]
    buffer_load_dwordx4 a[176:179], v4, s[20:23], s30 offen offset:1024
    v_mfma_f32_16x16x32_bf16 v[68:71], a[100:103], v[100:103], v[68:71]
    s_waitcnt lgkmcnt(3)
    ds_write_b64 v82, v[80:81]
    s_waitcnt vmcnt(12)
    v_mfma_f32_16x16x32_bf16 v[32:35], a[104:107], v[104:107], v[32:35]
    ds_read_b128 v[100:103], v1 offset:13312
    s_waitcnt vmcnt(11)
    v_mfma_f32_16x16x32_bf16 v[48:51], a[112:115], v[104:107], v[48:51]
    buffer_load_dwordx4 a[184:187], v4, s[20:23], s31 offen offset:1024
    s_waitcnt vmcnt(11)
    v_mfma_f32_16x16x32_bf16 v[64:67], a[116:119], v[104:107], v[64:67]
    s_waitcnt lgkmcnt(4)
    ds_write2_b32 v83, v80, v81 offset0:0 offset1:128
    v_mfma_f32_16x16x32_bf16 v[36:39], a[104:107], v[88:91], v[36:39]
    ds_read_b128 v[104:107], v1 offset:29696
    v_mfma_f32_16x16x32_bf16 v[52:55], a[112:115], v[88:91], v[52:55]
    buffer_load_dwordx4 a[188:191], v4, s[20:23], s32 offen offset:1024
    v_mfma_f32_16x16x32_bf16 v[68:71], a[116:119], v[88:91], v[68:71]
    s_waitcnt lgkmcnt(5)
    s_waitcnt lgkmcnt(0)
    s_barrier
    ds_read_b64 v[80:81], v9 offset:0
    ds_read_b64 v[82:83], v9 offset:128
    ds_read_b64 v[84:85], v9 offset:256
    ds_read_b64 v[86:87], v9 offset:384
    s_waitcnt vmcnt(11)
    v_mfma_f32_16x16x32_bf16 v[32:35], a[124:127], v[92:95], v[32:35]
    ds_read_b128 v[88:91], v1 offset:14336
    s_waitcnt vmcnt(10)
    v_mfma_f32_16x16x32_bf16 v[48:51], a[128:131], v[92:95], v[48:51]
    s_waitcnt vmcnt(9)
    v_mfma_f32_16x16x32_bf16 v[64:67], a[136:139], v[92:95], v[64:67]
    v_mfma_f32_16x16x32_bf16 v[36:39], a[124:127], v[96:99], v[36:39]
    ds_read_b128 v[92:95], v1 offset:30720
    v_mfma_f32_16x16x32_bf16 v[52:55], a[128:131], v[96:99], v[52:55]
    v_mfma_f32_16x16x32_bf16 v[68:71], a[136:139], v[96:99], v[68:71]
    s_waitcnt vmcnt(8)
    v_mfma_f32_16x16x32_bf16 v[32:35], a[140:143], v[100:103], v[32:35]
    ds_read_b128 v[96:99], v1 offset:15360
    s_waitcnt vmcnt(7)
    v_mfma_f32_16x16x32_bf16 v[48:51], a[148:151], v[100:103], v[48:51]
    s_waitcnt vmcnt(6)
    v_mfma_f32_16x16x32_bf16 v[64:67], a[152:155], v[100:103], v[64:67]
    v_mfma_f32_16x16x32_bf16 v[36:39], a[140:143], v[104:107], v[36:39]
    ds_read_b128 v[100:103], v1 offset:31744
    v_mfma_f32_16x16x32_bf16 v[52:55], a[148:151], v[104:107], v[52:55]
    v_mfma_f32_16x16x32_bf16 v[68:71], a[152:155], v[104:107], v[68:71]
    s_waitcnt lgkmcnt(3)
    s_waitcnt vmcnt(5)
    v_mfma_f32_16x16x32_bf16 v[32:35], a[160:163], v[88:91], v[32:35]
    ds_read_b128 v[104:107], v1 offset:43008
    s_waitcnt vmcnt(4)
    v_mfma_f32_16x16x32_bf16 v[48:51], a[164:167], v[88:91], v[48:51]
    s_waitcnt vmcnt(3)
    v_mfma_f32_16x16x32_bf16 v[64:67], a[172:175], v[88:91], v[64:67]
    s_waitcnt lgkmcnt(3)
    v_mfma_f32_16x16x32_bf16 v[36:39], a[160:163], v[92:95], v[36:39]
    ds_read_b128 v[88:91], v1 offset:59392
    v_mfma_f32_16x16x32_bf16 v[52:55], a[164:167], v[92:95], v[52:55]
    v_mfma_f32_16x16x32_bf16 v[68:71], a[172:175], v[92:95], v[68:71]
    s_waitcnt lgkmcnt(3)
    s_waitcnt vmcnt(2)
    v_mfma_f32_16x16x32_bf16 v[32:35], a[176:179], v[96:99], v[32:35]
    ds_read_b128 v[92:95], v1 offset:44032
    s_waitcnt vmcnt(1)
    v_mfma_f32_16x16x32_bf16 v[48:51], a[184:187], v[96:99], v[48:51]
    s_waitcnt vmcnt(0)
    v_mfma_f32_16x16x32_bf16 v[64:67], a[188:191], v[96:99], v[64:67]
    s_waitcnt lgkmcnt(3)
    v_mfma_f32_16x16x32_bf16 v[36:39], a[176:179], v[100:103], v[36:39]
    ds_read_b128 v[96:99], v1 offset:60416
    v_mfma_f32_16x16x32_bf16 v[52:55], a[184:187], v[100:103], v[52:55]
    v_mfma_f32_16x16x32_bf16 v[68:71], a[188:191], v[100:103], v[68:71]
    s_waitcnt lgkmcnt(3)
    v_mfma_f32_16x16x32_bf16 v[40:43], a[88:91], v[104:107], v[40:43]
    ds_read_b128 v[100:103], v1 offset:45056
    v_mfma_f32_16x16x32_bf16 v[56:59], a[92:95], v[104:107], v[56:59]
    v_mfma_f32_16x16x32_bf16 v[72:75], a[100:103], v[104:107], v[72:75]
    s_waitcnt lgkmcnt(3)
    v_mfma_f32_16x16x32_bf16 v[44:47], a[88:91], v[88:91], v[44:47]
    ds_read_b128 v[104:107], v1 offset:61440
    v_mfma_f32_16x16x32_bf16 v[60:63], a[92:95], v[88:91], v[60:63]
    v_fmac_f32 v32, v108, v80
    v_fmac_f32 v33, v109, v80
    v_mfma_f32_16x16x32_bf16 v[76:79], a[100:103], v[88:91], v[76:79]
    s_waitcnt lgkmcnt(3)
    v_fmac_f32 v34, v110, v80
    v_fmac_f32 v35, v111, v80
    v_mfma_f32_16x16x32_bf16 v[40:43], a[104:107], v[92:95], v[40:43]
    ds_read_b128 v[88:91], v1 offset:46080
    v_cvt_pk_bf16_f32 v120, v32, v33
    v_mfma_f32_16x16x32_bf16 v[56:59], a[112:115], v[92:95], v[56:59]
    v_cvt_pk_bf16_f32 v121, v34, v35
    v_fmac_f32 v36, v108, v82
    v_mfma_f32_16x16x32_bf16 v[72:75], a[116:119], v[92:95], v[72:75]
    s_waitcnt lgkmcnt(3)
    v_fmac_f32 v37, v109, v82
    v_fmac_f32 v38, v110, v82
    v_mfma_f32_16x16x32_bf16 v[44:47], a[104:107], v[96:99], v[44:47]
    ds_read_b128 v[92:95], v1 offset:62464
    v_fmac_f32 v39, v111, v82
    v_mfma_f32_16x16x32_bf16 v[60:63], a[112:115], v[96:99], v[60:63]
    v_cvt_pk_bf16_f32 v122, v36, v37
    v_cvt_pk_bf16_f32 v123, v38, v39
    v_mfma_f32_16x16x32_bf16 v[76:79], a[116:119], v[96:99], v[76:79]
    s_waitcnt lgkmcnt(3)
    v_pk_max_i16 v120, v120, 0
    v_pk_max_i16 v122, v122, 0
    v_mfma_f32_16x16x32_bf16 v[40:43], a[124:127], v[100:103], v[40:43]
    ds_read_b128 v[96:99], v1 offset:47104
    v_pk_max_i16 v121, v121, 0
    v_mfma_f32_16x16x32_bf16 v[56:59], a[128:131], v[100:103], v[56:59]
    v_pk_max_i16 v123, v123, 0
    v_mfma_f32_16x16x32_bf16 v[72:75], a[136:139], v[100:103], v[72:75]
    s_waitcnt lgkmcnt(3)
    v_permlane16_swap_b32 v120, v122
    v_mfma_f32_16x16x32_bf16 v[44:47], a[124:127], v[104:107], v[44:47]
    ds_read_b128 v[100:103], v1 offset:63488
    v_mfma_f32_16x16x32_bf16 v[60:63], a[128:131], v[104:107], v[60:63]
    v_permlane16_swap_b32 v121, v123
    v_mfma_f32_16x16x32_bf16 v[76:79], a[136:139], v[104:107], v[76:79]
    s_waitcnt lgkmcnt(3)
    buffer_store_dwordx4 v[120:123], v1, s[16:19], s99 offen offset:0
    v_mfma_f32_16x16x32_bf16 v[40:43], a[140:143], v[88:91], v[40:43]
    ds_read_b128 v[104:107], v1 offset:48128
    v_fmac_f32 v48, v112, v80
    v_mfma_f32_16x16x32_bf16 v[56:59], a[148:151], v[88:91], v[56:59]
    v_fmac_f32 v49, v113, v80
    v_fmac_f32 v50, v114, v80
    v_mfma_f32_16x16x32_bf16 v[72:75], a[152:155], v[88:91], v[72:75]
    s_waitcnt lgkmcnt(3)
    v_fmac_f32 v51, v115, v80
    v_cvt_pk_bf16_f32 v124, v48, v49
    v_mfma_f32_16x16x32_bf16 v[44:47], a[140:143], v[92:95], v[44:47]
    ds_read_b128 v[88:91], v1 offset:64512
    v_cvt_pk_bf16_f32 v125, v50, v51
    v_mfma_f32_16x16x32_bf16 v[60:63], a[148:151], v[92:95], v[60:63]
    v_fmac_f32 v52, v112, v82
    v_fmac_f32 v53, v113, v82
    v_mfma_f32_16x16x32_bf16 v[76:79], a[152:155], v[92:95], v[76:79]
    s_waitcnt lgkmcnt(3)
    v_fmac_f32 v54, v114, v82
    v_fmac_f32 v55, v115, v82
    v_mfma_f32_16x16x32_bf16 v[40:43], a[160:163], v[96:99], v[40:43]
    v_cvt_pk_bf16_f32 v126, v52, v53
    v_cvt_pk_bf16_f32 v127, v54, v55
    v_mfma_f32_16x16x32_bf16 v[56:59], a[164:167], v[96:99], v[56:59]
    v_pk_max_i16 v124, v124, 0
    v_pk_max_i16 v126, v126, 0
    v_mfma_f32_16x16x32_bf16 v[72:75], a[172:175], v[96:99], v[72:75]
    s_waitcnt lgkmcnt(2)
    v_pk_max_i16 v125, v125, 0
    v_pk_max_i16 v127, v127, 0
    v_mfma_f32_16x16x32_bf16 v[44:47], a[160:163], v[100:103], v[44:47]
    v_permlane16_swap_b32 v124, v126
    v_mfma_f32_16x16x32_bf16 v[60:63], a[164:167], v[100:103], v[60:63]
    v_permlane16_swap_b32 v125, v127
    v_mfma_f32_16x16x32_bf16 v[76:79], a[172:175], v[100:103], v[76:79]
    s_waitcnt lgkmcnt(1)
    buffer_store_dwordx4 v[124:127], v1, s[16:19], s100 offen offset:1024
    v_mfma_f32_16x16x32_bf16 v[40:43], a[176:179], v[104:107], v[40:43]
    v_fmac_f32 v64, v116, v80
    v_fmac_f32 v65, v117, v80
    v_mfma_f32_16x16x32_bf16 v[56:59], a[184:187], v[104:107], v[56:59]
    v_fmac_f32 v66, v118, v80
    v_fmac_f32 v67, v119, v80
    v_mfma_f32_16x16x32_bf16 v[72:75], a[188:191], v[104:107], v[72:75]
    s_waitcnt lgkmcnt(0)
    v_cvt_pk_bf16_f32 v120, v64, v65
    v_cvt_pk_bf16_f32 v121, v66, v67
    v_mfma_f32_16x16x32_bf16 v[44:47], a[176:179], v[88:91], v[44:47]
    v_fmac_f32 v68, v116, v82
    v_fmac_f32 v69, v117, v82
    v_mfma_f32_16x16x32_bf16 v[60:63], a[184:187], v[88:91], v[60:63]
    v_fmac_f32 v70, v118, v82
    v_fmac_f32 v71, v119, v82
    v_mfma_f32_16x16x32_bf16 v[76:79], a[188:191], v[88:91], v[76:79]
    v_cvt_pk_bf16_f32 v122, v68, v69
    v_cvt_pk_bf16_f32 v123, v70, v71
    v_pk_max_i16 v120, v120, 0
    v_pk_max_i16 v122, v122, 0
    v_pk_max_i16 v121, v121, 0
    v_pk_max_i16 v123, v123, 0
    v_permlane16_swap_b32 v120, v122
    s_nop 0
    v_permlane16_swap_b32_e64 v121, v123
    buffer_store_dwordx4 v[120:123], v1, s[16:19], s60 offen offset:2048
    v_pk_fma_f32 v[40:41], v[108:109], v[84:85], v[40:41] op_sel:[0,0,0] op_sel_hi:[1,0,1]
    v_pk_fma_f32 v[42:43], v[110:111], v[84:85], v[42:43] op_sel:[0,0,0] op_sel_hi:[1,0,1]
    v_cvt_pk_bf16_f32 v88, v40, v41
    v_cvt_pk_bf16_f32 v89, v42, v43
    v_pk_fma_f32 v[44:45], v[108:109], v[86:87], v[44:45] op_sel:[0,0,0] op_sel_hi:[1,0,1]
    v_pk_fma_f32 v[46:47], v[110:111], v[86:87], v[46:47] op_sel:[0,0,0] op_sel_hi:[1,0,1]
    v_cvt_pk_bf16_f32 v90, v44, v45
    v_cvt_pk_bf16_f32 v91, v46, v47
    v_pk_max_i16 v88, v88, 0
    v_pk_max_i16 v90, v90, 0
    v_pk_max_i16 v89, v89, 0
    v_pk_max_i16 v91, v91, 0
    v_permlane16_swap_b32 v88, v90
    s_nop 0
    v_permlane16_swap_b32_e64 v89, v91
    buffer_store_dwordx4 v[88:91], v1, s[16:19], s100 offen offset:0
    v_pk_fma_f32 v[56:57], v[112:113], v[84:85], v[56:57] op_sel:[0,0,0] op_sel_hi:[1,0,1]
    v_pk_fma_f32 v[58:59], v[114:115], v[84:85], v[58:59] op_sel:[0,0,0] op_sel_hi:[1,0,1]
    v_cvt_pk_bf16_f32 v92, v56, v57
    v_cvt_pk_bf16_f32 v93, v58, v59
    v_pk_fma_f32 v[60:61], v[112:113], v[86:87], v[60:61] op_sel:[0,0,0] op_sel_hi:[1,0,1]
    v_pk_fma_f32 v[62:63], v[114:115], v[86:87], v[62:63] op_sel:[0,0,0] op_sel_hi:[1,0,1]
    v_cvt_pk_bf16_f32 v94, v60, v61
    v_cvt_pk_bf16_f32 v95, v62, v63
    v_pk_max_i16 v92, v92, 0
    v_pk_max_i16 v94, v94, 0
    v_pk_max_i16 v93, v93, 0
    v_pk_max_i16 v95, v95, 0
    v_permlane16_swap_b32 v92, v94
    s_nop 0
    v_permlane16_swap_b32_e64 v93, v95
    buffer_store_dwordx4 v[92:95], v1, s[16:19], s99 offen offset:1024
    v_pk_fma_f32 v[72:73], v[116:117], v[84:85], v[72:73] op_sel:[0,0,0] op_sel_hi:[1,0,1]
    v_pk_fma_f32 v[74:75], v[118:119], v[84:85], v[74:75] op_sel:[0,0,0] op_sel_hi:[1,0,1]
    v_cvt_pk_bf16_f32 v96, v72, v73
    v_cvt_pk_bf16_f32 v97, v74, v75
    v_pk_fma_f32 v[76:77], v[116:117], v[86:87], v[76:77] op_sel:[0,0,0] op_sel_hi:[1,0,1]
    v_pk_fma_f32 v[78:79], v[118:119], v[86:87], v[78:79] op_sel:[0,0,0] op_sel_hi:[1,0,1]
    v_cvt_pk_bf16_f32 v98, v76, v77
    v_cvt_pk_bf16_f32 v99, v78, v79
    v_pk_max_i16 v96, v96, 0
    v_pk_max_i16 v98, v98, 0
    v_pk_max_i16 v97, v97, 0
    v_pk_max_i16 v99, v99, 0
    v_permlane16_swap_b32 v96, v98
    s_nop 0
    v_permlane16_swap_b32 v97, v99
    buffer_store_dwordx4 v[96:99], v1, s[16:19], s61 offen offset:2048
    v_mov_b32 v11, 7
    s_mov_b64 exec, 1
    s_waitcnt vmcnt(0)
    buffer_store_dword v11, off, s[16:19], s40
    s_mov_b64 exec, -1
    v_lshl_add_u32 v11, s25, 7, v6
    v_add_u32 v11, 161280, v11
    ds_read_b32 v14, v11
    s_lshl_b32 s44, s6, 11
    s_add_u32 s57, s35, s44
    s_cmp_ge_u32 s6, 2
    s_cselect_b32 s58, 134217728, s57
    v_lshl_add_u32 v12, s6, 12, v2
    v_xor_b32 v13, 0x1000, v12
    v_lshlrev_b32 v0, 8, v6
    v_lshrrev_b32 v11, 9, v1
    v_lshl_add_u32 v0, v11, 4, v0
    s_sleep 2
LF_poll_21:
    buffer_load_dword v11, v6, s[16:19], s39 offen sc1
    s_sub_u32 s46, s46, 1
    s_cbranch_scc1 L_end
    s_waitcnt vmcnt(0)
    v_cmp_gt_i32 vcc, 7, v11
    s_cbranch_vccnz LF_poll_21
    s_add_u32 m0, s44, 0
    s_nop 0
    buffer_load_dwordx4 v1, s[16:19], s57 offen offset:0 sc1 lds
    buffer_load_dwordx4 v1, s[16:19], s57 offen offset:1024 sc1 lds
    s_add_u32 s54, s57, 8192
    s_add_u32 m0, s44, 8192
    s_nop 0
    buffer_load_dwordx4 v1, s[16:19], s54 offen offset:0 sc1 lds
    buffer_load_dwordx4 v1, s[16:19], s54 offen offset:1024 sc1 lds
    s_add_u32 s54, s57, 16384
    s_add_u32 m0, s44, 16384
    s_nop 0
    buffer_load_dwordx4 v1, s[16:19], s54 offen offset:0 sc1 lds
    buffer_load_dwordx4 v1, s[16:19], s54 offen offset:1024 sc1 lds
    s_waitcnt vmcnt(4)
    s_barrier
    ds_read_b128 v[64:67], v3 offset:0
    ds_read_b128 v[68:71], v3 offset:2048
    ds_read_b128 v[72:75], v3 offset:4096
    ds_read_b128 v[76:79], v3 offset:6144
    s_add_u32 s54, s57, 24576
    s_add_u32 m0, s44, 24576
    s_nop 0
    buffer_load_dwordx4 v1, s[16:19], s54 offen offset:0 sc1 lds
    buffer_load_dwordx4 v1, s[16:19], s54 offen offset:1024 sc1 lds
    s_waitcnt lgkmcnt(3)
    v_mfma_f32_32x32x16_bf16 v[48:63], a[192:195], v[64:67], 0
    s_add_u32 s54, s57, 32768
    s_add_u32 m0, s44, 32768
    s_nop 0
    buffer_load_dwordx4 v1, s[16:19], s54 offen offset:0 sc1 lds
    s_waitcnt lgkmcnt(2)
    v_mfma_f32_32x32x16_bf16 v[48:63], a[196:199], v[68:71], v[48:63]
    s_waitcnt vmcnt(5)
    s_barrier
    ds_read_b128 v[80:83], v3 offset:8192
    ds_read_b128 v[84:87], v3 offset:10240
    s_waitcnt lgkmcnt(3)
    v_mfma_f32_32x32x16_bf16 v[48:63], a[200:203], v[72:75], v[48:63]
    ds_read_b128 v[88:91], v3 offset:12288
    ds_read_b128 v[92:95], v3 offset:14336
    s_waitcnt lgkmcnt(4)
    v_mfma_f32_32x32x16_bf16 v[48:63], a[204:207], v[76:79], v[48:63]
    buffer_load_dwordx4 v1, s[16:19], s54 offen offset:1024 sc1 lds
    s_waitcnt lgkmcnt(3)
    v_mfma_f32_32x32x16_bf16 v[48:63], a[208:211], v[80:83], v[48:63]
    s_add_u32 s54, s57, 40960
    s_add_u32 m0, s44, 40960
    s_nop 0
    buffer_load_dwordx4 v1, s[16:19], s54 offen offset:0 sc1 lds
    s_waitcnt lgkmcnt(2)
    v_mfma_f32_32x32x16_bf16 v[48:63], a[212:215], v[84:87], v[48:63]
    s_waitcnt vmcnt(5)
    s_barrier
    ds_read_b128 v[64:67], v3 offset:16384
    ds_read_b128 v[68:71], v3 offset:18432
    s_waitcnt lgkmcnt(3)
    v_mfma_f32_32x32x16_bf16 v[48:63], a[216:219], v[88:91], v[48:63]
    ds_read_b128 v[72:75], v3 offset:20480
    ds_read_b128 v[76:79], v3 offset:22528
    s_waitcnt lgkmcnt(4)
    v_mfma_f32_32x32x16_bf16 v[48:63], a[220:223], v[92:95], v[48:63]
    buffer_load_dwordx4 v1, s[16:19], s54 offen offset:1024 sc1 lds
    s_waitcnt lgkmcnt(3)
    v_mfma_f32_32x32x16_bf16 v[48:63], a[224:227], v[64:67], v[48:63]
    s_add_u32 s54, s57, 49152
    s_add_u32 m0, s44, 49152
    s_nop 0
    buffer_load_dwordx4 v1, s[16:19], s54 offen offset:0 sc1 lds
    s_waitcnt lgkmcnt(2)
    v_mfma_f32_32x32x16_bf16 v[48:63], a[228:231], v[68:71], v[48:63]
    s_waitcnt vmcnt(5)
    s_barrier
    ds_read_b128 v[80:83], v3 offset:24576
    ds_read_b128 v[84:87], v3 offset:26624
    s_waitcnt lgkmcnt(3)
    v_mfma_f32_32x32x16_bf16 v[48:63], a[232:235], v[72:75], v[48:63]
    ds_read_b128 v[88:91], v3 offset:28672
    ds_read_b128 v[92:95], v3 offset:30720
    s_waitcnt lgkmcnt(4)
    v_mfma_f32_32x32x16_bf16 v[48:63], a[236:239], v[76:79], v[48:63]
    buffer_load_dwordx4 v1, s[16:19], s54 offen offset:1024 sc1 lds
    s_waitcnt lgkmcnt(3)
    v_mfma_f32_32x32x16_bf16 v[48:63], a[240:243], v[80:83], v[48:63]
    s_add_u32 s54, s57, 57344
    s_add_u32 m0, s44, 57344
    s_nop 0
    buffer_load_dwordx4 v1, s[16:19], s54 offen offset:0 sc1 lds
    s_waitcnt lgkmcnt(2)
    v_mfma_f32_32x32x16_bf16 v[48:63], a[244:247], v[84:87], v[48:63]
    s_waitcnt vmcnt(5)
    s_barrier
    ds_read_b128 v[64:67], v3 offset:32768
    ds_read_b128 v[68:71], v3 offset:34816
    s_waitcnt lgkmcnt(3)
    v_mfma_f32_32x32x16_bf16 v[48:63], a[248:251], v[88:91], v[48:63]
    ds_read_b128 v[72:75], v3 offset:36864
    ds_read_b128 v[76:79], v3 offset:38912
    s_waitcnt lgkmcnt(4)
    v_mfma_f32_32x32x16_bf16 v[48:63], a[252:255], v[92:95], v[48:63]
    buffer_load_dwordx4 v1, s[16:19], s54 offen offset:1024 sc1 lds
    s_waitcnt lgkmcnt(3)
    v_mfma_f32_32x32x16_bf16 v[48:63], v[128:131], v[64:67], v[48:63]
    s_add_u32 s54, s57, 65536
    s_add_u32 m0, s44, 0
    s_nop 0
    buffer_load_dwordx4 v1, s[16:19], s54 offen offset:0 sc1 lds
    s_waitcnt lgkmcnt(2)
    v_mfma_f32_32x32x16_bf16 v[48:63], v[132:135], v[68:71], v[48:63]
    s_waitcnt vmcnt(5)
    s_barrier
    ds_read_b128 v[80:83], v3 offset:40960
    ds_read_b128 v[84:87], v3 offset:43008
    s_waitcnt lgkmcnt(3)
    v_mfma_f32_32x32x16_bf16 v[48:63], v[136:139], v[72:75], v[48:63]
    ds_read_b128 v[88:91], v3 offset:45056
    ds_read_b128 v[92:95], v3 offset:47104
    s_waitcnt lgkmcnt(4)
    v_mfma_f32_32x32x16_bf16 v[48:63], v[140:143], v[76:79], v[48:63]
    buffer_load_dwordx4 v1, s[16:19], s54 offen offset:1024 sc1 lds
    s_waitcnt lgkmcnt(3)
    v_mfma_f32_32x32x16_bf16 v[48:63], v[144:147], v[80:83], v[48:63]
    s_add_u32 s54, s57, 73728
    s_add_u32 m0, s44, 8192
    s_nop 0
    buffer_load_dwordx4 v1, s[16:19], s54 offen offset:0 sc1 lds
    s_waitcnt lgkmcnt(2)
    v_mfma_f32_32x32x16_bf16 v[48:63], v[148:151], v[84:87], v[48:63]
    s_waitcnt vmcnt(5)
    s_barrier
    ds_read_b128 v[64:67], v3 offset:49152
    ds_read_b128 v[68:71], v3 offset:51200
    s_waitcnt lgkmcnt(3)
    v_mfma_f32_32x32x16_bf16 v[48:63], v[152:155], v[88:91], v[48:63]
    ds_read_b128 v[72:75], v3 offset:53248
    ds_read_b128 v[76:79], v3 offset:55296
    s_waitcnt lgkmcnt(4)
    v_mfma_f32_32x32x16_bf16 v[48:63], v[156:159], v[92:95], v[48:63]
    buffer_load_dwordx4 v1, s[16:19], s54 offen offset:1024 sc1 lds
    s_waitcnt lgkmcnt(3)
    v_mfma_f32_32x32x16_bf16 v[48:63], v[160:163], v[64:67], v[48:63]
    s_add_u32 s54, s57, 81920
    s_add_u32 m0, s44, 16384
    s_nop 0
    buffer_load_dwordx4 v1, s[16:19], s54 offen offset:0 sc1 lds
    s_waitcnt lgkmcnt(2)
    v_mfma_f32_32x32x16_bf16 v[48:63], v[164:167], v[68:71], v[48:63]
    s_waitcnt vmcnt(5)
    s_barrier
    ds_read_b128 v[80:83], v3 offset:57344
    ds_read_b128 v[84:87], v3 offset:59392
    s_waitcnt lgkmcnt(3)
    v_mfma_f32_32x32x16_bf16 v[48:63], v[168:171], v[72:75], v[48:63]
    ds_read_b128 v[88:91], v3 offset:61440
    ds_read_b128 v[92:95], v3 offset:63488
    s_waitcnt lgkmcnt(4)
    v_mfma_f32_32x32x16_bf16 v[48:63], v[172:175], v[76:79], v[48:63]
    buffer_load_dwordx4 v1, s[16:19], s54 offen offset:1024 sc1 lds
    s_waitcnt lgkmcnt(3)
    v_mfma_f32_32x32x16_bf16 v[48:63], v[176:179], v[80:83], v[48:63]
    s_add_u32 s54, s57, 90112
    s_add_u32 m0, s44, 24576
    s_nop 0
    buffer_load_dwordx4 v1, s[16:19], s54 offen offset:0 sc1 lds
    s_waitcnt lgkmcnt(2)
    v_mfma_f32_32x32x16_bf16 v[48:63], v[180:183], v[84:87], v[48:63]
    s_waitcnt vmcnt(5)
    s_barrier
    ds_read_b128 v[64:67], v3 offset:0
    ds_read_b128 v[68:71], v3 offset:2048
    s_waitcnt lgkmcnt(3)
    v_mfma_f32_32x32x16_bf16 v[48:63], v[184:187], v[88:91], v[48:63]
    ds_read_b128 v[72:75], v3 offset:4096
    ds_read_b128 v[76:79], v3 offset:6144
    s_waitcnt lgkmcnt(4)
    v_mfma_f32_32x32x16_bf16 v[48:63], v[188:191], v[92:95], v[48:63]
    buffer_load_dwordx4 v1, s[16:19], s54 offen offset:1024 sc1 lds
    s_waitcnt lgkmcnt(3)
    v_mfma_f32_32x32x16_bf16 v[48:63], v[192:195], v[64:67], v[48:63]
    s_add_u32 s54, s57, 98304
    s_add_u32 m0, s44, 32768
    s_nop 0
    buffer_load_dwordx4 v1, s[16:19], s54 offen offset:0 sc1 lds
    s_waitcnt lgkmcnt(2)
    v_mfma_f32_32x32x16_bf16 v[48:63], v[196:199], v[68:71], v[48:63]
    s_waitcnt vmcnt(5)
    s_barrier
    ds_read_b128 v[80:83], v3 offset:8192
    ds_read_b128 v[84:87], v3 offset:10240
    s_waitcnt lgkmcnt(3)
    v_mfma_f32_32x32x16_bf16 v[48:63], v[200:203], v[72:75], v[48:63]
    ds_read_b128 v[88:91], v3 offset:12288
    ds_read_b128 v[92:95], v3 offset:14336
    s_waitcnt lgkmcnt(4)
    v_mfma_f32_32x32x16_bf16 v[48:63], v[204:207], v[76:79], v[48:63]
    buffer_load_dwordx4 v1, s[16:19], s54 offen offset:1024 sc1 lds
    s_waitcnt lgkmcnt(3)
    v_mfma_f32_32x32x16_bf16 v[48:63], v[208:211], v[80:83], v[48:63]
    s_add_u32 s54, s57, 106496
    s_add_u32 m0, s44, 40960
    s_nop 0
    buffer_load_dwordx4 v1, s[16:19], s54 offen offset:0 sc1 lds
    s_waitcnt lgkmcnt(2)
    v_mfma_f32_32x32x16_bf16 v[48:63], v[212:215], v[84:87], v[48:63]
    s_waitcnt vmcnt(5)
    s_barrier
    ds_read_b128 v[64:67], v3 offset:16384
    ds_read_b128 v[68:71], v3 offset:18432
    s_waitcnt lgkmcnt(3)
    v_mfma_f32_32x32x16_bf16 v[48:63], v[216:219], v[88:91], v[48:63]
    ds_read_b128 v[72:75], v3 offset:20480
    ds_read_b128 v[76:79], v3 offset:22528
    s_waitcnt lgkmcnt(4)
    v_mfma_f32_32x32x16_bf16 v[48:63], v[220:223], v[92:95], v[48:63]
    buffer_load_dwordx4 v1, s[16:19], s54 offen offset:1024 sc1 lds
    s_waitcnt lgkmcnt(3)
    v_mfma_f32_32x32x16_bf16 v[48:63], v[224:227], v[64:67], v[48:63]
    s_add_u32 s54, s57, 114688
    s_add_u32 m0, s44, 49152
    s_nop 0
    buffer_load_dwordx4 v1, s[16:19], s54 offen offset:0 sc1 lds
    s_waitcnt lgkmcnt(2)
    v_mfma_f32_32x32x16_bf16 v[48:63], v[228:231], v[68:71], v[48:63]
    s_waitcnt vmcnt(5)
    s_barrier
    ds_read_b128 v[80:83], v3 offset:24576
    ds_read_b128 v[84:87], v3 offset:26624
    s_waitcnt lgkmcnt(3)
    v_mfma_f32_32x32x16_bf16 v[48:63], v[232:235], v[72:75], v[48:63]
    ds_read_b128 v[88:91], v3 offset:28672
    ds_read_b128 v[92:95], v3 offset:30720
    s_waitcnt lgkmcnt(4)
    v_mfma_f32_32x32x16_bf16 v[32:47], a[192:195], v[76:79], 0
    buffer_load_dwordx4 v1, s[16:19], s54 offen offset:1024 sc1 lds
    s_waitcnt lgkmcnt(3)
    v_mfma_f32_32x32x16_bf16 v[32:47], a[196:199], v[80:83], v[32:47]
    s_add_u32 s54, s57, 122880
    s_add_u32 m0, s44, 57344
    s_nop 0
    buffer_load_dwordx4 v1, s[16:19], s54 offen offset:0 sc1 lds
    s_nop 0
    v_cvt_pk_bf16_f32 v48, v48, v49
    v_cvt_pk_bf16_f32 v49, v50, v51
    s_waitcnt lgkmcnt(2)
    v_mfma_f32_32x32x16_bf16 v[32:47], a[200:203], v[84:87], v[32:47]
    s_waitcnt vmcnt(5)
    s_barrier
    ds_read_b128 v[64:67], v3 offset:32768
    ds_read_b128 v[68:71], v3 offset:34816
    v_cvt_pk_bf16_f32 v50, v52, v53
    s_waitcnt lgkmcnt(3)
    v_mfma_f32_32x32x16_bf16 v[32:47], a[204:207], v[88:91], v[32:47]
    ds_read_b128 v[72:75], v3 offset:36864
    ds_read_b128 v[76:79], v3 offset:38912
    v_cvt_pk_bf16_f32 v51, v54, v55
    v_cvt_pk_bf16_f32 v52, v56, v57
    v_cvt_pk_bf16_f32 v53, v58, v59
    s_waitcnt lgkmcnt(4)
    v_mfma_f32_32x32x16_bf16 v[32:47], a[208:211], v[92:95], v[32:47]
    buffer_load_dwordx4 v1, s[16:19], s54 offen offset:1024 sc1 lds
    v_cvt_pk_bf16_f32 v54, v60, v61
    v_cvt_pk_bf16_f32 v55, v62, v63
    s_waitcnt lgkmcnt(3)
    v_mfma_f32_32x32x16_bf16 v[32:47], a[212:215], v[64:67], v[32:47]
    s_add_u32 s54, s57, 131072
    s_add_u32 m0, s44, 0
    s_nop 0
    buffer_load_dwordx4 v1, s[16:19], s54 offen offset:0 sc1 lds
    s_waitcnt lgkmcnt(2)
    v_mfma_f32_32x32x16_bf16 v[32:47], a[216:219], v[68:71], v[32:47]
    s_waitcnt vmcnt(5)
    s_barrier
    ds_read_b128 v[80:83], v3 offset:40960
    ds_read_b128 v[84:87], v3 offset:43008
    s_waitcnt lgkmcnt(3)
    v_mfma_f32_32x32x16_bf16 v[32:47], a[220:223], v[72:75], v[32:47]
    ds_read_b128 v[88:91], v3 offset:45056
    ds_read_b128 v[92:95], v3 offset:47104
    s_waitcnt lgkmcnt(4)
    v_mfma_f32_32x32x16_bf16 v[32:47], a[224:227], v[76:79], v[32:47]
    buffer_load_dwordx4 v1, s[16:19], s54 offen offset:1024 sc1 lds
    s_waitcnt lgkmcnt(3)
    v_mfma_f32_32x32x16_bf16 v[32:47], a[228:231], v[80:83], v[32:47]
    s_add_u32 s54, s57, 139264
    s_add_u32 m0, s44, 8192
    s_nop 0
    buffer_load_dwordx4 v1, s[16:19], s54 offen offset:0 sc1 lds
    s_waitcnt lgkmcnt(2)
    v_mfma_f32_32x32x16_bf16 v[32:47], a[232:235], v[84:87], v[32:47]
    s_waitcnt vmcnt(5)
    s_barrier
    ds_read_b128 v[64:67], v3 offset:49152
    ds_read_b128 v[68:71], v3 offset:51200
    s_waitcnt lgkmcnt(3)
    v_mfma_f32_32x32x16_bf16 v[32:47], a[236:239], v[88:91], v[32:47]
    ds_read_b128 v[72:75], v3 offset:53248
    ds_read_b128 v[76:79], v3 offset:55296
    s_waitcnt lgkmcnt(4)
    v_mfma_f32_32x32x16_bf16 v[32:47], a[240:243], v[92:95], v[32:47]
    buffer_load_dwordx4 v1, s[16:19], s54 offen offset:1024 sc1 lds
    s_waitcnt lgkmcnt(3)
    v_mfma_f32_32x32x16_bf16 v[32:47], a[244:247], v[64:67], v[32:47]
    s_add_u32 s54, s57, 147456
    s_add_u32 m0, s44, 16384
    s_nop 0
    buffer_load_dwordx4 v1, s[16:19], s54 offen offset:0 sc1 lds
L_pad8:
    s_cbranch_execz L_body
    s_waitcnt lgkmcnt(2)
    v_mfma_f32_32x32x16_bf16 v[32:47], a[248:251], v[68:71], v[32:47]
    s_waitcnt vmcnt(5)
    s_barrier
    ds_read_b128 v[80:83], v3 offset:57344
    ds_read_b128 v[84:87], v3 offset:59392
    s_waitcnt lgkmcnt(3)
    v_mfma_f32_32x32x16_bf16 v[32:47], a[252:255], v[72:75], v[32:47]
    ds_read_b128 v[88:91], v3 offset:61440
    ds_read_b128 v[92:95], v3 offset:63488
    s_waitcnt lgkmcnt(4)
    v_mfma_f32_32x32x16_bf16 v[32:47], v[128:131], v[76:79], v[32:47]
    buffer_load_dwordx4 v1, s[16:19], s54 offen offset:1024 sc1 lds
    s_waitcnt lgkmcnt(3)
    v_mfma_f32_32x32x16_bf16 v[32:47], v[132:135], v[80:83], v[32:47]
    s_add_u32 s54, s57, 155648
    s_add_u32 m0, s44, 24576
    s_nop 0
    buffer_load_dwordx4 v1, s[16:19], s54 offen offset:0 sc1 lds
    s_waitcnt lgkmcnt(2)
    v_mfma_f32_32x32x16_bf16 v[32:47], v[136:139], v[84:87], v[32:47]
    s_waitcnt vmcnt(5)
    s_barrier
    ds_read_b128 v[64:67], v3 offset:0
    ds_read_b128 v[68:71], v3 offset:2048
    s_waitcnt lgkmcnt(3)
    v_mfma_f32_32x32x16_bf16 v[32:47], v[140:143], v[88:91], v[32:47]
    ds_read_b128 v[72:75], v3 offset:4096
    ds_read_b128 v[76:79], v3 offset:6144
    s_waitcnt lgkmcnt(4)
    v_mfma_f32_32x32x16_bf16 v[32:47], v[144:147], v[92:95], v[32:47]
    buffer_load_dwordx4 v1, s[16:19], s54 offen offset:1024 sc1 lds
    s_waitcnt lgkmcnt(3)
    v_mfma_f32_32x32x16_bf16 v[32:47], v[148:151], v[64:67], v[32:47]
    s_add_u32 s54, s57, 163840
    s_add_u32 m0, s44, 32768
    s_nop 0
    buffer_load_dwordx4 v1, s[16:19], s54 offen offset:0 sc1 lds
    s_waitcnt lgkmcnt(2)
    v_mfma_f32_32x32x16_bf16 v[32:47], v[152:155], v[68:71], v[32:47]
    s_waitcnt vmcnt(5)
    s_barrier
    ds_read_b128 v[80:83], v3 offset:8192
    ds_read_b128 v[84:87], v3 offset:10240
    s_waitcnt lgkmcnt(3)
    v_mfma_f32_32x32x16_bf16 v[32:47], v[156:159], v[72:75], v[32:47]
    ds_read_b128 v[88:91], v3 offset:12288
    ds_read_b128 v[92:95], v3 offset:14336
    s_waitcnt lgkmcnt(4)
    v_mfma_f32_32x32x16_bf16 v[32:47], v[160:163], v[76:79], v[32:47]
    buffer_load_dwordx4 v1, s[16:19], s54 offen offset:1024 sc1 lds
    s_waitcnt lgkmcnt(3)
    v_mfma_f32_32x32x16_bf16 v[32:47], v[164:167], v[80:83], v[32:47]
    s_add_u32 s54, s58, 172032
    s_add_u32 m0, s44, 40960
    s_nop 0
    buffer_load_dwordx4 v1, s[16:19], s54 offen offset:0 sc1 lds
    s_waitcnt lgkmcnt(2)
    v_mfma_f32_32x32x16_bf16 v[32:47], v[168:171], v[84:87], v[32:47]
    s_waitcnt vmcnt(5)
    s_barrier
    ds_read_b128 v[64:67], v3 offset:16384
    ds_read_b128 v[68:71], v3 offset:18432
    s_waitcnt lgkmcnt(3)
    v_mfma_f32_32x32x16_bf16 v[32:47], v[172:175], v[88:91], v[32:47]
    ds_read_b128 v[72:75], v3 offset:20480
    ds_read_b128 v[76:79], v3 offset:22528
    s_waitcnt lgkmcnt(4)
    v_mfma_f32_32x32x16_bf16 v[32:47], v[176:179], v[92:95], v[32:47]
    buffer_load_dwordx4 v1, s[16:19], s54 offen offset:1024 sc1 lds
    s_waitcnt lgkmcnt(3)
    v_mfma_f32_32x32x16_bf16 v[32:47], v[180:183], v[64:67], v[32:47]
    s_waitcnt lgkmcnt(2)
    v_mfma_f32_32x32x16_bf16 v[32:47], v[184:187], v[68:71], v[32:47]
    s_waitcnt vmcnt(4)
    s_barrier
    ds_read_b128 v[80:83], v3 offset:24576
    ds_read_b128 v[84:87], v3 offset:26624
    s_waitcnt lgkmcnt(3)
    v_mfma_f32_32x32x16_bf16 v[32:47], v[188:191], v[72:75], v[32:47]
    ds_read_b128 v[88:91], v3 offset:28672
    ds_read_b128 v[92:95], v3 offset:30720
    s_waitcnt lgkmcnt(4)
    v_mfma_f32_32x32x16_bf16 v[32:47], v[192:195], v[76:79], v[32:47]
    s_waitcnt lgkmcnt(3)
    v_mfma_f32_32x32x16_bf16 v[32:47], v[196:199], v[80:83], v[32:47]
    s_waitcnt lgkmcnt(2)
    v_mfma_f32_32x32x16_bf16 v[32:47], v[200:203], v[84:87], v[32:47]
    s_waitcnt vmcnt(2)
    s_barrier
    ds_read_b128 v[64:67], v3 offset:32768
    ds_read_b128 v[68:71], v3 offset:34816
    s_waitcnt lgkmcnt(3)
    v_mfma_f32_32x32x16_bf16 v[32:47], v[204:207], v[88:91], v[32:47]
    ds_read_b128 v[72:75], v3 offset:36864
    ds_read_b128 v[76:79], v3 offset:38912
    s_waitcnt lgkmcnt(4)
    v_mfma_f32_32x32x16_bf16 v[32:47], v[208:211], v[92:95], v[32:47]
    ds_write_b128 v12, v[48:51] offset:0
    s_waitcnt lgkmcnt(4)
    v_mfma_f32_32x32x16_bf16 v[32:47], v[212:215], v[64:67], v[32:47]
    ds_write_b128 v12, v[52:55] offset:1024
    s_waitcnt lgkmcnt(4)
    v_mfma_f32_32x32x16_bf16 v[32:47], v[216:219], v[68:71], v[32:47]
    s_waitcnt lgkmcnt(0)
    s_waitcnt vmcnt(0)
    s_barrier
    ds_read_b128 v[80:83], v3 offset:40960
    ds_read_b128 v[84:87], v3 offset:43008
    v_mfma_f32_32x32x16_bf16 v[32:47], v[220:223], v[72:75], v[32:47]
    ds_read_b128 v[56:59], v13 offset:0
    ds_read_b128 v[60:63], v13 offset:1024
    v_mfma_f32_32x32x16_bf16 v[32:47], v[224:227], v[76:79], v[32:47]
    s_waitcnt lgkmcnt(0)
    v_lshlrev_b32 v48, 16, v56
    v_and_b32 v49, 0xffff0000, v56
    v_lshlrev_b32 v50, 16, v57
    v_and_b32 v51, 0xffff0000, v57
    v_lshlrev_b32 v52, 16, v58
    v_and_b32 v53, 0xffff0000, v58
    v_mfma_f32_32x32x16_bf16 v[32:47], v[228:231], v[80:83], v[32:47]
    v_lshlrev_b32 v54, 16, v59
    v_and_b32 v55, 0xffff0000, v59
    v_lshlrev_b32 v56, 16, v60
    v_and_b32 v57, 0xffff0000, v60
    v_lshlrev_b32 v58, 16, v61
    v_and_b32 v59, 0xffff0000, v61
    v_mfma_f32_32x32x16_bf16 v[32:47], v[232:235], v[84:87], v[32:47]
    v_lshlrev_b32 v60, 16, v62
    v_and_b32 v61, 0xffff0000, v62
    v_lshlrev_b32 v62, 16, v63
    v_and_b32 v63, 0xffff0000, v63
    v_fmac_f32 v16, v14, v48
    v_fmac_f32 v17, v14, v49
    v_fmac_f32 v18, v14, v50
    v_fmac_f32 v19, v14, v51
    v_fmac_f32 v20, v14, v52
    v_fmac_f32 v21, v14, v53
    v_fmac_f32 v22, v14, v54
    v_fmac_f32 v23, v14, v55
    v_fmac_f32 v24, v14, v56
    v_fmac_f32 v25, v14, v57
    v_fmac_f32 v26, v14, v58
    v_fmac_f32 v27, v14, v59
    v_fmac_f32 v28, v14, v60
    v_fmac_f32 v29, v14, v61
    v_fmac_f32 v30, v14, v62
    v_fmac_f32_e64 v31, v14, v63
    v_pk_fma_f32 v[16:17], v[32:33], v[14:15], v[16:17] op_sel:[0,0,0] op_sel_hi:[1,0,1]
    v_pk_fma_f32 v[18:19], v[34:35], v[14:15], v[18:19] op_sel:[0,0,0] op_sel_hi:[1,0,1]
    v_pk_fma_f32 v[20:21], v[36:37], v[14:15], v[20:21] op_sel:[0,0,0] op_sel_hi:[1,0,1]
    v_pk_fma_f32 v[22:23], v[38:39], v[14:15], v[22:23] op_sel:[0,0,0] op_sel_hi:[1,0,1]
    v_cvt_pk_bf16_f32 v64, v16, v17
    v_cvt_pk_bf16_f32 v65, v18, v19
    v_cvt_pk_bf16_f32 v66, v20, v21
    v_cvt_pk_bf16_f32 v67, v22, v23
    buffer_store_dwordx4 v[64:67], v0, s[12:15], s41 offen offset:0
    v_pk_fma_f32 v[24:25], v[40:41], v[14:15], v[24:25] op_sel:[0,0,0] op_sel_hi:[1,0,1]
    v_pk_fma_f32 v[26:27], v[42:43], v[14:15], v[26:27] op_sel:[0,0,0] op_sel_hi:[1,0,1]
    v_pk_fma_f32 v[28:29], v[44:45], v[14:15], v[28:29] op_sel:[0,0,0] op_sel_hi:[1,0,1]
    v_pk_fma_f32 v[30:31], v[46:47], v[14:15], v[30:31] op_sel:[0,0,0] op_sel_hi:[1,0,1]
    v_cvt_pk_bf16_f32 v68, v24, v25
    v_cvt_pk_bf16_f32 v69, v26, v27
    v_cvt_pk_bf16_f32 v70, v28, v29
    v_cvt_pk_bf16_f32 v71, v30, v31
    buffer_store_dwordx4 v[68:71], v0, s[12:15], s41 offen offset:32
    s_or_b32 s3, s2, s6
    s_cmp_lg_u32 s3, 0
    s_cbranch_scc1 LF_noE_22
    v_mov_b32 v12, s62
    v_mov_b32 v13, s63
    v_mov_b32 v11, 0
    s_mov_b64 exec, 1
    buffer_store_dwordx2 v[12:13], v11, s[16:19], 0 offen sc1
    s_mov_b64 exec, -1
LF_noE_22:
    s_endpgm
LF_retry_1:
    s_sleep 4
    s_mov_b64 exec, vcc
    buffer_load_dwordx2 v[126:127], v124, s[16:19], 0 offen sc1
    s_mov_b64 exec, -1
    s_sub_u32 s46, s46, 1
    s_cbranch_scc1 L_end
    s_waitcnt vmcnt(0)
    v_and_b32 v11, -16, v126
    v_xor_b32 v11, s62, v11
    v_xor_b32 v153, s63, v127
    v_or_b32 v152, v11, v153
    v_cmp_ne_u32 vcc, 0, v152
    s_cbranch_vccnz LF_retry_1
    s_branch LF_got_2
LF_retry_3:
    s_sleep 4
    s_mov_b64 exec, vcc
    s_movk_i32 s3, 8192
    buffer_load_dwordx4 v[128:131], v1, s[16:19], s3 offen offset:0 sc1
    buffer_load_dwordx4 v[132:135], v1, s[16:19], s3 offen offset:1024 sc1
    s_mov_b64 exec, -1
    s_sub_u32 s46, s46, 1
    s_cbranch_scc1 L_end
    s_waitcnt vmcnt(0)
    v_and_b32 v11, -16, v128
    v_xor_b32 v11, s62, v11
    v_xor_b32 v153, s63, v129
    v_or_b32 v152, v11, v153
    v_and_b32 v11, -16, v130
    v_xor_b32 v11, s62, v11
    v_xor_b32 v153, s63, v131
    v_or3_b32 v152, v11, v153, v152
    v_and_b32 v11, -16, v132
    v_xor_b32 v11, s62, v11
    v_xor_b32 v153, s63, v133
    v_or3_b32 v152, v11, v153, v152
    v_and_b32 v11, -16, v134
    v_xor_b32 v11, s62, v11
    v_xor_b32 v153, s63, v135
    v_or3_b32 v152, v11, v153, v152
    v_cmp_ne_u32 vcc, 0, v152
    s_cbranch_vccnz LF_retry_3
    s_branch LF_got_4
LF_spin_6:
    buffer_load_dword v11, v6, s[16:19], s39 offen sc1
    s_sub_u32 s46, s46, 1
    s_cbranch_scc1 L_end
    s_waitcnt vmcnt(0)
    v_cmp_gt_i32 vcc, 1, v11
    s_cbranch_vccnz LF_spin_6
    s_branch LF_got_7
LF_spin_10:
    buffer_load_dword v11, v6, s[16:19], s39 offen sc1
    s_sub_u32 s46, s46, 1
    s_cbranch_scc1 L_end
    s_waitcnt vmcnt(0)
    v_cmp_gt_i32 vcc, 3, v11
    s_cbranch_vccnz LF_spin_10
    s_branch LF_got_11
LF_spin_13:
    buffer_load_dword v11, v6, s[16:19], s39 offen sc1
    s_sub_u32 s46, s46, 1
    s_cbranch_scc1 L_end
    s_waitcnt vmcnt(0)
    v_cmp_gt_i32 vcc, 4, v11
    s_cbranch_vccnz LF_spin_13
    s_branch LF_got_14
LF_retry_15:
    s_sleep 4
    s_mov_b64 exec, vcc
    buffer_load_dwordx4 v[16:19], v1, s[16:19], s97 offen offset:0 sc1
    buffer_load_dwordx4 v[20:23], v1, s[16:19], s97 offen offset:1024 sc1
    buffer_load_dwordx4 v[24:27], v1, s[16:19], s98 offen offset:0 sc1
    buffer_load_dwordx4 v[28:31], v1, s[16:19], s98 offen offset:1024 sc1
    buffer_load_dwordx4 v[116:119], v124, s[16:19], s38 offen offset:2048 sc1
    buffer_load_dwordx4 v[120:123], v124, s[16:19], s38 offen offset:2304 sc1
    s_mov_b64 exec, -1
    s_sub_u32 s46, s46, 1
    s_cbranch_scc1 L_end
    s_waitcnt vmcnt(0)
    v_max3_u32 v11, v16, v17, v18
    v_max3_u32 v11, v11, v19, v20
    v_max3_u32 v11, v11, v21, v22
    v_max3_u32 v11, v11, v23, v24
    v_max3_u32 v11, v11, v25, v26
    v_max3_u32 v11, v11, v27, v28
    v_max3_u32 v11, v11, v29, v30
    v_max3_u32 v11, v11, v31, v116
    v_max3_u32 v11, v11, v117, v118
    v_max3_u32 v11, v11, v119, v120
    v_max3_u32 v11, v11, v121, v122
    v_max_u32 v11, v11, v123
    v_cmp_eq_u32 vcc, -1, v11
    s_cbranch_vccnz LF_retry_15
    s_branch LF_got_16
LF_spin_19:
    buffer_load_dword v11, v6, s[16:19], s39 offen sc1
    s_sub_u32 s46, s46, 1
    s_cbranch_scc1 L_end
    s_waitcnt vmcnt(0)
    v_cmp_gt_i32 vcc, 6, v11
    s_cbranch_vccnz LF_spin_19
    s_branch LF_got_20
L_end:
    s_endpgm
L_slow:
    ds_read_b128 v[88:91], v10 offset:64
    ds_read_b128 v[92:95], v10 offset:576
    ds_read_b128 v[96:99], v10 offset:128
    ds_read_b128 v[100:103], v10 offset:640
    ds_read_b128 v[104:107], v10 offset:192
    s_lshl2_add_u32 s3, s5, s6
    s_lshl_b32 s3, s3, 10
    s_add_u32 s3, s3, s35
    s_lshl_b32 s58, s25, 15
    s_xor_b32 s57, s58, 0x8000
    s_add_u32 s57, s57, s3
    s_add_u32 s58, s58, s3
    s_waitcnt lgkmcnt(5)
    v_pk_fma_f32 v[32:33], v[236:237], v[16:17], v[32:33] op_sel:[0,0,0] op_sel_hi:[1,0,1]
    v_pk_fma_f32 v[34:35], v[238:239], v[16:17], v[34:35] op_sel:[0,0,0] op_sel_hi:[1,0,1]
    v_cvt_pk_bf16_f32 v32, v32, v33
    v_cvt_pk_bf16_f32 v33, v34, v35
    v_pk_fma_f32 v[36:37], v[236:237], v[18:19], v[36:37] op_sel:[0,0,0] op_sel_hi:[1,0,1]
    v_pk_fma_f32 v[38:39], v[238:239], v[18:19], v[38:39] op_sel:[0,0,0] op_sel_hi:[1,0,1]
    v_cvt_pk_bf16_f32 v36, v36, v37
    v_cvt_pk_bf16_f32 v37, v38, v39
    v_pk_fma_f32 v[40:41], v[236:237], v[20:21], v[40:41] op_sel:[0,0,0] op_sel_hi:[1,0,1]
    v_pk_fma_f32 v[42:43], v[238:239], v[20:21], v[42:43] op_sel:[0,0,0] op_sel_hi:[1,0,1]
    v_cvt_pk_bf16_f32 v40, v40, v41
    v_cvt_pk_bf16_f32 v41, v42, v43
    v_pk_fma_f32 v[44:45], v[236:237], v[22:23], v[44:45] op_sel:[0,0,0] op_sel_hi:[1,0,1]
    v_pk_fma_f32 v[46:47], v[238:239], v[22:23], v[46:47] op_sel:[0,0,0] op_sel_hi:[1,0,1]
    v_cvt_pk_bf16_f32 v44, v44, v45
    v_cvt_pk_bf16_f32 v45, v46, v47
    v_pk_fma_f32 v[68:69], v[108:109], v[244:245], v[68:69] op_sel:[0,0,0] op_sel_hi:[1,0,1]
    v_pk_fma_f32 v[70:71], v[110:111], v[244:245], v[70:71] op_sel:[0,0,0] op_sel_hi:[1,0,1]
    v_pk_mul_f32 v[68:69], v[68:69], v[112:113]
    v_pk_mul_f32 v[70:71], v[70:71], v[114:115]
    v_cvt_pk_bf16_f32 v68, v68, v69
    v_cvt_pk_bf16_f32 v69, v70, v71
    s_add_u32 m0, s29, 118784
    s_add_u32 s54, s28, 294912
    buffer_load_dwordx4 v150, s[12:15], s54 offen lds
    v_pk_fma_f32 v[72:73], v[116:117], v[244:245], v[72:73] op_sel:[0,0,0] op_sel_hi:[1,0,1]
    v_pk_fma_f32 v[74:75], v[118:119], v[244:245], v[74:75] op_sel:[0,0,0] op_sel_hi:[1,0,1]
    v_pk_mul_f32 v[72:73], v[72:73], v[120:121]
    v_pk_mul_f32 v[74:75], v[74:75], v[122:123]
    v_cvt_pk_bf16_f32 v70, v72, v73
    v_cvt_pk_bf16_f32 v71, v74, v75
    s_waitcnt lgkmcnt(0)
    v_pk_fma_f32 v[76:77], v[88:89], v[244:245], v[76:77] op_sel:[0,0,0] op_sel_hi:[1,0,1]
    v_pk_fma_f32 v[78:79], v[90:91], v[244:245], v[78:79] op_sel:[0,0,0] op_sel_hi:[1,0,1]
    v_pk_mul_f32 v[76:77], v[76:77], v[92:93]
    v_pk_mul_f32 v[78:79], v[78:79], v[94:95]
    v_cvt_pk_bf16_f32 v72, v76, v77
    v_cvt_pk_bf16_f32 v73, v78, v79
    v_pk_fma_f32 v[80:81], v[96:97], v[244:245], v[80:81] op_sel:[0,0,0] op_sel_hi:[1,0,1]
    v_pk_fma_f32 v[82:83], v[98:99], v[244:245], v[82:83] op_sel:[0,0,0] op_sel_hi:[1,0,1]
    v_pk_mul_f32 v[80:81], v[80:81], v[100:101]
    v_pk_mul_f32 v[82:83], v[82:83], v[102:103]
    v_cvt_pk_bf16_f32 v74, v80, v81
    v_cvt_pk_bf16_f32 v75, v82, v83
    s_add_u32 m0, s29, 122880
    s_add_u32 s54, s28, 327680
    buffer_load_dwordx4 v150, s[12:15], s54 offen lds
    v_pk_fma_f32 v[84:85], v[104:105], v[244:245], v[84:85] op_sel:[0,0,0] op_sel_hi:[1,0,1]
    v_pk_fma_f32 v[86:87], v[106:107], v[244:245], v[86:87] op_sel:[0,0,0] op_sel_hi:[1,0,1]
    v_pk_mul_f32 v[84:85], v[84:85], v[124:125]
    v_pk_mul_f32 v[86:87], v[86:87], v[126:127]
    v_cvt_pk_bf16_f32 v76, v84, v85
    v_cvt_pk_bf16_f32 v77, v86, v87
    v_pk_fma_f32 v[64:65], v[240:241], v[24:25], v[64:65] op_sel:[0,0,0] op_sel_hi:[1,0,1]
    v_pk_fma_f32 v[66:67], v[242:243], v[24:25], v[66:67] op_sel:[0,0,0] op_sel_hi:[1,0,1]
    v_pk_mul_f32 v[64:65], v[64:65], v[24:25] op_sel:[0,1] op_sel_hi:[1,1]
    v_pk_mul_f32 v[66:67], v[66:67], v[24:25] op_sel:[0,1] op_sel_hi:[1,1]
    v_cvt_pk_bf16_f32 v64, v64, v65
    v_cvt_pk_bf16_f32 v65, v66, v67
    v_pk_fma_f32 v[48:49], v[240:241], v[16:17], v[48:49] op_sel:[0,0,0] op_sel_hi:[1,0,1]
    v_pk_fma_f32 v[50:51], v[242:243], v[16:17], v[50:51] op_sel:[0,0,0] op_sel_hi:[1,0,1]
    v_pk_mul_f32 v[48:49], v[48:49], v[16:17] op_sel:[0,1] op_sel_hi:[1,1]
    v_pk_mul_f32 v[50:51], v[50:51], v[16:17] op_sel:[0,1] op_sel_hi:[1,1]
    v_cvt_pk_bf16_f32 v48, v48, v49
    v_cvt_pk_bf16_f32 v49, v50, v51
    v_pk_fma_f32 v[52:53], v[240:241], v[18:19], v[52:53] op_sel:[0,0,0] op_sel_hi:[1,0,1]
    v_pk_fma_f32 v[54:55], v[242:243], v[18:19], v[54:55] op_sel:[0,0,0] op_sel_hi:[1,0,1]
    v_pk_mul_f32 v[52:53], v[52:53], v[18:19] op_sel:[0,1] op_sel_hi:[1,1]
    v_pk_mul_f32 v[54:55], v[54:55], v[18:19] op_sel:[0,1] op_sel_hi:[1,1]
    v_cvt_pk_bf16_f32 v52, v52, v53
    v_cvt_pk_bf16_f32 v53, v54, v55
    s_add_u32 m0, s29, 126976
    s_add_u32 s54, s28, 360448
    buffer_load_dwordx4 v150, s[12:15], s54 offen lds
    v_pk_fma_f32 v[56:57], v[240:241], v[20:21], v[56:57] op_sel:[0,0,0] op_sel_hi:[1,0,1]
    v_pk_fma_f32 v[58:59], v[242:243], v[20:21], v[58:59] op_sel:[0,0,0] op_sel_hi:[1,0,1]
    v_pk_mul_f32 v[56:57], v[56:57], v[20:21] op_sel:[0,1] op_sel_hi:[1,1]
    v_pk_mul_f32 v[58:59], v[58:59], v[20:21] op_sel:[0,1] op_sel_hi:[1,1]
    v_cvt_pk_bf16_f32 v56, v56, v57
    v_cvt_pk_bf16_f32 v57, v58, v59
    v_pk_fma_f32 v[60:61], v[240:241], v[22:23], v[60:61] op_sel:[0,0,0] op_sel_hi:[1,0,1]
    v_pk_fma_f32 v[62:63], v[242:243], v[22:23], v[62:63] op_sel:[0,0,0] op_sel_hi:[1,0,1]
    v_pk_mul_f32 v[60:61], v[60:61], v[22:23] op_sel:[0,1] op_sel_hi:[1,1]
    v_pk_mul_f32 v[62:63], v[62:63], v[22:23] op_sel:[0,1] op_sel_hi:[1,1]
    v_cvt_pk_bf16_f32 v60, v60, v61
    v_cvt_pk_bf16_f32 v61, v62, v63
    v_mfma_f32_16x16x16_bf16 v[88:91], v[48:49], v[32:33], 0
    v_mul_f32 v16, 0x3eb8aa3b, v17
    v_mul_f32 v18, 0x3eb8aa3b, v19
    v_mfma_f32_16x16x16_bf16 v[92:95], v[64:65], v[32:33], 0
    v_mul_f32 v20, 0x3eb8aa3b, v21
    v_mul_f32 v22, 0x3eb8aa3b, v23
    v_mfma_f32_16x16x16_bf16 v[96:99], v[52:53], v[36:37], 0
    s_add_u32 m0, s29, 131072
    s_add_u32 s54, s28, 393216
    buffer_load_dwordx4 v150, s[12:15], s54 offen lds
    v_mfma_f32_16x16x16_bf16 v[100:103], v[48:49], v[36:37], 0
    v_cndmask_b32 v88, v88, v89, s[48:49]
    v_cndmask_b32 v89, v90, v91, s[48:49]
    v_mfma_f32_16x16x16_bf16 v[104:107], v[56:57], v[40:41], 0
    v_cndmask_b32 v92, v92, v93, s[48:49]
    v_cndmask_b32 v93, v94, v95, s[48:49]
    v_mfma_f32_16x16x16_bf16 v[108:111], v[52:53], v[40:41], 0
    v_min_f32 v92, s45, v92
    v_min_f32 v93, s45, v93
    v_mfma_f32_16x16x16_bf16 v[112:115], v[60:61], v[44:45], 0
    v_cndmask_b32 v88, v92, v88, s[50:51]
    v_cndmask_b32 v89, v93, v89, s[52:53]
    v_mfma_f32_16x16x16_bf16 v[116:119], v[56:57], v[44:45], 0
    v_max_f32 v34, v88, v89
    v_cndmask_b32 v96, v96, v97, s[48:49]
    v_cndmask_b32 v97, v98, v99, s[48:49]
    v_cndmask_b32 v100, v100, v101, s[48:49]
    v_cndmask_b32 v101, v102, v103, s[48:49]
    v_cndmask_b32 v96, v100, v96, s[50:51]
    v_cndmask_b32 v97, v101, v97, s[52:53]
    v_max_f32 v38, v96, v97
    v_cndmask_b32 v104, v104, v105, s[48:49]
    v_cndmask_b32 v105, v106, v107, s[48:49]
    v_cndmask_b32 v108, v108, v109, s[48:49]
    v_permlane32_swap_b32 v34, v38
    v_cndmask_b32 v109, v110, v111, s[48:49]
    v_cndmask_b32 v104, v108, v104, s[50:51]
    v_cndmask_b32 v105, v109, v105, s[52:53]
    v_max_f32 v42, v104, v105
    v_cndmask_b32 v112, v112, v113, s[48:49]
    v_cndmask_b32 v113, v114, v115, s[48:49]
    v_cndmask_b32 v116, v116, v117, s[48:49]
    v_cndmask_b32 v117, v118, v119, s[48:49]
    v_cndmask_b32 v112, v116, v112, s[50:51]
    v_cndmask_b32 v113, v117, v113, s[52:53]
    v_max_f32 v46, v112, v113
    v_max_f32 v120, v34, v38
    s_nop 0
    v_permlane32_swap_b32 v42, v46
    v_max_f32 v122, v42, v46
    s_add_u32 m0, s29, 135168
    s_add_u32 s54, s28, 425984
    buffer_load_dwordx4 v150, s[12:15], s54 offen lds
    s_add_u32 m0, s29, 139264
    s_add_u32 s54, s28, 458752
    buffer_load_dwordx4 v150, s[12:15], s54 offen lds
    s_mov_b32 s12, s26
    s_mov_b32 s13, s27
    s_mov_b32 s14, 0x200000
    v_permlane16_swap_b32 v120, v122
    v_max_f32 v124, v120, v122
    v_max_f32 v126, v120, v122
    s_nop 1
    v_permlane16_swap_b32 v124, v126
    v_mov_b32 v125, v124
    v_mov_b32 v127, v126
    s_nop 0
    v_permlane32_swap_b32 v124, v125
    v_permlane32_swap_b32 v126, v127
    v_pk_add_f32 v[88:89], v[88:89], v[124:125] op_sel:[0,0] op_sel_hi:[1,0] neg_lo:[0,1] neg_hi:[0,1]
    v_pk_add_f32 v[96:97], v[96:97], v[124:125] op_sel:[0,1] op_sel_hi:[1,1] neg_lo:[0,1] neg_hi:[0,1]
    v_pk_add_f32 v[104:105], v[104:105], v[126:127] op_sel:[0,0] op_sel_hi:[1,0] neg_lo:[0,1] neg_hi:[0,1]
    v_pk_add_f32 v[112:113], v[112:113], v[126:127] op_sel:[0,1] op_sel_hi:[1,1] neg_lo:[0,1] neg_hi:[0,1]
    v_pk_mul_f32 v[88:89], v[88:89], v[16:17] op_sel:[0,0] op_sel_hi:[1,0]
    v_pk_mul_f32 v[96:97], v[96:97], v[18:19] op_sel:[0,0] op_sel_hi:[1,0]
    v_pk_mul_f32 v[104:105], v[104:105], v[20:21] op_sel:[0,0] op_sel_hi:[1,0]
    v_pk_mul_f32 v[112:113], v[112:113], v[22:23] op_sel:[0,0] op_sel_hi:[1,0]
    v_exp_f32 v88, v88
    v_exp_f32 v89, v89
    v_cvt_pk_bf16_f32 v88, v88, v88
    v_cvt_pk_bf16_f32 v89, v89, v89
    v_and_b32 v92, v252, v88
    v_and_b32 v94, v254, v88
    v_and_b32 v93, v253, v89
    v_and_b32 v95, v255, v89
    v_exp_f32 v96, v96
    v_exp_f32 v97, v97
    v_mfma_f32_16x16x32_bf16 v[48:51], v[248:251], v[92:95], 0
    v_cvt_pk_bf16_f32 v96, v96, v96
    v_cvt_pk_bf16_f32 v97, v97, v97
    v_mfma_f32_16x16x32_bf16 v[88:91], v[68:71], v[92:95], 0
    v_and_b32 v100, v252, v96
    v_and_b32 v102, v254, v96
    v_and_b32 v101, v253, v97
    v_and_b32 v103, v255, v97
    v_exp_f32 v104, v104
    v_exp_f32 v105, v105
    v_mfma_f32_16x16x32_bf16 v[52:55], v[248:251], v[100:103], 0
    v_cvt_pk_bf16_f32 v104, v104, v104
    v_cvt_pk_bf16_f32 v105, v105, v105
    v_mfma_f32_16x16x32_bf16 v[96:99], v[70:73], v[100:103], 0
    v_and_b32 v108, v252, v104
    v_and_b32 v110, v254, v104
    v_and_b32 v109, v253, v105
    v_and_b32 v111, v255, v105
    v_exp_f32 v112, v112
    v_exp_f32 v113, v113
    v_mfma_f32_16x16x32_bf16 v[56:59], v[248:251], v[108:111], 0
    v_cvt_pk_bf16_f32 v112, v112, v112
    v_cvt_pk_bf16_f32 v113, v113, v113
    v_mfma_f32_16x16x32_bf16 v[104:107], v[72:75], v[108:111], 0
    v_and_b32 v116, v252, v112
    v_and_b32 v118, v254, v112
    v_and_b32 v117, v253, v113
    v_and_b32 v119, v255, v113
    v_rcp_f32 v48, v48
    v_rcp_f32 v52, v52
    v_mfma_f32_16x16x32_bf16 v[60:63], v[248:251], v[116:119], 0
    v_mul_f32 v88, v88, v48
    v_mul_f32 v89, v89, v48
    v_mfma_f32_16x16x32_bf16 v[112:115], v[74:77], v[116:119], 0
    v_mul_f32 v90, v90, v48
    v_mul_f32 v91, v91, v48
    v_cvt_pk_bf16_f32 v32, v88, v89
    v_cvt_pk_bf16_f32 v33, v90, v91
    v_mul_f32 v96, v96, v52
    v_mul_f32 v97, v97, v52
    v_mul_f32 v98, v98, v52
    v_mul_f32 v99, v99, v52
    v_cvt_pk_bf16_f32 v34, v96, v97
    v_cvt_pk_bf16_f32 v35, v98, v99
    v_rcp_f32 v56, v56
    v_rcp_f32 v60, v60
    v_permlane16_swap_b32 v32, v34
    v_permlane16_swap_b32 v33, v35
    buffer_store_dwordx4 v[32:35], v1, s[16:19], s57 offen sc1
    v_mul_f32 v104, v104, v56
    v_mul_f32 v105, v105, v56
    v_mul_f32 v106, v106, v56
    v_mul_f32 v107, v107, v56
    v_mul_f32 v112, v112, v60
    v_mul_f32 v113, v113, v60
    v_mul_f32 v114, v114, v60
    v_mul_f32 v115, v115, v60
    v_cvt_pk_bf16_f32 v40, v104, v105
    v_cvt_pk_bf16_f32 v42, v112, v113
    v_cvt_pk_bf16_f32 v41, v106, v107
    v_cvt_pk_bf16_f32 v43, v114, v115
    v_permlane16_swap_b32 v40, v42
    s_nop 0
    v_permlane16_swap_b32 v41, v43
    buffer_store_dwordx4 v[40:43], v1, s[16:19], s58 offen sc1
    v_xor_b32 v11, 32, v0
    ds_read_b128 v[64:67], v0
    ds_read_b128 v[68:71], v11
    v_add_u32 v14, 0x8000, v15
    s_mul_i32 s3, s6, 192
    s_add_u32 s3, s3, 1024
    v_add_u32 v13, s3, v10
    s_add_u32 s3, s3, 81024
    v_lshrrev_b32 v12, 1, v9
    v_add_u32 v12, s3, v12
    s_mov_b32 exec_lo, 0x10001
    s_mov_b32 exec_hi, 0x10001
    ds_write_b128 v13, v[236:239] offset:0
    ds_write_b128 v13, v[240:243] offset:64
    s_mov_b64 exec, 0xffff
    ds_write_b32 v12, v244
    s_mov_b64 exec, -1
    s_waitcnt vmcnt(8)
    v_and_b32 v11, -16, v128
    v_xor_b32 v11, s62, v11
    v_xor_b32 v153, s63, v129
    v_or_b32 v152, v11, v153
    v_and_b32 v11, -16, v130
    v_xor_b32 v11, s62, v11
    v_xor_b32 v153, s63, v131
    v_or3_b32 v152, v11, v153, v152
    v_and_b32 v11, -16, v132
    v_xor_b32 v11, s62, v11
    v_xor_b32 v153, s63, v133
    v_or3_b32 v152, v11, v153, v152
    v_and_b32 v11, -16, v134
    v_xor_b32 v11, s62, v11
    v_xor_b32 v153, s63, v135
    v_or3_b32 v152, v11, v153, v152
    v_cmp_ne_u32 vcc, 0, v152
    s_cbranch_vccnz LS_retry_3
LS_got_4:
    s_bfe_u32 s55, s56, 196608
    v_lshl_add_u32 v4, s55, 11, v1
    buffer_load_dwordx4 a[192:195], v4, s[20:23], s30 offen offset:0
    buffer_load_dwordx4 a[196:199], v4, s[20:23], s31 offen offset:0
    buffer_load_dwordx4 a[200:203], v4, s[20:23], s32 offen offset:0
    buffer_load_dwordx4 a[204:207], v4, s[20:23], s30 offen offset:1024
    buffer_load_dwordx4 a[208:211], v4, s[20:23], s31 offen offset:1024
    buffer_load_dwordx4 a[212:215], v4, s[20:23], s32 offen offset:1024
    s_bfe_u32 s55, s56, 196612
    v_lshl_add_u32 v4, s55, 11, v1
    buffer_load_dwordx4 a[216:219], v4, s[20:23], s30 offen offset:0
    buffer_load_dwordx4 a[220:223], v4, s[20:23], s31 offen offset:0
    buffer_load_dwordx4 a[224:227], v4, s[20:23], s32 offen offset:0
    buffer_load_dwordx4 a[228:231], v4, s[20:23], s30 offen offset:1024
    buffer_load_dwordx4 a[232:235], v4, s[20:23], s31 offen offset:1024
    buffer_load_dwordx4 a[236:239], v4, s[20:23], s32 offen offset:1024
    s_lshl_b32 s3, s25, 5
    s_add_u32 s3, s3, s24
    s_lshl_b32 s3, s3, 10
    v_add_u32 v0, s3, v5
    s_lshl_b32 s47, s5, 11
    s_add_u32 s47, s47, s3
    s_add_u32 s47, s47, s34
    s_mul_i32 s3, s5, 11
    s_mul_i32 s60, s6, 3
    s_add_u32 s60, s60, s3
    s_lshl_b32 s3, s60, 10
    s_add_u32 s3, s3, s35
    s_cmpk_ge_u32 s60, 86
    s_cselect_b32 s3, 134217728, s3
    s_add_u32 s61, s3, 88064
    s_bitcmp1_b32 s60, 0
    s_cselect_b32 s99, s3, s61
    s_cselect_b32 s100, s61, s3
    s_cmp_eq_u32 s6, 3
    s_cselect_b32 s60, 134217728, s99
    s_cselect_b32 s61, 134217728, s100
    s_waitcnt lgkmcnt(3)
    v_lshlrev_b32 v32, 16, v64
    v_and_b32 v33, 0xffff0000, v64
    v_lshlrev_b32 v34, 16, v65
    v_and_b32 v35, 0xffff0000, v65
    v_lshlrev_b32 v36, 16, v66
    v_and_b32 v37, 0xffff0000, v66
    v_lshlrev_b32 v38, 16, v67
    v_and_b32 v39, 0xffff0000, v67
    v_lshlrev_b32 v40, 16, v68
    v_and_b32 v41, 0xffff0000, v68
    v_lshlrev_b32 v42, 16, v69
    v_and_b32 v43, 0xffff0000, v69
    v_lshlrev_b32 v44, 16, v70
    v_and_b32 v45, 0xffff0000, v70
    v_lshlrev_b32 v46, 16, v71
    v_and_b32 v47, 0xffff0000, v71
    v_mov_b32 v11, 1
    s_mov_b64 exec, 1
    s_waitcnt vmcnt(12)
    buffer_store_dword v11, off, s[16:19], s40 sc1
    s_mov_b64 exec, -1
    s_barrier
    s_bfe_u32 s55, s56, 196616
    v_lshl_add_u32 v4, s55, 11, v1
    buffer_load_dwordx4 a[240:243], v4, s[20:23], s30 offen offset:0
    ds_read_b64_tr_b16 v[16:17], v14 offset:28672
    ds_read_b64_tr_b16 v[18:19], v14 offset:29184
    buffer_load_dwordx4 a[244:247], v4, s[20:23], s31 offen offset:0
    ds_read_b64_tr_b16 v[20:21], v14 offset:32768
    ds_read_b64_tr_b16 v[22:23], v14 offset:33280
    buffer_load_dwordx4 a[248:251], v4, s[20:23], s32 offen offset:0
    ds_read_b64_tr_b16 v[24:25], v14 offset:36864
    ds_read_b64_tr_b16 v[26:27], v14 offset:37376
    buffer_load_dwordx4 a[252:255], v4, s[20:23], s30 offen offset:1024
    ds_read_b64_tr_b16 v[28:29], v15 offset:12288
    ds_read_b64_tr_b16 v[30:31], v15 offset:12800
    buffer_load_dwordx4 v[128:131], v4, s[20:23], s31 offen offset:1024
    ds_read_b64_tr_b16 v[236:237], v15 offset:16384
    ds_read_b64_tr_b16 v[238:239], v15 offset:16896
    buffer_load_dwordx4 v[132:135], v4, s[20:23], s32 offen offset:1024
    ds_read_b64_tr_b16 v[240:241], v15 offset:20480
    ds_read_b64_tr_b16 v[242:243], v15 offset:20992
    s_bfe_u32 s55, s56, 196620
    v_lshl_add_u32 v4, s55, 11, v1
    buffer_load_dwordx4 v[136:139], v4, s[20:23], s30 offen offset:0
    ds_read_b64_tr_b16 v[244:245], v15 offset:24576
    ds_read_b64_tr_b16 v[246:247], v15 offset:25088
    buffer_load_dwordx4 v[140:143], v4, s[20:23], s31 offen offset:0
    ds_read_b64_tr_b16 v[248:249], v15 offset:28672
    ds_read_b64_tr_b16 v[250:251], v15 offset:29184
    buffer_load_dwordx4 v[144:147], v4, s[20:23], s32 offen offset:0
    ds_read_b64_tr_b16 v[96:97], v14 offset:0
    ds_read_b64_tr_b16 v[98:99], v14 offset:512
    buffer_load_dwordx4 v[148:151], v4, s[20:23], s30 offen offset:1024
    ds_read_b64_tr_b16 v[100:101], v14 offset:4096
    ds_read_b64_tr_b16 v[102:103], v14 offset:4608
    buffer_load_dwordx4 v[152:155], v4, s[20:23], s31 offen offset:1024
    ds_read_b64_tr_b16 v[104:105], v14 offset:8192
    ds_read_b64_tr_b16 v[106:107], v14 offset:8704
    buffer_load_dwordx4 v[156:159], v4, s[20:23], s32 offen offset:1024
    ds_read_b64_tr_b16 v[108:109], v14 offset:12288
    ds_read_b64_tr_b16 v[110:111], v14 offset:12800
    ds_read_b64_tr_b16 v[112:113], v14 offset:16384
    ds_read_b64_tr_b16 v[114:115], v14 offset:16896
    ds_read_b64_tr_b16 v[116:117], v14 offset:20480
    ds_read_b64_tr_b16 v[118:119], v14 offset:20992
    ds_read_b64_tr_b16 v[120:121], v14 offset:24576
    ds_read_b64_tr_b16 v[122:123], v14 offset:25088
    ds_read_b64_tr_b16 v[124:125], v14 offset:40960
    ds_read_b64_tr_b16 v[126:127], v14 offset:41472
    s_lshl_b32 s44, s6, 11
    s_add_u32 s57, s35, s44
    s_cmp_ge_u32 s6, 2
    s_cselect_b32 s58, 134217728, s57
    v_lshl_add_u32 v12, s6, 12, v2
    v_xor_b32 v13, 0x1000, v12
    buffer_load_dword v11, v6, s[16:19], s39 offen sc1
    s_bfe_u32 s55, s56, 196624
    v_lshl_add_u32 v4, s55, 11, v1
    buffer_load_dwordx4 v[160:163], v4, s[20:23], s30 offen offset:0
    buffer_load_dwordx4 v[164:167], v4, s[20:23], s31 offen offset:0
    buffer_load_dwordx4 v[168:171], v4, s[20:23], s32 offen offset:0
    buffer_load_dwordx4 v[172:175], v4, s[20:23], s30 offen offset:1024
    buffer_load_dwordx4 v[176:179], v4, s[20:23], s31 offen offset:1024
    buffer_load_dwordx4 v[180:183], v4, s[20:23], s32 offen offset:1024
    s_bfe_u32 s55, s56, 196628
    v_lshl_add_u32 v4, s55, 11, v1
    buffer_load_dwordx4 v[184:187], v4, s[20:23], s30 offen offset:0
    buffer_load_dwordx4 v[188:191], v4, s[20:23], s31 offen offset:0
    s_waitcnt vmcnt(8)
    v_cmp_gt_i32 vcc, 1, v11
    s_cbranch_vccnz LS_spin_6
LS_got_7:
    s_add_u32 m0, s44, 0
    s_nop 0
    buffer_load_dwordx4 v1, s[16:19], s57 offen offset:0 sc1 lds
    buffer_load_dwordx4 v1, s[16:19], s57 offen offset:1024 sc1 lds
    s_add_u32 s54, s57, 8192
    s_add_u32 m0, s44, 8192
    s_nop 0
    buffer_load_dwordx4 v1, s[16:19], s54 offen offset:0 sc1 lds
    buffer_load_dwordx4 v1, s[16:19], s54 offen offset:1024 sc1 lds
    s_add_u32 s54, s57, 16384
    s_add_u32 m0, s44, 16384
    s_nop 0
    buffer_load_dwordx4 v1, s[16:19], s54 offen offset:0 sc1 lds
    buffer_load_dwordx4 v1, s[16:19], s54 offen offset:1024 sc1 lds
    s_waitcnt vmcnt(4)
    s_barrier
    ds_read_b128 v[64:67], v3 offset:0
    ds_read_b128 v[68:71], v3 offset:2048
    ds_read_b128 v[72:75], v3 offset:4096
    ds_read_b128 v[76:79], v3 offset:6144
    s_add_u32 s54, s57, 24576
    s_add_u32 m0, s44, 24576
    s_nop 0
    buffer_load_dwordx4 v1, s[16:19], s54 offen offset:0 sc1 lds
    buffer_load_dwordx4 v1, s[16:19], s54 offen offset:1024 sc1 lds
    s_add_u32 s54, s57, 32768
    s_add_u32 m0, s44, 32768
    s_nop 0
    buffer_load_dwordx4 v1, s[16:19], s54 offen offset:0 sc1 lds
    buffer_load_dwordx4 v1, s[16:19], s54 offen offset:1024 sc1 lds
    s_waitcnt lgkmcnt(3)
    v_mfma_f32_32x32x16_bf16 v[48:63], v[16:19], v[64:67], 0
    s_add_u32 s54, s57, 40960
    s_add_u32 m0, s44, 40960
    s_nop 0
    buffer_load_dwordx4 v1, s[16:19], s54 offen offset:0 sc1 lds
    s_waitcnt lgkmcnt(2)
    v_mfma_f32_32x32x16_bf16 v[48:63], v[20:23], v[68:71], v[48:63]
    s_waitcnt vmcnt(7)
    s_barrier
    ds_read_b128 v[80:83], v3 offset:8192
    ds_read_b128 v[84:87], v3 offset:10240
    s_waitcnt lgkmcnt(3)
    v_mfma_f32_32x32x16_bf16 v[48:63], v[24:27], v[72:75], v[48:63]
    ds_read_b128 v[88:91], v3 offset:12288
    ds_read_b128 v[92:95], v3 offset:14336
    s_waitcnt lgkmcnt(4)
    v_mfma_f32_32x32x16_bf16 v[48:63], v[28:31], v[76:79], v[48:63]
    buffer_load_dwordx4 v1, s[16:19], s54 offen offset:1024 sc1 lds
    s_waitcnt lgkmcnt(3)
    v_mfma_f32_32x32x16_bf16 v[48:63], v[236:239], v[80:83], v[48:63]
    s_add_u32 s54, s57, 49152
    s_add_u32 m0, s44, 49152
    s_nop 0
    buffer_load_dwordx4 v1, s[16:19], s54 offen offset:0 sc1 lds
    s_waitcnt lgkmcnt(2)
    v_mfma_f32_32x32x16_bf16 v[48:63], v[240:243], v[84:87], v[48:63]
    s_waitcnt vmcnt(7)
    s_barrier
    ds_read_b128 v[64:67], v3 offset:16384
    ds_read_b128 v[68:71], v3 offset:18432
    s_waitcnt lgkmcnt(3)
    v_mfma_f32_32x32x16_bf16 v[48:63], v[244:247], v[88:91], v[48:63]
    ds_read_b128 v[72:75], v3 offset:20480
    ds_read_b128 v[76:79], v3 offset:22528
    s_waitcnt lgkmcnt(4)
    v_mfma_f32_32x32x16_bf16 v[48:63], v[248:251], v[92:95], v[48:63]
    buffer_load_dwordx4 v1, s[16:19], s54 offen offset:1024 sc1 lds
    s_waitcnt lgkmcnt(3)
    v_mfma_f32_32x32x16_bf16 v[48:63], v[96:99], v[64:67], v[48:63]
    s_add_u32 s54, s57, 57344
    s_add_u32 m0, s44, 57344
    s_nop 0
    buffer_load_dwordx4 v1, s[16:19], s54 offen offset:0 sc1 lds
    s_waitcnt lgkmcnt(2)
    v_mfma_f32_32x32x16_bf16 v[48:63], v[100:103], v[68:71], v[48:63]
    s_waitcnt vmcnt(7)
    s_barrier
    ds_read_b128 v[80:83], v3 offset:24576
    ds_read_b128 v[84:87], v3 offset:26624
    s_waitcnt lgkmcnt(3)
    v_mfma_f32_32x32x16_bf16 v[48:63], v[104:107], v[72:75], v[48:63]
    ds_read_b128 v[88:91], v3 offset:28672
    ds_read_b128 v[92:95], v3 offset:30720
    s_waitcnt lgkmcnt(4)
    v_mfma_f32_32x32x16_bf16 v[48:63], v[108:111], v[76:79], v[48:63]
    buffer_load_dwordx4 v1, s[16:19], s54 offen offset:1024 sc1 lds
    s_waitcnt lgkmcnt(3)
    v_mfma_f32_32x32x16_bf16 v[48:63], v[112:115], v[80:83], v[48:63]
    s_waitcnt lgkmcnt(2)
    v_mfma_f32_32x32x16_bf16 v[48:63], v[116:119], v[84:87], v[48:63]
    s_waitcnt vmcnt(6)
    s_barrier
    ds_read_b128 v[64:67], v3 offset:32768
    ds_read_b128 v[68:71], v3 offset:34816
    s_waitcnt lgkmcnt(3)
    v_mfma_f32_32x32x16_bf16 v[48:63], v[120:123], v[88:91], v[48:63]
    ds_read_b128 v[72:75], v3 offset:36864
    ds_read_b128 v[76:79], v3 offset:38912
    s_waitcnt lgkmcnt(4)
    v_mfma_f32_32x32x16_bf16 v[48:63], v[124:127], v[92:95], v[48:63]
    s_waitcnt lgkmcnt(3)
    v_mfma_f32_32x32x16_bf16 v[32:47], v[16:19], v[64:67], v[32:47]
    buffer_load_dwordx4 v[192:195], v4, s[20:23], s32 offen offset:0
    s_waitcnt lgkmcnt(2)
    v_mfma_f32_32x32x16_bf16 v[32:47], v[20:23], v[68:71], v[32:47]
    s_waitcnt vmcnt(5)
    s_barrier
    ds_read_b128 v[80:83], v3 offset:40960
    ds_read_b128 v[84:87], v3 offset:43008
    s_nop 2
    v_cvt_pk_bf16_f32 v48, v48, v49
    s_waitcnt lgkmcnt(3)
    v_mfma_f32_32x32x16_bf16 v[32:47], v[24:27], v[72:75], v[32:47]
    ds_read_b128 v[88:91], v3 offset:45056
    ds_read_b128 v[92:95], v3 offset:47104
    buffer_load_dwordx4 v[196:199], v4, s[20:23], s30 offen offset:1024
    s_waitcnt lgkmcnt(4)
    v_mfma_f32_32x32x16_bf16 v[32:47], v[28:31], v[76:79], v[32:47]
    v_cvt_pk_bf16_f32 v49, v50, v51
    v_cvt_pk_bf16_f32 v50, v52, v53
    v_cvt_pk_bf16_f32 v51, v54, v55
    v_cvt_pk_bf16_f32 v52, v56, v57
    v_cvt_pk_bf16_f32 v53, v58, v59
    v_cvt_pk_bf16_f32 v54, v60, v61
    s_waitcnt lgkmcnt(3)
    v_mfma_f32_32x32x16_bf16 v[32:47], v[236:239], v[80:83], v[32:47]
    buffer_load_dwordx4 v[200:203], v4, s[20:23], s31 offen offset:1024
    v_cvt_pk_bf16_f32 v55, v62, v63
    s_waitcnt lgkmcnt(2)
    v_mfma_f32_32x32x16_bf16 v[32:47], v[240:243], v[84:87], v[32:47]
    s_waitcnt vmcnt(5)
    s_barrier
    ds_read_b128 v[64:67], v3 offset:49152
    ds_read_b128 v[68:71], v3 offset:51200
    s_waitcnt lgkmcnt(3)
    v_mfma_f32_32x32x16_bf16 v[32:47], v[244:247], v[88:91], v[32:47]
    ds_read_b128 v[72:75], v3 offset:53248
    ds_read_b128 v[76:79], v3 offset:55296
    buffer_load_dwordx4 v[204:207], v4, s[20:23], s32 offen offset:1024
    s_waitcnt lgkmcnt(4)
    v_mfma_f32_32x32x16_bf16 v[32:47], v[248:251], v[92:95], v[32:47]
    ds_write_b128 v12, v[48:51] offset:0
    s_waitcnt lgkmcnt(4)
    v_mfma_f32_32x32x16_bf16 v[32:47], v[96:99], v[64:67], v[32:47]
    ds_write_b128 v12, v[52:55] offset:1024
    s_bfe_u32 s55, s56, 196632
    v_lshl_add_u32 v4, s55, 11, v1
    buffer_load_dwordx4 v[208:211], v4, s[20:23], s30 offen offset:0
    s_waitcnt lgkmcnt(4)
    v_mfma_f32_32x32x16_bf16 v[32:47], v[100:103], v[68:71], v[32:47]
    s_waitcnt lgkmcnt(0)
    s_waitcnt vmcnt(5)
    s_barrier
    ds_read_b128 v[80:83], v3 offset:57344
    ds_read_b128 v[84:87], v3 offset:59392
    v_mfma_f32_32x32x16_bf16 v[32:47], v[104:107], v[72:75], v[32:47]
    ds_read_b128 v[88:91], v3 offset:61440
    ds_read_b128 v[92:95], v3 offset:63488
    buffer_load_dwordx4 v[212:215], v4, s[20:23], s31 offen offset:0
    v_mfma_f32_32x32x16_bf16 v[32:47], v[108:111], v[76:79], v[32:47]
    ds_read_b128 v[56:59], v13 offset:0
    ds_read_b128 v[60:63], v13 offset:1024
    s_waitcnt lgkmcnt(5)
    v_mfma_f32_32x32x16_bf16 v[32:47], v[112:115], v[80:83], v[32:47]
    buffer_load_dwordx4 v[216:219], v4, s[20:23], s32 offen offset:0
    s_waitcnt lgkmcnt(0)
    v_lshlrev_b32 v48, 16, v56
    v_and_b32 v49, 0xffff0000, v56
    v_lshlrev_b32 v50, 16, v57
    v_mfma_f32_32x32x16_bf16 v[32:47], v[116:119], v[84:87], v[32:47]
    v_and_b32 v51, 0xffff0000, v57
    v_lshlrev_b32 v52, 16, v58
    v_and_b32 v53, 0xffff0000, v58
    v_lshlrev_b32 v54, 16, v59
    v_and_b32 v55, 0xffff0000, v59
    v_lshlrev_b32 v56, 16, v60
    v_mfma_f32_32x32x16_bf16 v[32:47], v[120:123], v[88:91], v[32:47]
    buffer_load_dwordx4 v[220:223], v4, s[20:23], s30 offen offset:1024
    v_and_b32 v57, 0xffff0000, v60
    v_lshlrev_b32 v58, 16, v61
    v_and_b32 v59, 0xffff0000, v61
    v_lshlrev_b32 v60, 16, v62
    v_mfma_f32_32x32x16_bf16 v[32:47], v[124:127], v[92:95], v[32:47]
    v_and_b32 v61, 0xffff0000, v62
    v_lshlrev_b32 v62, 16, v63
    v_and_b32 v63, 0xffff0000, v63
    s_nop 8
    v_pk_add_f32 v[16:17], v[32:33], v[48:49]
    v_pk_add_f32 v[18:19], v[34:35], v[50:51]
    v_pk_add_f32 v[20:21], v[36:37], v[52:53]
    v_pk_add_f32 v[22:23], v[38:39], v[54:55]
    v_cvt_pk_bf16_f32 v80, v16, v17
    v_cvt_pk_bf16_f32 v81, v18, v19
    v_cvt_pk_bf16_f32 v82, v20, v21
    v_cvt_pk_bf16_f32 v83, v22, v23
    buffer_store_dwordx4 v[80:83], v5, s[16:19], s47 offen offset:0 sc1
    v_pk_add_f32 v[24:25], v[40:41], v[56:57]
    v_pk_add_f32 v[26:27], v[42:43], v[58:59]
    v_pk_add_f32 v[28:29], v[44:45], v[60:61]
    v_pk_add_f32 v[30:31], v[46:47], v[62:63]
    v_cvt_pk_bf16_f32 v84, v24, v25
    v_cvt_pk_bf16_f32 v85, v26, v27
    v_cvt_pk_bf16_f32 v86, v28, v29
    v_cvt_pk_bf16_f32 v87, v30, v31
    buffer_store_dwordx4 v[84:87], v5, s[16:19], s47 offen offset:512 sc1
    v_pk_add_f32 v[12:13], v[16:17], v[18:19]
    v_pk_mul_f32 v[78:79], v[16:17], v[16:17]
    v_pk_fma_f32 v[78:79], v[18:19], v[18:19], v[78:79]
    v_pk_add_f32 v[12:13], v[12:13], v[20:21]
    v_pk_fma_f32 v[78:79], v[20:21], v[20:21], v[78:79]
    v_pk_add_f32 v[12:13], v[12:13], v[22:23]
    v_pk_fma_f32 v[78:79], v[22:23], v[22:23], v[78:79]
    v_pk_add_f32 v[12:13], v[12:13], v[24:25]
    v_pk_fma_f32 v[78:79], v[24:25], v[24:25], v[78:79]
    v_pk_add_f32 v[12:13], v[12:13], v[26:27]
    v_pk_fma_f32 v[78:79], v[26:27], v[26:27], v[78:79]
    v_pk_add_f32 v[12:13], v[12:13], v[28:29]
    v_pk_fma_f32 v[78:79], v[28:29], v[28:29], v[78:79]
    v_pk_add_f32 v[12:13], v[12:13], v[30:31]
    v_pk_fma_f32 v[78:79], v[30:31], v[30:31], v[78:79]
    v_add_f32 v12, v12, v13
    v_add_f32 v14, v78, v79
    s_nop 1
    v_permlane32_swap_b32 v12, v14
    v_add_f32 v14, v12, v14
    buffer_store_dword v14, v7, s[16:19], s36 offen sc1
    ds_write_b128 v0, v[80:83] offset:0
    ds_write_b128 v0, v[84:87] offset:512
    s_lshl_b32 s44, s6, 14
    s_add_u32 s58, s34, s44
    v_mov_b32 v120, 0x3f803f80
    v_mov_b32 v121, 0x3f803f80
    v_mov_b32 v122, 0x3f803f80
    v_mov_b32 v123, 0x3f803f80
    s_waitcnt lgkmcnt(0)
    s_barrier
    ds_read_b128 v[88:91], v1 offset:0
    ds_read_b128 v[92:95], v1 offset:16384
    ds_read_b128 v[96:99], v1 offset:32768
    ds_read_b128 v[100:103], v1 offset:49152
    s_waitcnt lgkmcnt(3)
    v_mfma_f32_16x16x32_bf16 v[32:35], a[192:195], v[88:91], 0
    ds_read_b128 v[104:107], v1 offset:1024
    v_mfma_f32_16x16x32_bf16 v[48:51], a[196:199], v[88:91], 0
    v_mfma_f32_16x16x32_bf16 v[64:67], a[200:203], v[88:91], 0
    s_waitcnt lgkmcnt(3)
    v_mfma_f32_16x16x32_bf16 v[108:111], a[192:195], v[120:123], 0
    v_mfma_f32_16x16x32_bf16 v[36:39], a[192:195], v[92:95], 0
    ds_read_b128 v[88:91], v1 offset:17408
    v_mfma_f32_16x16x32_bf16 v[52:55], a[196:199], v[92:95], 0
    v_mfma_f32_16x16x32_bf16 v[108:111], a[216:219], v[120:123], v[108:111]
    v_mfma_f32_16x16x32_bf16 v[112:115], a[220:223], v[120:123], 0
    v_mfma_f32_16x16x32_bf16 v[116:119], a[224:227], v[120:123], 0
    v_mfma_f32_16x16x32_bf16 v[108:111], a[228:231], v[120:123], v[108:111]
    v_mfma_f32_16x16x32_bf16 v[112:115], a[232:235], v[120:123], v[112:115]
    v_mfma_f32_16x16x32_bf16 v[116:119], a[236:239], v[120:123], v[116:119]
    v_mfma_f32_16x16x32_bf16 v[108:111], a[240:243], v[120:123], v[108:111]
    v_mfma_f32_16x16x32_bf16 v[112:115], a[244:247], v[120:123], v[112:115]
    v_mfma_f32_16x16x32_bf16 v[116:119], a[248:251], v[120:123], v[116:119]
    v_mfma_f32_16x16x32_bf16 v[108:111], a[252:255], v[120:123], v[108:111]
    v_mfma_f32_16x16x32_bf16 v[112:115], v[128:131], v[120:123], v[112:115]
    v_mfma_f32_16x16x32_bf16 v[116:119], v[132:135], v[120:123], v[116:119]
    v_mfma_f32_16x16x32_bf16 v[108:111], v[136:139], v[120:123], v[108:111]
    v_mfma_f32_16x16x32_bf16 v[112:115], v[140:143], v[120:123], v[112:115]
    v_mfma_f32_16x16x32_bf16 v[116:119], v[144:147], v[120:123], v[116:119]
    v_mfma_f32_16x16x32_bf16 v[108:111], v[148:151], v[120:123], v[108:111]
    v_mfma_f32_16x16x32_bf16 v[112:115], v[152:155], v[120:123], v[112:115]
    v_mfma_f32_16x16x32_bf16 v[116:119], v[156:159], v[120:123], v[116:119]
    v_mov_b32 v11, 2
    s_mov_b64 exec, 1
    s_waitcnt vmcnt(0)
    buffer_store_dword v11, off, s[16:19], s40 sc1
    s_mov_b64 exec, -1
    v_mfma_f32_16x16x32_bf16 v[68:71], a[200:203], v[92:95], 0
    s_waitcnt lgkmcnt(3)
    v_mfma_f32_16x16x32_bf16 v[112:115], a[196:199], v[120:123], v[112:115]
    v_mfma_f32_16x16x32_bf16 v[40:43], a[192:195], v[96:99], 0
    ds_read_b128 v[92:95], v1 offset:33792
    v_mfma_f32_16x16x32_bf16 v[56:59], a[196:199], v[96:99], 0
    v_mfma_f32_16x16x32_bf16 v[72:75], a[200:203], v[96:99], 0
    s_waitcnt lgkmcnt(3)
    v_mfma_f32_16x16x32_bf16 v[116:119], a[200:203], v[120:123], v[116:119]
    v_mfma_f32_16x16x32_bf16 v[44:47], a[192:195], v[100:103], 0
    ds_read_b128 v[96:99], v1 offset:50176
    v_mfma_f32_16x16x32_bf16 v[60:63], a[196:199], v[100:103], 0
    v_mfma_f32_16x16x32_bf16 v[76:79], a[200:203], v[100:103], 0
    s_waitcnt lgkmcnt(3)
    v_mfma_f32_16x16x32_bf16 v[32:35], a[204:207], v[104:107], v[32:35]
    v_mfma_f32_16x16x32_bf16 v[48:51], a[208:211], v[104:107], v[48:51]
    v_mfma_f32_16x16x32_bf16 v[64:67], a[212:215], v[104:107], v[64:67]
    s_waitcnt lgkmcnt(2)
    v_mfma_f32_16x16x32_bf16 v[108:111], a[204:207], v[120:123], v[108:111]
    v_mfma_f32_16x16x32_bf16 v[36:39], a[204:207], v[88:91], v[36:39]
    v_mfma_f32_16x16x32_bf16 v[52:55], a[208:211], v[88:91], v[52:55]
    v_mfma_f32_16x16x32_bf16 v[68:71], a[212:215], v[88:91], v[68:71]
    s_waitcnt lgkmcnt(1)
    v_mfma_f32_16x16x32_bf16 v[112:115], a[208:211], v[120:123], v[112:115]
    v_mfma_f32_16x16x32_bf16 v[40:43], a[204:207], v[92:95], v[40:43]
    v_mfma_f32_16x16x32_bf16 v[56:59], a[208:211], v[92:95], v[56:59]
    v_mfma_f32_16x16x32_bf16 v[72:75], a[212:215], v[92:95], v[72:75]
    s_waitcnt lgkmcnt(0)
    v_mfma_f32_16x16x32_bf16 v[116:119], a[212:215], v[120:123], v[116:119]
    v_mfma_f32_16x16x32_bf16 v[44:47], a[204:207], v[96:99], v[44:47]
    v_mfma_f32_16x16x32_bf16 v[60:63], a[208:211], v[96:99], v[60:63]
    v_mfma_f32_16x16x32_bf16 v[76:79], a[212:215], v[96:99], v[76:79]
    s_bfe_u32 s3, s56, 196612
    s_lshl_b32 s3, s3, 11
    s_add_u32 m0, s44, 2048
    s_add_u32 s57, s3, s58
LS_poll_8:
    buffer_load_dword v11, v6, s[16:19], s39 offen sc1
    s_sub_u32 s46, s46, 1
    s_cbranch_scc1 L_end
    s_waitcnt vmcnt(0)
    v_cmp_gt_i32 vcc, 2, v11
    s_cbranch_vccnz LS_poll_8
    buffer_load_dwordx4 v1, s[16:19], s57 offen offset:0 sc1 lds
    buffer_load_dwordx4 v1, s[16:19], s57 offen offset:1024 sc1 lds
    s_bfe_u32 s3, s56, 196616
    s_lshl_b32 s3, s3, 11
    s_add_u32 m0, s44, 4096
    s_add_u32 s57, s3, s58
    buffer_load_dwordx4 v1, s[16:19], s57 offen offset:0 sc1 lds
    buffer_load_dwordx4 v1, s[16:19], s57 offen offset:1024 sc1 lds
    s_bfe_u32 s3, s56, 196620
    s_lshl_b32 s3, s3, 11
    s_add_u32 m0, s44, 6144
    s_add_u32 s57, s3, s58
    buffer_load_dwordx4 v1, s[16:19], s57 offen offset:0 sc1 lds
    buffer_load_dwordx4 v1, s[16:19], s57 offen offset:1024 sc1 lds
    s_waitcnt vmcnt(5)
    s_barrier
    ds_read_b128 v[88:91], v1 offset:2048
    ds_read_b128 v[92:95], v1 offset:18432
    ds_read_b128 v[96:99], v1 offset:34816
    ds_read_b128 v[100:103], v1 offset:51200
    s_waitcnt lgkmcnt(3)
    v_mfma_f32_16x16x32_bf16 v[32:35], a[216:219], v[88:91], v[32:35]
    s_waitcnt vmcnt(4)
    s_barrier
    ds_read_b128 v[104:107], v1 offset:3072
    v_mfma_f32_16x16x32_bf16 v[48:51], a[220:223], v[88:91], v[48:51]
    s_bfe_u32 s3, s56, 196624
    s_lshl_b32 s3, s3, 11
    s_add_u32 m0, s44, 8192
    s_add_u32 s57, s3, s58
    buffer_load_dwordx4 v1, s[16:19], s57 offen offset:0 sc1 lds
    v_mfma_f32_16x16x32_bf16 v[64:67], a[224:227], v[88:91], v[64:67]
    s_waitcnt lgkmcnt(3)
    v_mfma_f32_16x16x32_bf16 v[36:39], a[216:219], v[92:95], v[36:39]
    ds_read_b128 v[88:91], v1 offset:19456
    v_mfma_f32_16x16x32_bf16 v[52:55], a[220:223], v[92:95], v[52:55]
    buffer_load_dwordx4 v1, s[16:19], s57 offen offset:1024 sc1 lds
    v_mfma_f32_16x16x32_bf16 v[68:71], a[224:227], v[92:95], v[68:71]
    s_waitcnt lgkmcnt(3)
    v_mfma_f32_16x16x32_bf16 v[40:43], a[216:219], v[96:99], v[40:43]
    ds_read_b128 v[92:95], v1 offset:35840
    v_mfma_f32_16x16x32_bf16 v[56:59], a[220:223], v[96:99], v[56:59]
    s_bfe_u32 s3, s56, 196628
    s_lshl_b32 s3, s3, 11
    s_add_u32 m0, s44, 10240
    s_add_u32 s57, s3, s58
    buffer_load_dwordx4 v1, s[16:19], s57 offen offset:0 sc1 lds
    v_mfma_f32_16x16x32_bf16 v[72:75], a[224:227], v[96:99], v[72:75]
    s_waitcnt lgkmcnt(3)
    v_mfma_f32_16x16x32_bf16 v[44:47], a[216:219], v[100:103], v[44:47]
    ds_read_b128 v[96:99], v1 offset:52224
    v_mfma_f32_16x16x32_bf16 v[60:63], a[220:223], v[100:103], v[60:63]
    buffer_load_dwordx4 v1, s[16:19], s57 offen offset:1024 sc1 lds
    v_mfma_f32_16x16x32_bf16 v[76:79], a[224:227], v[100:103], v[76:79]
    s_waitcnt lgkmcnt(3)
    v_mfma_f32_16x16x32_bf16 v[32:35], a[228:231], v[104:107], v[32:35]
    s_waitcnt vmcnt(6)
    s_barrier
    ds_read_b128 v[100:103], v1 offset:4096
    v_mfma_f32_16x16x32_bf16 v[48:51], a[232:235], v[104:107], v[48:51]
    s_bfe_u32 s3, s56, 196632
    s_lshl_b32 s3, s3, 11
    s_add_u32 m0, s44, 12288
    s_add_u32 s57, s3, s58
    buffer_load_dwordx4 v1, s[16:19], s57 offen offset:0 sc1 lds
    v_mfma_f32_16x16x32_bf16 v[64:67], a[236:239], v[104:107], v[64:67]
    s_waitcnt lgkmcnt(3)
    v_mfma_f32_16x16x32_bf16 v[36:39], a[228:231], v[88:91], v[36:39]
    ds_read_b128 v[104:107], v1 offset:20480
    v_mfma_f32_16x16x32_bf16 v[52:55], a[232:235], v[88:91], v[52:55]
    buffer_load_dwordx4 v1, s[16:19], s57 offen offset:1024 sc1 lds
    v_mfma_f32_16x16x32_bf16 v[68:71], a[236:239], v[88:91], v[68:71]
    s_waitcnt lgkmcnt(3)
    v_mfma_f32_16x16x32_bf16 v[40:43], a[228:231], v[92:95], v[40:43]
    ds_read_b128 v[88:91], v1 offset:36864
    v_mfma_f32_16x16x32_bf16 v[56:59], a[232:235], v[92:95], v[56:59]
    s_bfe_u32 s3, s56, 196636
    s_lshl_b32 s3, s3, 11
    s_add_u32 m0, s44, 14336
    s_add_u32 s57, s3, s58
    buffer_load_dwordx4 v1, s[16:19], s57 offen offset:0 sc1 lds
    v_mfma_f32_16x16x32_bf16 v[72:75], a[236:239], v[92:95], v[72:75]
    s_waitcnt lgkmcnt(3)
    v_mfma_f32_16x16x32_bf16 v[44:47], a[228:231], v[96:99], v[44:47]
    ds_read_b128 v[92:95], v1 offset:53248
    v_mfma_f32_16x16x32_bf16 v[60:63], a[232:235], v[96:99], v[60:63]
    buffer_load_dwordx4 v1, s[16:19], s57 offen offset:1024 sc1 lds
    v_mfma_f32_16x16x32_bf16 v[76:79], a[236:239], v[96:99], v[76:79]
    s_waitcnt lgkmcnt(3)
    v_mfma_f32_16x16x32_bf16 v[32:35], a[240:243], v[100:103], v[32:35]
    ds_read_b128 v[96:99], v1 offset:5120
    v_mfma_f32_16x16x32_bf16 v[48:51], a[244:247], v[100:103], v[48:51]
    buffer_load_dwordx4 v[80:83], v8, s[16:19], s37 offen offset:0 sc1
    v_mfma_f32_16x16x32_bf16 v[64:67], a[248:251], v[100:103], v[64:67]
    s_waitcnt lgkmcnt(3)
    v_mfma_f32_16x16x32_bf16 v[36:39], a[240:243], v[104:107], v[36:39]
    ds_read_b128 v[100:103], v1 offset:21504
    v_mfma_f32_16x16x32_bf16 v[52:55], a[244:247], v[104:107], v[52:55]
    buffer_load_dwordx4 v[84:87], v8, s[16:19], s37 offen offset:1024 sc1
    v_mfma_f32_16x16x32_bf16 v[68:71], a[248:251], v[104:107], v[68:71]
    s_waitcnt lgkmcnt(3)
    v_mfma_f32_16x16x32_bf16 v[40:43], a[240:243], v[88:91], v[40:43]
    ds_read_b128 v[104:107], v1 offset:37888
    v_mfma_f32_16x16x32_bf16 v[56:59], a[244:247], v[88:91], v[56:59]
    v_mfma_f32_16x16x32_bf16 v[72:75], a[248:251], v[88:91], v[72:75]
    s_waitcnt lgkmcnt(3)
    s_lshl2_add_u32 s3, s5, s6
    v_lshlrev_b32 v11, 3, v1
    s_mulk_i32 s3, 3456
    s_add_u32 s3, s3, s35
    s_add_u32 s3, s3, 0x10000
    s_mov_b64 exec, 0x7ffffff
    buffer_load_dword v14, v11, s[16:19], s3 offen sc1
    s_mov_b64 exec, -1
    v_mfma_f32_16x16x32_bf16 v[44:47], a[240:243], v[92:95], v[44:47]
    ds_read_b128 v[88:91], v1 offset:54272
    v_mfma_f32_16x16x32_bf16 v[60:63], a[244:247], v[92:95], v[60:63]
    buffer_load_dwordx4 v[224:227], v4, s[20:23], s31 offen offset:1024
    v_mfma_f32_16x16x32_bf16 v[76:79], a[248:251], v[92:95], v[76:79]
    s_waitcnt lgkmcnt(3)
    v_mfma_f32_16x16x32_bf16 v[32:35], a[252:255], v[96:99], v[32:35]
    s_waitcnt vmcnt(12)
    s_barrier
    ds_read_b128 v[92:95], v1 offset:6144
    v_mfma_f32_16x16x32_bf16 v[48:51], v[128:131], v[96:99], v[48:51]
    buffer_load_dwordx4 v[228:231], v4, s[20:23], s32 offen offset:1024
    v_mfma_f32_16x16x32_bf16 v[64:67], v[132:135], v[96:99], v[64:67]
    s_waitcnt lgkmcnt(3)
    v_mfma_f32_16x16x32_bf16 v[36:39], a[252:255], v[100:103], v[36:39]
    ds_read_b128 v[96:99], v1 offset:22528
    v_mfma_f32_16x16x32_bf16 v[52:55], v[128:131], v[100:103], v[52:55]
    v_mfma_f32_16x16x32_bf16 v[68:71], v[132:135], v[100:103], v[68:71]
    s_waitcnt lgkmcnt(3)
    v_mfma_f32_16x16x32_bf16 v[40:43], a[252:255], v[104:107], v[40:43]
    ds_read_b128 v[100:103], v1 offset:38912
    v_mfma_f32_16x16x32_bf16 v[56:59], v[128:131], v[104:107], v[56:59]
    s_bfe_u32 s55, s56, 196636
    v_lshl_add_u32 v4, s55, 11, v1
    buffer_load_dwordx4 v[232:235], v4, s[20:23], s30 offen offset:0
    v_mfma_f32_16x16x32_bf16 v[72:75], v[132:135], v[104:107], v[72:75]
    s_waitcnt lgkmcnt(3)
    v_mfma_f32_16x16x32_bf16 v[44:47], a[252:255], v[88:91], v[44:47]
    ds_read_b128 v[104:107], v1 offset:55296
    v_mfma_f32_16x16x32_bf16 v[60:63], v[128:131], v[88:91], v[60:63]
    buffer_load_dwordx4 v[236:239], v4, s[20:23], s31 offen offset:0
    v_mfma_f32_16x16x32_bf16 v[76:79], v[132:135], v[88:91], v[76:79]
    s_waitcnt lgkmcnt(3)
    v_mfma_f32_16x16x32_bf16 v[32:35], v[136:139], v[92:95], v[32:35]
    ds_read_b128 v[88:91], v1 offset:7168
    v_mfma_f32_16x16x32_bf16 v[48:51], v[140:143], v[92:95], v[48:51]
    v_mfma_f32_16x16x32_bf16 v[64:67], v[144:147], v[92:95], v[64:67]
    s_waitcnt lgkmcnt(3)
    v_mfma_f32_16x16x32_bf16 v[36:39], v[136:139], v[96:99], v[36:39]
    ds_read_b128 v[92:95], v1 offset:23552
    v_mfma_f32_16x16x32_bf16 v[52:55], v[140:143], v[96:99], v[52:55]
    buffer_load_dwordx4 v[240:243], v4, s[20:23], s32 offen offset:0
    v_mfma_f32_16x16x32_bf16 v[68:71], v[144:147], v[96:99], v[68:71]
    s_waitcnt lgkmcnt(3)
    v_mfma_f32_16x16x32_bf16 v[40:43], v[136:139], v[100:103], v[40:43]
    ds_read_b128 v[96:99], v1 offset:39936
    v_mfma_f32_16x16x32_bf16 v[56:59], v[140:143], v[100:103], v[56:59]
    buffer_load_dwordx4 v[244:247], v4, s[20:23], s30 offen offset:1024
    v_mfma_f32_16x16x32_bf16 v[72:75], v[144:147], v[100:103], v[72:75]
    s_waitcnt lgkmcnt(3)
    v_mfma_f32_16x16x32_bf16 v[44:47], v[136:139], v[104:107], v[44:47]
    ds_read_b128 v[100:103], v1 offset:56320
    v_mfma_f32_16x16x32_bf16 v[60:63], v[140:143], v[104:107], v[60:63]
    v_mfma_f32_16x16x32_bf16 v[76:79], v[144:147], v[104:107], v[76:79]
    s_waitcnt lgkmcnt(3)
    v_mfma_f32_16x16x32_bf16 v[32:35], v[148:151], v[88:91], v[32:35]
    s_waitcnt vmcnt(13)
    s_barrier
    ds_read_b128 v[104:107], v1 offset:8192
    v_mfma_f32_16x16x32_bf16 v[48:51], v[152:155], v[88:91], v[48:51]
    buffer_load_dwordx4 v[248:251], v4, s[20:23], s31 offen offset:1024
    v_mfma_f32_16x16x32_bf16 v[64:67], v[156:159], v[88:91], v[64:67]
    s_waitcnt lgkmcnt(3)
    v_mfma_f32_16x16x32_bf16 v[36:39], v[148:151], v[92:95], v[36:39]
    ds_read_b128 v[88:91], v1 offset:24576
    v_mfma_f32_16x16x32_bf16 v[52:55], v[152:155], v[92:95], v[52:55]
    buffer_load_dwordx4 v[252:255], v4, s[20:23], s32 offen offset:1024
    v_mfma_f32_16x16x32_bf16 v[68:71], v[156:159], v[92:95], v[68:71]
    s_waitcnt lgkmcnt(3)
    v_mfma_f32_16x16x32_bf16 v[40:43], v[148:151], v[96:99], v[40:43]
    ds_read_b128 v[92:95], v1 offset:40960
    v_mfma_f32_16x16x32_bf16 v[56:59], v[152:155], v[96:99], v[56:59]
    v_mfma_f32_16x16x32_bf16 v[72:75], v[156:159], v[96:99], v[72:75]
    s_waitcnt lgkmcnt(3)
    v_mfma_f32_16x16x32_bf16 v[44:47], v[148:151], v[100:103], v[44:47]
    ds_read_b128 v[96:99], v1 offset:57344
    v_mfma_f32_16x16x32_bf16 v[60:63], v[152:155], v[100:103], v[60:63]
    buffer_load_dwordx4 a[192:195], v1, s[16:19], s33 offen offset:0
    v_mfma_f32_16x16x32_bf16 v[76:79], v[156:159], v[100:103], v[76:79]
    s_waitcnt lgkmcnt(3)
    v_mfma_f32_16x16x32_bf16 v[32:35], v[160:163], v[104:107], v[32:35]
    ds_read_b128 v[100:103], v1 offset:9216
    v_mfma_f32_16x16x32_bf16 v[48:51], v[164:167], v[104:107], v[48:51]
    buffer_load_dwordx4 a[196:199], v1, s[16:19], s33 offen offset:1024
    v_mfma_f32_16x16x32_bf16 v[64:67], v[168:171], v[104:107], v[64:67]
    s_waitcnt lgkmcnt(3)
    v_mfma_f32_16x16x32_bf16 v[108:111], v[160:163], v[120:123], v[108:111]
    v_mfma_f32_16x16x32_bf16 v[36:39], v[160:163], v[88:91], v[36:39]
    ds_read_b128 v[104:107], v1 offset:25600
    v_mfma_f32_16x16x32_bf16 v[52:55], v[164:167], v[88:91], v[52:55]
    v_mfma_f32_16x16x32_bf16 v[68:71], v[168:171], v[88:91], v[68:71]
    s_waitcnt lgkmcnt(3)
    v_mfma_f32_16x16x32_bf16 v[112:115], v[164:167], v[120:123], v[112:115]
    v_mfma_f32_16x16x32_bf16 v[40:43], v[160:163], v[92:95], v[40:43]
    ds_read_b128 v[88:91], v1 offset:41984
    v_mfma_f32_16x16x32_bf16 v[56:59], v[164:167], v[92:95], v[56:59]
    buffer_load_dwordx4 a[200:203], v1, s[16:19], s33 offen offset:2048
    v_mfma_f32_16x16x32_bf16 v[72:75], v[168:171], v[92:95], v[72:75]
    s_waitcnt lgkmcnt(3)
    s_waitcnt vmcnt(12)
    v_add_f32 v80, v80, v82
    v_mfma_f32_16x16x32_bf16 v[116:119], v[168:171], v[120:123], v[116:119]
    v_add_f32 v81, v81, v83
    v_add_f32 v84, v84, v86
    v_mfma_f32_16x16x32_bf16 v[44:47], v[160:163], v[96:99], v[44:47]
    ds_read_b128 v[92:95], v1 offset:58368
    v_add_f32 v85, v85, v87
    v_mfma_f32_16x16x32_bf16 v[60:63], v[164:167], v[96:99], v[60:63]
    buffer_load_dwordx4 a[204:207], v1, s[16:19], s33 offen offset:3072
    v_mfma_f32_16x16x32_bf16 v[76:79], v[168:171], v[96:99], v[76:79]
    s_waitcnt lgkmcnt(3)
    v_add_f32 v80, v80, v84
    v_add_f32 v81, v81, v85
    v_mfma_f32_16x16x32_bf16 v[32:35], v[172:175], v[100:103], v[32:35]
    ds_read_b128 v[96:99], v1 offset:10240
    v_lshl_add_u32 v82, s6, 7, v9
    v_mfma_f32_16x16x32_bf16 v[48:51], v[176:179], v[100:103], v[48:51]
    v_lshrrev_b32 v83, 1, v82
    v_mfma_f32_16x16x32_bf16 v[64:67], v[180:183], v[100:103], v[64:67]
    s_waitcnt lgkmcnt(3)
    v_permlane32_swap_b32 v80, v81
    v_mfma_f32_16x16x32_bf16 v[108:111], v[172:175], v[120:123], v[108:111]
    v_add_f32 v84, v80, v81
    v_add_f32 v85, v80, v81
    v_mfma_f32_16x16x32_bf16 v[36:39], v[172:175], v[104:107], v[36:39]
    ds_read_b128 v[100:103], v1 offset:26624
    v_add_u32 v83, 80896, v83
    v_mfma_f32_16x16x32_bf16 v[52:55], v[176:179], v[104:107], v[52:55]
    s_add_u32 s55, s33, 4096
    buffer_load_dwordx4 a[208:211], v1, s[16:19], s55 offen offset:0
    v_mfma_f32_16x16x32_bf16 v[68:71], v[180:183], v[104:107], v[68:71]
    s_waitcnt lgkmcnt(3)
    v_permlane16_swap_b32 v84, v85
    v_mfma_f32_16x16x32_bf16 v[112:115], v[176:179], v[120:123], v[112:115]
    v_add_f32 v80, v84, v85
    v_add_f32 v81, v84, v85
    v_mfma_f32_16x16x32_bf16 v[40:43], v[172:175], v[88:91], v[40:43]
    ds_read_b128 v[104:107], v1 offset:11264
    v_mfma_f32_16x16x32_bf16 v[56:59], v[176:179], v[88:91], v[56:59]
    buffer_load_dwordx4 a[212:215], v1, s[16:19], s55 offen offset:1024
    v_mfma_f32_16x16x32_bf16 v[72:75], v[180:183], v[88:91], v[72:75]
    s_waitcnt lgkmcnt(3)
    v_permlane32_swap_b32 v80, v81
    v_mfma_f32_16x16x32_bf16 v[116:119], v[180:183], v[120:123], v[116:119]
    v_mul_f32 v80, 0xbb000000, v80
    v_mul_f32 v81, 0x3b000000, v81
    v_mfma_f32_16x16x32_bf16 v[44:47], v[172:175], v[92:95], v[44:47]
    ds_read_b128 v[88:91], v1 offset:27648
    v_fma_f32 v81, -v80, v80, v81
    v_mfma_f32_16x16x32_bf16 v[60:63], v[176:179], v[92:95], v[60:63]
    v_max_f32 v81, 0, v81
    v_add_f32 v81, 0x3727c5ac, v81
    v_mfma_f32_16x16x32_bf16 v[76:79], v[180:183], v[92:95], v[76:79]
    s_waitcnt lgkmcnt(3)
    v_rsq_f32 v81, v81
    v_mfma_f32_16x16x32_bf16 v[32:35], v[184:187], v[96:99], v[32:35]
    s_barrier
    ds_read_b128 v[92:95], v1 offset:12288
    v_mfma_f32_16x16x32_bf16 v[48:51], v[188:191], v[96:99], v[48:51]
    buffer_load_dwordx4 a[216:219], v1, s[16:19], s55 offen offset:2048
    v_mfma_f32_16x16x32_bf16 v[64:67], v[192:195], v[96:99], v[64:67]
    s_waitcnt lgkmcnt(3)
    ds_write_b64 v82, v[80:81]
    v_mfma_f32_16x16x32_bf16 v[108:111], v[184:187], v[120:123], v[108:111]
    ds_write2_b32 v83, v80, v81 offset0:0 offset1:128
    v_mfma_f32_16x16x32_bf16 v[112:115], v[188:191], v[120:123], v[112:115]
    s_waitcnt lgkmcnt(0)
    s_barrier
    ds_read_b64 v[80:81], v9 offset:0
    ds_read_b64 v[82:83], v9 offset:128
    ds_read_b64 v[84:85], v9 offset:256
    ds_read_b64 v[86:87], v9 offset:384
    v_mfma_f32_16x16x32_bf16 v[36:39], v[184:187], v[100:103], v[36:39]
    ds_read_b128 v[96:99], v1 offset:28672
    v_mfma_f32_16x16x32_bf16 v[52:55], v[188:191], v[100:103], v[52:55]
    buffer_load_dwordx4 a[220:223], v1, s[16:19], s55 offen offset:3072
    v_mfma_f32_16x16x32_bf16 v[68:71], v[192:195], v[100:103], v[68:71]
    v_mfma_f32_16x16x32_bf16 v[116:119], v[192:195], v[120:123], v[116:119]
    v_mfma_f32_16x16x32_bf16 v[32:35], v[196:199], v[104:107], v[32:35]
    ds_read_b128 v[100:103], v1 offset:13312
    v_mfma_f32_16x16x32_bf16 v[48:51], v[200:203], v[104:107], v[48:51]
    v_mfma_f32_16x16x32_bf16 v[64:67], v[204:207], v[104:107], v[64:67]
    v_mfma_f32_16x16x32_bf16 v[108:111], v[196:199], v[120:123], v[108:111]
    v_mfma_f32_16x16x32_bf16 v[112:115], v[200:203], v[120:123], v[112:115]
    v_mfma_f32_16x16x32_bf16 v[36:39], v[196:199], v[88:91], v[36:39]
    ds_read_b128 v[104:107], v1 offset:29696
    v_mfma_f32_16x16x32_bf16 v[52:55], v[200:203], v[88:91], v[52:55]
    s_add_u32 s55, s33, 8192
    buffer_load_dwordx4 a[224:227], v1, s[16:19], s55 offen offset:0
    v_mfma_f32_16x16x32_bf16 v[68:71], v[204:207], v[88:91], v[68:71]
    v_mfma_f32_16x16x32_bf16 v[116:119], v[204:207], v[120:123], v[116:119]
    v_mfma_f32_16x16x32_bf16 v[32:35], v[208:211], v[92:95], v[32:35]
    ds_read_b128 v[88:91], v1 offset:14336
    v_mfma_f32_16x16x32_bf16 v[48:51], v[212:215], v[92:95], v[48:51]
    buffer_load_dwordx4 a[228:231], v1, s[16:19], s55 offen offset:1024
    v_mfma_f32_16x16x32_bf16 v[64:67], v[216:219], v[92:95], v[64:67]
    s_waitcnt lgkmcnt(3)
    v_mfma_f32_16x16x32_bf16 v[108:111], v[208:211], v[120:123], v[108:111]
    v_mfma_f32_16x16x32_bf16 v[112:115], v[212:215], v[120:123], v[112:115]
    v_mfma_f32_16x16x32_bf16 v[36:39], v[208:211], v[96:99], v[36:39]
    ds_read_b128 v[92:95], v1 offset:30720
    v_mfma_f32_16x16x32_bf16 v[52:55], v[212:215], v[96:99], v[52:55]
    v_mfma_f32_16x16x32_bf16 v[68:71], v[216:219], v[96:99], v[68:71]
    s_waitcnt lgkmcnt(3)
    v_mfma_f32_16x16x32_bf16 v[116:119], v[216:219], v[120:123], v[116:119]
    v_mfma_f32_16x16x32_bf16 v[32:35], v[220:223], v[100:103], v[32:35]
    ds_read_b128 v[96:99], v1 offset:15360
    s_waitcnt vmcnt(17)
    v_mfma_f32_16x16x32_bf16 v[48:51], v[224:227], v[100:103], v[48:51]
    buffer_load_dwordx4 a[232:235], v1, s[16:19], s55 offen offset:2048
    s_waitcnt vmcnt(17)
    v_mfma_f32_16x16x32_bf16 v[64:67], v[228:231], v[100:103], v[64:67]
    s_waitcnt lgkmcnt(3)
    v_mfma_f32_16x16x32_bf16 v[108:111], v[220:223], v[120:123], v[108:111]
    v_mfma_f32_16x16x32_bf16 v[112:115], v[224:227], v[120:123], v[112:115]
    v_mfma_f32_16x16x32_bf16 v[36:39], v[220:223], v[104:107], v[36:39]
    ds_read_b128 v[100:103], v1 offset:31744
    v_mfma_f32_16x16x32_bf16 v[52:55], v[224:227], v[104:107], v[52:55]
    buffer_load_dwordx4 a[236:239], v1, s[16:19], s55 offen offset:3072
    v_mfma_f32_16x16x32_bf16 v[68:71], v[228:231], v[104:107], v[68:71]
    s_waitcnt lgkmcnt(3)
    v_mfma_f32_16x16x32_bf16 v[116:119], v[228:231], v[120:123], v[116:119]
    s_waitcnt vmcnt(17)
    v_mfma_f32_16x16x32_bf16 v[32:35], v[232:235], v[88:91], v[32:35]
    ds_read_b128 v[104:107], v1 offset:43008
    s_waitcnt vmcnt(16)
    v_mfma_f32_16x16x32_bf16 v[48:51], v[236:239], v[88:91], v[48:51]
    s_waitcnt vmcnt(15)
    v_mfma_f32_16x16x32_bf16 v[64:67], v[240:243], v[88:91], v[64:67]
    s_waitcnt lgkmcnt(3)
    v_mfma_f32_16x16x32_bf16 v[108:111], v[232:235], v[120:123], v[108:111]
    v_mfma_f32_16x16x32_bf16 v[112:115], v[236:239], v[120:123], v[112:115]
    v_mfma_f32_16x16x32_bf16 v[36:39], v[232:235], v[92:95], v[36:39]
    ds_read_b128 v[88:91], v1 offset:59392
    v_mfma_f32_16x16x32_bf16 v[52:55], v[236:239], v[92:95], v[52:55]
    s_add_u32 s55, s33, 12288
    buffer_load_dwordx4 a[240:243], v1, s[16:19], s55 offen offset:0
    v_mfma_f32_16x16x32_bf16 v[68:71], v[240:243], v[92:95], v[68:71]
    s_waitcnt lgkmcnt(3)
    v_mfma_f32_16x16x32_bf16 v[116:119], v[240:243], v[120:123], v[116:119]
    s_waitcnt vmcnt(15)
    v_mfma_f32_16x16x32_bf16 v[32:35], v[244:247], v[96:99], v[32:35]
    ds_read_b128 v[92:95], v1 offset:44032
    s_waitcnt vmcnt(14)
    v_mfma_f32_16x16x32_bf16 v[48:51], v[248:251], v[96:99], v[48:51]
    buffer_load_dwordx4 a[244:247], v1, s[16:19], s55 offen offset:1024
    s_waitcnt vmcnt(14)
    v_mfma_f32_16x16x32_bf16 v[64:67], v[252:255], v[96:99], v[64:67]
    s_waitcnt lgkmcnt(3)
    v_mfma_f32_16x16x32_bf16 v[108:111], v[244:247], v[120:123], v[108:111]
    v_mfma_f32_16x16x32_bf16 v[112:115], v[248:251], v[120:123], v[112:115]
    v_mfma_f32_16x16x32_bf16 v[36:39], v[244:247], v[100:103], v[36:39]
    ds_read_b128 v[96:99], v1 offset:60416
    v_mfma_f32_16x16x32_bf16 v[52:55], v[248:251], v[100:103], v[52:55]
    v_mfma_f32_16x16x32_bf16 v[68:71], v[252:255], v[100:103], v[68:71]
    s_waitcnt lgkmcnt(3)
    v_mfma_f32_16x16x32_bf16 v[116:119], v[252:255], v[120:123], v[116:119]
    v_mfma_f32_16x16x32_bf16 v[40:43], v[184:187], v[104:107], v[40:43]
    ds_read_b128 v[100:103], v1 offset:45056
    v_mfma_f32_16x16x32_bf16 v[56:59], v[188:191], v[104:107], v[56:59]
    buffer_load_dwordx4 a[248:251], v1, s[16:19], s55 offen offset:2048
    v_mfma_f32_16x16x32_bf16 v[72:75], v[192:195], v[104:107], v[72:75]
    s_waitcnt lgkmcnt(3)
    v_mfma_f32_16x16x32_bf16 v[44:47], v[184:187], v[88:91], v[44:47]
    ds_read_b128 v[104:107], v1 offset:61440
    v_mfma_f32_16x16x32_bf16 v[60:63], v[188:191], v[88:91], v[60:63]
    buffer_load_dwordx4 a[252:255], v1, s[16:19], s55 offen offset:3072
    v_mfma_f32_16x16x32_bf16 v[76:79], v[192:195], v[88:91], v[76:79]
    s_waitcnt lgkmcnt(3)
    v_fmac_f32 v32, v108, v80
    v_fmac_f32 v33, v109, v80
    v_mfma_f32_16x16x32_bf16 v[40:43], v[196:199], v[92:95], v[40:43]
    ds_read_b128 v[88:91], v1 offset:46080
    v_fmac_f32 v34, v110, v80
    v_mfma_f32_16x16x32_bf16 v[56:59], v[200:203], v[92:95], v[56:59]
    v_fmac_f32 v35, v111, v80
    v_cvt_pk_bf16_f32 v120, v32, v33
    v_mfma_f32_16x16x32_bf16 v[72:75], v[204:207], v[92:95], v[72:75]
    s_waitcnt lgkmcnt(3)
    v_cvt_pk_bf16_f32 v121, v34, v35
    v_fmac_f32 v36, v108, v82
    v_mfma_f32_16x16x32_bf16 v[44:47], v[196:199], v[96:99], v[44:47]
    ds_read_b128 v[92:95], v1 offset:62464
    v_fmac_f32 v37, v109, v82
    v_mfma_f32_16x16x32_bf16 v[60:63], v[200:203], v[96:99], v[60:63]
    s_add_u32 s55, s33, 16384
    buffer_load_dwordx4 v[128:131], v1, s[16:19], s55 offen offset:0
    v_mfma_f32_16x16x32_bf16 v[76:79], v[204:207], v[96:99], v[76:79]
    s_waitcnt lgkmcnt(3)
    v_fmac_f32 v38, v110, v82
    v_fmac_f32 v39, v111, v82
    v_mfma_f32_16x16x32_bf16 v[40:43], v[208:211], v[100:103], v[40:43]
    ds_read_b128 v[96:99], v1 offset:47104
    v_cvt_pk_bf16_f32 v122, v36, v37
    v_mfma_f32_16x16x32_bf16 v[56:59], v[212:215], v[100:103], v[56:59]
    buffer_load_dwordx4 v[132:135], v1, s[16:19], s55 offen offset:1024
    v_mfma_f32_16x16x32_bf16 v[72:75], v[216:219], v[100:103], v[72:75]
    s_waitcnt lgkmcnt(3)
    v_cvt_pk_bf16_f32 v123, v38, v39
    v_pk_max_i16 v120, v120, 0
    v_mfma_f32_16x16x32_bf16 v[44:47], v[208:211], v[104:107], v[44:47]
    ds_read_b128 v[100:103], v1 offset:63488
    v_pk_max_i16 v122, v122, 0
    v_mfma_f32_16x16x32_bf16 v[60:63], v[212:215], v[104:107], v[60:63]
    v_pk_max_i16 v121, v121, 0
    v_pk_max_i16 v123, v123, 0
    v_mfma_f32_16x16x32_bf16 v[76:79], v[216:219], v[104:107], v[76:79]
    s_waitcnt lgkmcnt(3)
    v_permlane16_swap_b32 v120, v122
    v_mfma_f32_16x16x32_bf16 v[40:43], v[220:223], v[88:91], v[40:43]
    ds_read_b128 v[104:107], v1 offset:48128
    v_mfma_f32_16x16x32_bf16 v[56:59], v[224:227], v[88:91], v[56:59]
    buffer_load_dwordx4 v[136:139], v1, s[16:19], s55 offen offset:2048
    v_mfma_f32_16x16x32_bf16 v[72:75], v[228:231], v[88:91], v[72:75]
    s_waitcnt lgkmcnt(3)
    v_permlane16_swap_b32 v121, v123
    v_mfma_f32_16x16x32_bf16 v[44:47], v[220:223], v[92:95], v[44:47]
    ds_read_b128 v[88:91], v1 offset:64512
    v_mfma_f32_16x16x32_bf16 v[60:63], v[224:227], v[92:95], v[60:63]
    buffer_load_dwordx4 v[140:143], v1, s[16:19], s55 offen offset:3072
    v_mfma_f32_16x16x32_bf16 v[76:79], v[228:231], v[92:95], v[76:79]
    s_waitcnt lgkmcnt(3)
    buffer_store_dwordx4 v[120:123], v1, s[16:19], s99 offen offset:0 sc1
    v_mfma_f32_16x16x32_bf16 v[40:43], v[232:235], v[96:99], v[40:43]
    v_fmac_f32 v48, v112, v80
    v_fmac_f32 v49, v113, v80
    v_mfma_f32_16x16x32_bf16 v[56:59], v[236:239], v[96:99], v[56:59]
    v_fmac_f32 v50, v114, v80
    v_fmac_f32 v51, v115, v80
    v_mfma_f32_16x16x32_bf16 v[72:75], v[240:243], v[96:99], v[72:75]
    s_waitcnt lgkmcnt(2)
    v_cvt_pk_bf16_f32 v124, v48, v49
    v_cvt_pk_bf16_f32 v125, v50, v51
    v_mfma_f32_16x16x32_bf16 v[44:47], v[232:235], v[100:103], v[44:47]
    v_fmac_f32 v52, v112, v82
    v_fmac_f32 v53, v113, v82
    v_mfma_f32_16x16x32_bf16 v[60:63], v[236:239], v[100:103], v[60:63]
    s_add_u32 s55, s33, 20480
    buffer_load_dwordx4 v[144:147], v1, s[16:19], s55 offen offset:0
    v_mfma_f32_16x16x32_bf16 v[76:79], v[240:243], v[100:103], v[76:79]
    s_waitcnt lgkmcnt(1)
    v_fmac_f32 v54, v114, v82
    v_fmac_f32 v55, v115, v82
    v_mfma_f32_16x16x32_bf16 v[40:43], v[244:247], v[104:107], v[40:43]
    v_cvt_pk_bf16_f32 v126, v52, v53
    v_cvt_pk_bf16_f32 v127, v54, v55
    v_mfma_f32_16x16x32_bf16 v[56:59], v[248:251], v[104:107], v[56:59]
    buffer_load_dwordx4 v[148:151], v1, s[16:19], s55 offen offset:1024
    v_mfma_f32_16x16x32_bf16 v[72:75], v[252:255], v[104:107], v[72:75]
    s_waitcnt lgkmcnt(0)
    v_pk_max_i16 v124, v124, 0
    v_pk_max_i16 v126, v126, 0
    v_mfma_f32_16x16x32_bf16 v[44:47], v[244:247], v[88:91], v[44:47]
    v_pk_max_i16 v125, v125, 0
    v_pk_max_i16 v127, v127, 0
    v_mfma_f32_16x16x32_bf16 v[60:63], v[248:251], v[88:91], v[60:63]
    v_permlane16_swap_b32 v124, v126
    v_mfma_f32_16x16x32_bf16 v[76:79], v[252:255], v[88:91], v[76:79]
    v_permlane16_swap_b32 v125, v127
    buffer_store_dwordx4 v[124:127], v1, s[16:19], s100 offen offset:1024 sc1
    v_fmac_f32 v64, v116, v80
    v_fmac_f32 v65, v117, v80
    v_fmac_f32 v66, v118, v80
    v_fmac_f32 v67, v119, v80
    v_cvt_pk_bf16_f32 v120, v64, v65
    v_cvt_pk_bf16_f32 v121, v66, v67
    v_fmac_f32 v68, v116, v82
    v_fmac_f32 v69, v117, v82
    v_fmac_f32 v70, v118, v82
    v_fmac_f32 v71, v119, v82
    v_cvt_pk_bf16_f32 v122, v68, v69
    v_cvt_pk_bf16_f32 v123, v70, v71
    v_pk_max_i16 v120, v120, 0
    v_pk_max_i16 v122, v122, 0
    v_pk_max_i16 v121, v121, 0
    v_pk_max_i16 v123, v123, 0
    v_permlane16_swap_b32 v120, v122
    s_nop 0
    v_permlane16_swap_b32 v121, v123
    buffer_store_dwordx4 v[120:123], v1, s[16:19], s60 offen offset:2048 sc1
    v_pk_fma_f32 v[40:41], v[108:109], v[84:85], v[40:41] op_sel:[0,0,0] op_sel_hi:[1,0,1]
    v_pk_fma_f32 v[42:43], v[110:111], v[84:85], v[42:43] op_sel:[0,0,0] op_sel_hi:[1,0,1]
    v_cvt_pk_bf16_f32 v88, v40, v41
    v_cvt_pk_bf16_f32 v89, v42, v43
    v_pk_fma_f32 v[44:45], v[108:109], v[86:87], v[44:45] op_sel:[0,0,0] op_sel_hi:[1,0,1]
    v_pk_fma_f32 v[46:47], v[110:111], v[86:87], v[46:47] op_sel:[0,0,0] op_sel_hi:[1,0,1]
    v_cvt_pk_bf16_f32 v90, v44, v45
    v_cvt_pk_bf16_f32 v91, v46, v47
    v_pk_max_i16 v88, v88, 0
    v_pk_max_i16 v90, v90, 0
    v_pk_max_i16 v89, v89, 0
    v_pk_max_i16 v91, v91, 0
    v_permlane16_swap_b32 v88, v90
    s_nop 0
    v_permlane16_swap_b32 v89, v91
    buffer_store_dwordx4 v[88:91], v1, s[16:19], s100 offen offset:0 sc1
    v_pk_fma_f32 v[56:57], v[112:113], v[84:85], v[56:57] op_sel:[0,0,0] op_sel_hi:[1,0,1]
    v_pk_fma_f32 v[58:59], v[114:115], v[84:85], v[58:59] op_sel:[0,0,0] op_sel_hi:[1,0,1]
    v_cvt_pk_bf16_f32 v92, v56, v57
    v_cvt_pk_bf16_f32 v93, v58, v59
    v_pk_fma_f32 v[60:61], v[112:113], v[86:87], v[60:61] op_sel:[0,0,0] op_sel_hi:[1,0,1]
    v_pk_fma_f32 v[62:63], v[114:115], v[86:87], v[62:63] op_sel:[0,0,0] op_sel_hi:[1,0,1]
    v_cvt_pk_bf16_f32 v94, v60, v61
    v_cvt_pk_bf16_f32 v95, v62, v63
    v_pk_max_i16 v92, v92, 0
    v_pk_max_i16 v94, v94, 0
    v_pk_max_i16 v93, v93, 0
    v_pk_max_i16 v95, v95, 0
    v_permlane16_swap_b32 v92, v94
    s_nop 0
    v_permlane16_swap_b32 v93, v95
    buffer_store_dwordx4 v[92:95], v1, s[16:19], s99 offen offset:1024 sc1
    v_pk_fma_f32 v[72:73], v[116:117], v[84:85], v[72:73] op_sel:[0,0,0] op_sel_hi:[1,0,1]
    v_pk_fma_f32 v[74:75], v[118:119], v[84:85], v[74:75] op_sel:[0,0,0] op_sel_hi:[1,0,1]
    v_cvt_pk_bf16_f32 v96, v72, v73
    v_cvt_pk_bf16_f32 v97, v74, v75
    v_pk_fma_f32 v[76:77], v[116:117], v[86:87], v[76:77] op_sel:[0,0,0] op_sel_hi:[1,0,1]
    v_pk_fma_f32 v[78:79], v[118:119], v[86:87], v[78:79] op_sel:[0,0,0] op_sel_hi:[1,0,1]
    v_cvt_pk_bf16_f32 v98, v76, v77
    v_cvt_pk_bf16_f32 v99, v78, v79
    v_pk_max_i16 v96, v96, 0
    v_pk_max_i16 v98, v98, 0
    v_pk_max_i16 v97, v97, 0
    v_pk_max_i16 v99, v99, 0
    v_permlane16_swap_b32 v96, v98
    s_nop 0
    v_permlane16_swap_b32 v97, v99
    buffer_store_dwordx4 v[96:99], v1, s[16:19], s61 offen offset:2048 sc1
    buffer_load_dwordx4 v[152:155], v1, s[16:19], s55 offen offset:2048
    buffer_load_dwordx4 v[156:159], v1, s[16:19], s55 offen offset:3072
    s_add_u32 s55, s33, 24576
    buffer_load_dwordx4 v[160:163], v1, s[16:19], s55 offen offset:0
    buffer_load_dwordx4 v[164:167], v1, s[16:19], s55 offen offset:1024
    buffer_load_dwordx4 v[168:171], v1, s[16:19], s55 offen offset:2048
    buffer_load_dwordx4 v[172:175], v1, s[16:19], s55 offen offset:3072
    s_add_u32 s55, s33, 28672
    buffer_load_dwordx4 v[176:179], v1, s[16:19], s55 offen offset:0
    buffer_load_dwordx4 v[180:183], v1, s[16:19], s55 offen offset:1024
    buffer_load_dwordx4 v[184:187], v1, s[16:19], s55 offen offset:2048
    buffer_load_dwordx4 v[188:191], v1, s[16:19], s55 offen offset:3072
    v_mov_b32 v11, 3
    s_mov_b64 exec, 1
    s_waitcnt vmcnt(10)
    buffer_store_dword v11, off, s[16:19], s40 sc1
    s_mov_b64 exec, -1
    s_add_u32 s55, s33, 32768
    buffer_load_dwordx4 v[192:195], v1, s[16:19], s55 offen offset:0
    buffer_load_dwordx4 v[196:199], v1, s[16:19], s55 offen offset:1024
    buffer_load_dwordx4 v[200:203], v1, s[16:19], s55 offen offset:2048
    buffer_load_dwordx4 v[204:207], v1, s[16:19], s55 offen offset:3072
    s_add_u32 s55, s33, 36864
    buffer_load_dwordx4 v[208:211], v1, s[16:19], s55 offen offset:0
    buffer_load_dwordx4 v[212:215], v1, s[16:19], s55 offen offset:1024
    buffer_load_dwordx4 v[216:219], v1, s[16:19], s55 offen offset:2048
    buffer_load_dwordx4 v[220:223], v1, s[16:19], s55 offen offset:3072
    s_add_u32 s55, s33, 40960
    buffer_load_dwordx4 v[224:227], v1, s[16:19], s55 offen offset:0
    buffer_load_dwordx4 v[228:231], v1, s[16:19], s55 offen offset:1024
    s_mul_i32 s3, s6, 192
    s_add_u32 s3, s3, 1792
    v_add_u32 v13, s3, v10
    s_mov_b32 exec_lo, 0x10001
    s_mov_b32 exec_hi, 0x10001
    ds_write_b128 v13, v[108:111] offset:0
    ds_write_b128 v13, v[112:115] offset:64
    ds_write_b128 v13, v[116:119] offset:128
    s_mov_b64 exec, -1
    v_lshl_add_u32 v11, s25, 7, v6
    v_add_u32 v11, 161280, v11
    ds_read_b32 v14, v11
    s_lshl_b32 s44, s6, 11
    s_add_u32 s57, s35, s44
    s_cmp_ge_u32 s6, 2
    s_cselect_b32 s58, 134217728, s57
    v_lshl_add_u32 v12, s6, 12, v2
    v_xor_b32 v13, 0x1000, v12
    s_lshl3_add_u32 s3, s6, 196608
    s_bfe_u32 s3, s56, s3
    s_lshl_b32 s3, s3, 11
    s_add_u32 s97, s3, s43
    s_lshl3_add_u32 s3, s6, 196612
    s_bfe_u32 s3, s56, s3
    s_lshl_b32 s3, s3, 11
    s_add_u32 s98, s3, s43
    v_and_b32 v124, 0x300, v1
    v_add_u32 v124, v124, v1
    buffer_load_dword v11, v6, s[16:19], s39 offen sc1
    buffer_load_dwordx4 v[232:235], v1, s[16:19], s55 offen offset:2048
    s_waitcnt vmcnt(1)
    v_cmp_gt_i32 vcc, 3, v11
    s_cbranch_vccnz LS_spin_10
LS_got_11:
    s_add_u32 m0, s44, 0
    s_nop 0
    buffer_load_dwordx4 v1, s[16:19], s57 offen offset:0 sc1 lds
    buffer_load_dwordx4 v1, s[16:19], s57 offen offset:1024 sc1 lds
    s_add_u32 s54, s57, 8192
    s_add_u32 m0, s44, 8192
    s_nop 0
    buffer_load_dwordx4 v1, s[16:19], s54 offen offset:0 sc1 lds
    buffer_load_dwordx4 v1, s[16:19], s54 offen offset:1024 sc1 lds
    s_add_u32 s54, s57, 16384
    s_add_u32 m0, s44, 16384
    s_nop 0
    buffer_load_dwordx4 v1, s[16:19], s54 offen offset:0 sc1 lds
    buffer_load_dwordx4 v1, s[16:19], s54 offen offset:1024 sc1 lds
    s_waitcnt vmcnt(4)
    s_barrier
    ds_read_b128 v[64:67], v3 offset:0
    ds_read_b128 v[68:71], v3 offset:2048
    ds_read_b128 v[72:75], v3 offset:4096
    ds_read_b128 v[76:79], v3 offset:6144
    s_add_u32 s54, s57, 24576
    s_add_u32 m0, s44, 24576
    s_nop 0
    buffer_load_dwordx4 v1, s[16:19], s54 offen offset:0 sc1 lds
    buffer_load_dwordx4 v1, s[16:19], s54 offen offset:1024 sc1 lds
    s_add_u32 s54, s57, 32768
    s_add_u32 m0, s44, 32768
    s_nop 0
    buffer_load_dwordx4 v1, s[16:19], s54 offen offset:0 sc1 lds
    buffer_load_dwordx4 v1, s[16:19], s54 offen offset:1024 sc1 lds
    s_waitcnt lgkmcnt(3)
    v_mfma_f32_32x32x16_bf16 v[48:63], a[192:195], v[64:67], 0
    s_add_u32 s54, s57, 40960
    s_add_u32 m0, s44, 40960
    s_nop 0
    buffer_load_dwordx4 v1, s[16:19], s54 offen offset:0 sc1 lds
    s_waitcnt lgkmcnt(2)
    v_mfma_f32_32x32x16_bf16 v[48:63], a[196:199], v[68:71], v[48:63]
    s_waitcnt vmcnt(7)
    s_barrier
    ds_read_b128 v[80:83], v3 offset:8192
    ds_read_b128 v[84:87], v3 offset:10240
    s_waitcnt lgkmcnt(3)
    v_mfma_f32_32x32x16_bf16 v[48:63], a[200:203], v[72:75], v[48:63]
    ds_read_b128 v[88:91], v3 offset:12288
    ds_read_b128 v[92:95], v3 offset:14336
    s_waitcnt lgkmcnt(4)
    v_mfma_f32_32x32x16_bf16 v[48:63], a[204:207], v[76:79], v[48:63]
    buffer_load_dwordx4 v1, s[16:19], s54 offen offset:1024 sc1 lds
    s_waitcnt lgkmcnt(3)
    v_mfma_f32_32x32x16_bf16 v[48:63], a[208:211], v[80:83], v[48:63]
    s_add_u32 s54, s57, 49152
    s_add_u32 m0, s44, 49152
    s_nop 0
    buffer_load_dwordx4 v1, s[16:19], s54 offen offset:0 sc1 lds
    s_waitcnt lgkmcnt(2)
    v_mfma_f32_32x32x16_bf16 v[48:63], a[212:215], v[84:87], v[48:63]
    s_waitcnt vmcnt(7)
    s_barrier
    ds_read_b128 v[64:67], v3 offset:16384
    ds_read_b128 v[68:71], v3 offset:18432
    s_waitcnt lgkmcnt(3)
    v_mfma_f32_32x32x16_bf16 v[48:63], a[216:219], v[88:91], v[48:63]
    ds_read_b128 v[72:75], v3 offset:20480
    ds_read_b128 v[76:79], v3 offset:22528
    s_waitcnt lgkmcnt(4)
    v_mfma_f32_32x32x16_bf16 v[48:63], a[220:223], v[92:95], v[48:63]
    buffer_load_dwordx4 v1, s[16:19], s54 offen offset:1024 sc1 lds
    s_waitcnt lgkmcnt(3)
    v_mfma_f32_32x32x16_bf16 v[48:63], a[224:227], v[64:67], v[48:63]
    s_add_u32 s54, s57, 57344
    s_add_u32 m0, s44, 57344
    s_nop 0
    buffer_load_dwordx4 v1, s[16:19], s54 offen offset:0 sc1 lds
    s_waitcnt lgkmcnt(2)
    v_mfma_f32_32x32x16_bf16 v[48:63], a[228:231], v[68:71], v[48:63]
    s_waitcnt vmcnt(7)
    s_barrier
    ds_read_b128 v[80:83], v3 offset:24576
    ds_read_b128 v[84:87], v3 offset:26624
    s_waitcnt lgkmcnt(3)
    v_mfma_f32_32x32x16_bf16 v[48:63], a[232:235], v[72:75], v[48:63]
    ds_read_b128 v[88:91], v3 offset:28672
    ds_read_b128 v[92:95], v3 offset:30720
    s_waitcnt lgkmcnt(4)
    v_mfma_f32_32x32x16_bf16 v[48:63], a[236:239], v[76:79], v[48:63]
    buffer_load_dwordx4 v1, s[16:19], s54 offen offset:1024 sc1 lds
    s_waitcnt lgkmcnt(3)
    v_mfma_f32_32x32x16_bf16 v[48:63], a[240:243], v[80:83], v[48:63]
    s_add_u32 s54, s57, 65536
    s_add_u32 m0, s44, 0
    s_nop 0
    buffer_load_dwordx4 v1, s[16:19], s54 offen offset:0 sc1 lds
    s_waitcnt lgkmcnt(2)
    v_mfma_f32_32x32x16_bf16 v[48:63], a[244:247], v[84:87], v[48:63]
    s_waitcnt vmcnt(7)
    s_barrier
    ds_read_b128 v[64:67], v3 offset:32768
    ds_read_b128 v[68:71], v3 offset:34816
    s_waitcnt lgkmcnt(3)
    v_mfma_f32_32x32x16_bf16 v[48:63], a[248:251], v[88:91], v[48:63]
    ds_read_b128 v[72:75], v3 offset:36864
    ds_read_b128 v[76:79], v3 offset:38912
    s_waitcnt lgkmcnt(4)
    v_mfma_f32_32x32x16_bf16 v[48:63], a[252:255], v[92:95], v[48:63]
    buffer_load_dwordx4 v1, s[16:19], s54 offen offset:1024 sc1 lds
    s_waitcnt lgkmcnt(3)
    v_mfma_f32_32x32x16_bf16 v[48:63], v[128:131], v[64:67], v[48:63]
    s_add_u32 s54, s57, 73728
    s_add_u32 m0, s44, 8192
    s_nop 0
    buffer_load_dwordx4 v1, s[16:19], s54 offen offset:0 sc1 lds
    s_waitcnt lgkmcnt(2)
    v_mfma_f32_32x32x16_bf16 v[48:63], v[132:135], v[68:71], v[48:63]
    s_waitcnt vmcnt(7)
    s_barrier
    ds_read_b128 v[80:83], v3 offset:40960
    ds_read_b128 v[84:87], v3 offset:43008
    s_waitcnt lgkmcnt(3)
    v_mfma_f32_32x32x16_bf16 v[48:63], v[136:139], v[72:75], v[48:63]
    ds_read_b128 v[88:91], v3 offset:45056
    ds_read_b128 v[92:95], v3 offset:47104
    s_waitcnt lgkmcnt(4)
    v_mfma_f32_32x32x16_bf16 v[48:63], v[140:143], v[76:79], v[48:63]
    buffer_load_dwordx4 v1, s[16:19], s54 offen offset:1024 sc1 lds
    s_waitcnt lgkmcnt(3)
    v_mfma_f32_32x32x16_bf16 v[48:63], v[144:147], v[80:83], v[48:63]
    s_add_u32 s54, s57, 81920
    s_add_u32 m0, s44, 16384
    s_nop 0
    buffer_load_dwordx4 v1, s[16:19], s54 offen offset:0 sc1 lds
    s_waitcnt lgkmcnt(2)
    v_mfma_f32_32x32x16_bf16 v[48:63], v[148:151], v[84:87], v[48:63]
    s_waitcnt vmcnt(7)
    s_barrier
    ds_read_b128 v[64:67], v3 offset:49152
    ds_read_b128 v[68:71], v3 offset:51200
    s_waitcnt lgkmcnt(3)
    v_mfma_f32_32x32x16_bf16 v[48:63], v[152:155], v[88:91], v[48:63]
    ds_read_b128 v[72:75], v3 offset:53248
    ds_read_b128 v[76:79], v3 offset:55296
    s_waitcnt lgkmcnt(4)
    v_mfma_f32_32x32x16_bf16 v[48:63], v[156:159], v[92:95], v[48:63]
    buffer_load_dwordx4 v1, s[16:19], s54 offen offset:1024 sc1 lds
    s_waitcnt lgkmcnt(3)
    v_mfma_f32_32x32x16_bf16 v[48:63], v[160:163], v[64:67], v[48:63]
    s_add_u32 s54, s57, 90112
    s_add_u32 m0, s44, 24576
    s_nop 0
    buffer_load_dwordx4 v1, s[16:19], s54 offen offset:0 sc1 lds
    s_waitcnt lgkmcnt(2)
    v_mfma_f32_32x32x16_bf16 v[48:63], v[164:167], v[68:71], v[48:63]
    s_waitcnt vmcnt(7)
    s_barrier
    ds_read_b128 v[80:83], v3 offset:57344
    ds_read_b128 v[84:87], v3 offset:59392
    s_waitcnt lgkmcnt(3)
    v_mfma_f32_32x32x16_bf16 v[48:63], v[168:171], v[72:75], v[48:63]
    ds_read_b128 v[88:91], v3 offset:61440
    ds_read_b128 v[92:95], v3 offset:63488
    s_waitcnt lgkmcnt(4)
    v_mfma_f32_32x32x16_bf16 v[48:63], v[172:175], v[76:79], v[48:63]
    buffer_load_dwordx4 v1, s[16:19], s54 offen offset:1024 sc1 lds
    s_waitcnt lgkmcnt(3)
    v_mfma_f32_32x32x16_bf16 v[48:63], v[176:179], v[80:83], v[48:63]
    s_add_u32 s54, s57, 98304
    s_add_u32 m0, s44, 32768
    s_nop 0
    buffer_load_dwordx4 v1, s[16:19], s54 offen offset:0 sc1 lds
    s_waitcnt lgkmcnt(2)
    v_mfma_f32_32x32x16_bf16 v[48:63], v[180:183], v[84:87], v[48:63]
    s_waitcnt vmcnt(7)
    s_barrier
    ds_read_b128 v[64:67], v3 offset:0
    ds_read_b128 v[68:71], v3 offset:2048
    s_waitcnt lgkmcnt(3)
    v_mfma_f32_32x32x16_bf16 v[48:63], v[184:187], v[88:91], v[48:63]
    ds_read_b128 v[72:75], v3 offset:4096
    ds_read_b128 v[76:79], v3 offset:6144
    s_waitcnt lgkmcnt(4)
    v_mfma_f32_32x32x16_bf16 v[48:63], v[188:191], v[92:95], v[48:63]
    buffer_load_dwordx4 v1, s[16:19], s54 offen offset:1024 sc1 lds
    s_waitcnt lgkmcnt(3)
    v_mfma_f32_32x32x16_bf16 v[48:63], v[192:195], v[64:67], v[48:63]
    s_add_u32 s54, s57, 106496
    s_add_u32 m0, s44, 40960
    s_nop 0
    buffer_load_dwordx4 v1, s[16:19], s54 offen offset:0 sc1 lds
    s_waitcnt lgkmcnt(2)
    v_mfma_f32_32x32x16_bf16 v[48:63], v[196:199], v[68:71], v[48:63]
    s_waitcnt vmcnt(7)
    s_barrier
    ds_read_b128 v[80:83], v3 offset:8192
    ds_read_b128 v[84:87], v3 offset:10240
    s_waitcnt lgkmcnt(3)
    v_mfma_f32_32x32x16_bf16 v[48:63], v[200:203], v[72:75], v[48:63]
    ds_read_b128 v[88:91], v3 offset:12288
    ds_read_b128 v[92:95], v3 offset:14336
    s_waitcnt lgkmcnt(4)
    v_mfma_f32_32x32x16_bf16 v[48:63], v[204:207], v[76:79], v[48:63]
    buffer_load_dwordx4 v1, s[16:19], s54 offen offset:1024 sc1 lds
    s_waitcnt lgkmcnt(3)
    v_mfma_f32_32x32x16_bf16 v[48:63], v[208:211], v[80:83], v[48:63]
    s_add_u32 s54, s57, 114688
    s_add_u32 m0, s44, 49152
    s_nop 0
    buffer_load_dwordx4 v1, s[16:19], s54 offen offset:0 sc1 lds
    s_waitcnt lgkmcnt(2)
    v_mfma_f32_32x32x16_bf16 v[48:63], v[212:215], v[84:87], v[48:63]
    s_waitcnt vmcnt(7)
    s_barrier
    ds_read_b128 v[64:67], v3 offset:16384
    ds_read_b128 v[68:71], v3 offset:18432
    s_waitcnt lgkmcnt(3)
    v_mfma_f32_32x32x16_bf16 v[48:63], v[216:219], v[88:91], v[48:63]
    ds_read_b128 v[72:75], v3 offset:20480
    ds_read_b128 v[76:79], v3 offset:22528
    s_waitcnt lgkmcnt(4)
    v_mfma_f32_32x32x16_bf16 v[48:63], v[220:223], v[92:95], v[48:63]
    buffer_load_dwordx4 v1, s[16:19], s54 offen offset:1024 sc1 lds
    s_waitcnt lgkmcnt(3)
    v_mfma_f32_32x32x16_bf16 v[48:63], v[224:227], v[64:67], v[48:63]
    s_add_u32 s54, s57, 122880
    s_add_u32 m0, s44, 57344
    s_nop 0
    buffer_load_dwordx4 v1, s[16:19], s54 offen offset:0 sc1 lds
    s_waitcnt lgkmcnt(2)
    v_mfma_f32_32x32x16_bf16 v[48:63], v[228:231], v[68:71], v[48:63]
    s_waitcnt vmcnt(7)
    s_barrier
    ds_read_b128 v[80:83], v3 offset:24576
    ds_read_b128 v[84:87], v3 offset:26624
    s_waitcnt lgkmcnt(3)
    v_mfma_f32_32x32x16_bf16 v[48:63], v[232:235], v[72:75], v[48:63]
    ds_read_b128 v[88:91], v3 offset:28672
    ds_read_b128 v[92:95], v3 offset:30720
    s_waitcnt lgkmcnt(4)
    v_mfma_f32_32x32x16_bf16 v[32:47], a[192:195], v[76:79], 0
    buffer_load_dwordx4 v1, s[16:19], s54 offen offset:1024 sc1 lds
    s_waitcnt lgkmcnt(3)
    v_mfma_f32_32x32x16_bf16 v[32:47], a[196:199], v[80:83], v[32:47]
    s_add_u32 s54, s57, 131072
    s_add_u32 m0, s44, 0
    s_nop 0
    buffer_load_dwordx4 v1, s[16:19], s54 offen offset:0 sc1 lds
    s_nop 0
    v_cvt_pk_bf16_f32 v48, v48, v49
    v_cvt_pk_bf16_f32 v49, v50, v51
    s_waitcnt lgkmcnt(2)
    v_mfma_f32_32x32x16_bf16 v[32:47], a[200:203], v[84:87], v[32:47]
    s_waitcnt vmcnt(7)
    s_barrier
    ds_read_b128 v[64:67], v3 offset:32768
    ds_read_b128 v[68:71], v3 offset:34816
    v_cvt_pk_bf16_f32 v50, v52, v53
    s_waitcnt lgkmcnt(3)
    v_mfma_f32_32x32x16_bf16 v[32:47], a[204:207], v[88:91], v[32:47]
    ds_read_b128 v[72:75], v3 offset:36864
    ds_read_b128 v[76:79], v3 offset:38912
    v_cvt_pk_bf16_f32 v51, v54, v55
    v_cvt_pk_bf16_f32 v52, v56, v57
    v_cvt_pk_bf16_f32 v53, v58, v59
    s_waitcnt lgkmcnt(4)
    v_mfma_f32_32x32x16_bf16 v[32:47], a[208:211], v[92:95], v[32:47]
    buffer_load_dwordx4 v1, s[16:19], s54 offen offset:1024 sc1 lds
    v_cvt_pk_bf16_f32 v54, v60, v61
    v_cvt_pk_bf16_f32 v55, v62, v63
    s_waitcnt lgkmcnt(3)
    v_mfma_f32_32x32x16_bf16 v[32:47], a[212:215], v[64:67], v[32:47]
    s_add_u32 s54, s57, 139264
    s_add_u32 m0, s44, 8192
    s_nop 0
    buffer_load_dwordx4 v1, s[16:19], s54 offen offset:0 sc1 lds
    s_waitcnt lgkmcnt(2)
    v_mfma_f32_32x32x16_bf16 v[32:47], a[216:219], v[68:71], v[32:47]
    s_waitcnt vmcnt(7)
    s_barrier
    ds_read_b128 v[80:83], v3 offset:40960
    ds_read_b128 v[84:87], v3 offset:43008
    s_waitcnt lgkmcnt(3)
    v_mfma_f32_32x32x16_bf16 v[32:47], a[220:223], v[72:75], v[32:47]
    ds_read_b128 v[88:91], v3 offset:45056
    ds_read_b128 v[92:95], v3 offset:47104
    s_waitcnt lgkmcnt(4)
    v_mfma_f32_32x32x16_bf16 v[32:47], a[224:227], v[76:79], v[32:47]
    buffer_load_dwordx4 v1, s[16:19], s54 offen offset:1024 sc1 lds
    s_waitcnt lgkmcnt(3)
    v_mfma_f32_32x32x16_bf16 v[32:47], a[228:231], v[80:83], v[32:47]
    s_add_u32 s54, s57, 147456
    s_add_u32 m0, s44, 16384
    s_nop 0
    buffer_load_dwordx4 v1, s[16:19], s54 offen offset:0 sc1 lds
    s_waitcnt lgkmcnt(2)
    v_mfma_f32_32x32x16_bf16 v[32:47], a[232:235], v[84:87], v[32:47]
    s_waitcnt vmcnt(7)
    s_barrier
    ds_read_b128 v[64:67], v3 offset:49152
    ds_read_b128 v[68:71], v3 offset:51200
    s_waitcnt lgkmcnt(3)
    v_mfma_f32_32x32x16_bf16 v[32:47], a[236:239], v[88:91], v[32:47]
    ds_read_b128 v[72:75], v3 offset:53248
    ds_read_b128 v[76:79], v3 offset:55296
    s_waitcnt lgkmcnt(4)
    v_mfma_f32_32x32x16_bf16 v[32:47], a[240:243], v[92:95], v[32:47]
    buffer_load_dwordx4 v1, s[16:19], s54 offen offset:1024 sc1 lds
    s_waitcnt lgkmcnt(3)
    v_mfma_f32_32x32x16_bf16 v[32:47], a[244:247], v[64:67], v[32:47]
    s_add_u32 s54, s57, 155648
    s_add_u32 m0, s44, 24576
    s_nop 0
    buffer_load_dwordx4 v1, s[16:19], s54 offen offset:0 sc1 lds
    s_waitcnt lgkmcnt(2)
    v_mfma_f32_32x32x16_bf16 v[32:47], a[248:251], v[68:71], v[32:47]
    s_waitcnt vmcnt(7)
    s_barrier
    ds_read_b128 v[80:83], v3 offset:57344
    ds_read_b128 v[84:87], v3 offset:59392
    s_waitcnt lgkmcnt(3)
    v_mfma_f32_32x32x16_bf16 v[32:47], a[252:255], v[72:75], v[32:47]
    ds_read_b128 v[88:91], v3 offset:61440
    ds_read_b128 v[92:95], v3 offset:63488
    s_waitcnt lgkmcnt(4)
    v_mfma_f32_32x32x16_bf16 v[32:47], v[128:131], v[76:79], v[32:47]
    buffer_load_dwordx4 v1, s[16:19], s54 offen offset:1024 sc1 lds
    s_waitcnt lgkmcnt(3)
    v_mfma_f32_32x32x16_bf16 v[32:47], v[132:135], v[80:83], v[32:47]
    s_add_u32 s54, s57, 163840
    s_add_u32 m0, s44, 32768
    s_nop 0
    buffer_load_dwordx4 v1, s[16:19], s54 offen offset:0 sc1 lds
    s_waitcnt lgkmcnt(2)
    v_mfma_f32_32x32x16_bf16 v[32:47], v[136:139], v[84:87], v[32:47]
    s_waitcnt vmcnt(7)
    s_barrier
    ds_read_b128 v[64:67], v3 offset:0
    ds_read_b128 v[68:71], v3 offset:2048
    s_waitcnt lgkmcnt(3)
    v_mfma_f32_32x32x16_bf16 v[32:47], v[140:143], v[88:91], v[32:47]
    ds_read_b128 v[72:75], v3 offset:4096
    ds_read_b128 v[76:79], v3 offset:6144
    s_waitcnt lgkmcnt(4)
    v_mfma_f32_32x32x16_bf16 v[32:47], v[144:147], v[92:95], v[32:47]
    buffer_load_dwordx4 v1, s[16:19], s54 offen offset:1024 sc1 lds
    s_waitcnt lgkmcnt(3)
    v_mfma_f32_32x32x16_bf16 v[32:47], v[148:151], v[64:67], v[32:47]
    s_add_u32 s54, s58, 172032
    s_add_u32 m0, s44, 40960
    s_nop 0
    buffer_load_dwordx4 v1, s[16:19], s54 offen offset:0 sc1 lds
    s_waitcnt lgkmcnt(2)
    v_mfma_f32_32x32x16_bf16 v[32:47], v[152:155], v[68:71], v[32:47]
    s_waitcnt vmcnt(7)
    s_barrier
    ds_read_b128 v[80:83], v3 offset:8192
    ds_read_b128 v[84:87], v3 offset:10240
    s_waitcnt lgkmcnt(3)
    v_mfma_f32_32x32x16_bf16 v[32:47], v[156:159], v[72:75], v[32:47]
    ds_read_b128 v[88:91], v3 offset:12288
    ds_read_b128 v[92:95], v3 offset:14336
    s_waitcnt lgkmcnt(4)
    v_mfma_f32_32x32x16_bf16 v[32:47], v[160:163], v[76:79], v[32:47]
    buffer_load_dwordx4 v1, s[16:19], s54 offen offset:1024 sc1 lds
    s_waitcnt lgkmcnt(3)
    v_mfma_f32_32x32x16_bf16 v[32:47], v[164:167], v[80:83], v[32:47]
    s_waitcnt lgkmcnt(2)
    v_mfma_f32_32x32x16_bf16 v[32:47], v[168:171], v[84:87], v[32:47]
    s_waitcnt vmcnt(6)
    s_barrier
    ds_read_b128 v[64:67], v3 offset:16384
    ds_read_b128 v[68:71], v3 offset:18432
    s_waitcnt lgkmcnt(3)
    v_mfma_f32_32x32x16_bf16 v[32:47], v[172:175], v[88:91], v[32:47]
    ds_read_b128 v[72:75], v3 offset:20480
    ds_read_b128 v[76:79], v3 offset:22528
    s_waitcnt lgkmcnt(4)
    v_mfma_f32_32x32x16_bf16 v[32:47], v[176:179], v[92:95], v[32:47]
    s_waitcnt lgkmcnt(3)
    v_mfma_f32_32x32x16_bf16 v[32:47], v[180:183], v[64:67], v[32:47]
    s_waitcnt lgkmcnt(2)
    v_mfma_f32_32x32x16_bf16 v[32:47], v[184:187], v[68:71], v[32:47]
    s_waitcnt vmcnt(4)
    s_barrier
    ds_read_b128 v[80:83], v3 offset:24576
    ds_read_b128 v[84:87], v3 offset:26624
    s_waitcnt lgkmcnt(3)
    v_mfma_f32_32x32x16_bf16 v[32:47], v[188:191], v[72:75], v[32:47]
    ds_read_b128 v[88:91], v3 offset:28672
    ds_read_b128 v[92:95], v3 offset:30720
    s_waitcnt lgkmcnt(4)
    v_mfma_f32_32x32x16_bf16 v[32:47], v[192:195], v[76:79], v[32:47]
    ds_write_b128 v12, v[48:51] offset:0
    s_waitcnt lgkmcnt(4)
    v_mfma_f32_32x32x16_bf16 v[32:47], v[196:199], v[80:83], v[32:47]
    ds_write_b128 v12, v[52:55] offset:1024
    s_waitcnt lgkmcnt(4)
    v_mfma_f32_32x32x16_bf16 v[32:47], v[200:203], v[84:87], v[32:47]
    s_waitcnt lgkmcnt(0)
    s_waitcnt vmcnt(2)
    s_barrier
    ds_read_b128 v[64:67], v3 offset:32768
    ds_read_b128 v[68:71], v3 offset:34816
    v_mfma_f32_32x32x16_bf16 v[32:47], v[204:207], v[88:91], v[32:47]
    ds_read_b128 v[72:75], v3 offset:36864
    ds_read_b128 v[76:79], v3 offset:38912
    v_mfma_f32_32x32x16_bf16 v[32:47], v[208:211], v[92:95], v[32:47]
    ds_read_b128 v[56:59], v13 offset:0
    ds_read_b128 v[60:63], v13 offset:1024
    s_waitcnt lgkmcnt(5)
    v_mfma_f32_32x32x16_bf16 v[32:47], v[212:215], v[64:67], v[32:47]
    s_waitcnt lgkmcnt(0)
    v_lshlrev_b32 v48, 16, v56
    v_and_b32 v49, 0xffff0000, v56
    v_lshlrev_b32 v50, 16, v57
    v_and_b32 v51, 0xffff0000, v57
    v_lshlrev_b32 v52, 16, v58
    v_and_b32 v53, 0xffff0000, v58
    v_mfma_f32_32x32x16_bf16 v[32:47], v[216:219], v[68:71], v[32:47]
    s_waitcnt vmcnt(0)
    s_barrier
    ds_read_b128 v[80:83], v3 offset:40960
    ds_read_b128 v[84:87], v3 offset:43008
    v_lshlrev_b32 v54, 16, v59
    v_mfma_f32_32x32x16_bf16 v[32:47], v[220:223], v[72:75], v[32:47]
    v_and_b32 v55, 0xffff0000, v59
    v_lshlrev_b32 v56, 16, v60
    v_and_b32 v57, 0xffff0000, v60
    v_lshlrev_b32 v58, 16, v61
    v_and_b32 v59, 0xffff0000, v61
    v_lshlrev_b32 v60, 16, v62
    v_mfma_f32_32x32x16_bf16 v[32:47], v[224:227], v[76:79], v[32:47]
    v_and_b32 v61, 0xffff0000, v62
    v_lshlrev_b32 v62, 16, v63
    v_and_b32 v63, 0xffff0000, v63
    v_fmac_f32 v16, v14, v48
    v_fmac_f32 v17, v14, v49
    v_fmac_f32 v18, v14, v50
    s_waitcnt lgkmcnt(1)
    v_mfma_f32_32x32x16_bf16 v[32:47], v[228:231], v[80:83], v[32:47]
    v_fmac_f32 v19, v14, v51
    v_fmac_f32 v20, v14, v52
    v_fmac_f32 v21, v14, v53
    v_fmac_f32 v22, v14, v54
    v_fmac_f32 v23, v14, v55
    v_fmac_f32 v24, v14, v56
    s_waitcnt lgkmcnt(0)
    v_mfma_f32_32x32x16_bf16 v[32:47], v[232:235], v[84:87], v[32:47]
    v_fmac_f32 v25, v14, v57
    v_fmac_f32 v26, v14, v58
    v_fmac_f32 v27, v14, v59
    v_fmac_f32 v28, v14, v60
    v_fmac_f32 v29, v14, v61
    v_fmac_f32 v30, v14, v62
    v_fmac_f32 v31, v14, v63
    s_nop 4
    v_pk_fma_f32 v[16:17], v[32:33], v[14:15], v[16:17] op_sel:[0,0,0] op_sel_hi:[1,0,1]
    v_pk_fma_f32 v[18:19], v[34:35], v[14:15], v[18:19] op_sel:[0,0,0] op_sel_hi:[1,0,1]
    v_pk_fma_f32 v[20:21], v[36:37], v[14:15], v[20:21] op_sel:[0,0,0] op_sel_hi:[1,0,1]
    v_pk_fma_f32 v[22:23], v[38:39], v[14:15], v[22:23] op_sel:[0,0,0] op_sel_hi:[1,0,1]
    v_cvt_pk_bf16_f32 v64, v16, v17
    v_cvt_pk_bf16_f32 v65, v18, v19
    v_cvt_pk_bf16_f32 v66, v20, v21
    v_cvt_pk_bf16_f32 v67, v22, v23
    buffer_store_dwordx4 v[64:67], v5, s[16:19], s47 offen offset:0 sc1
    v_pk_fma_f32 v[24:25], v[40:41], v[14:15], v[24:25] op_sel:[0,0,0] op_sel_hi:[1,0,1]
    v_pk_fma_f32 v[26:27], v[42:43], v[14:15], v[26:27] op_sel:[0,0,0] op_sel_hi:[1,0,1]
    v_pk_fma_f32 v[28:29], v[44:45], v[14:15], v[28:29] op_sel:[0,0,0] op_sel_hi:[1,0,1]
    v_pk_fma_f32 v[30:31], v[46:47], v[14:15], v[30:31] op_sel:[0,0,0] op_sel_hi:[1,0,1]
    v_cvt_pk_bf16_f32 v68, v24, v25
    v_cvt_pk_bf16_f32 v69, v26, v27
    v_cvt_pk_bf16_f32 v70, v28, v29
    v_cvt_pk_bf16_f32 v71, v30, v31
    buffer_store_dwordx4 v[68:71], v5, s[16:19], s47 offen offset:512 sc1
    v_pk_add_f32 v[12:13], v[16:17], v[18:19]
    v_pk_mul_f32 v[78:79], v[16:17], v[16:17]
    v_pk_fma_f32 v[78:79], v[18:19], v[18:19], v[78:79]
    v_pk_add_f32 v[12:13], v[12:13], v[20:21]
    v_pk_fma_f32 v[78:79], v[20:21], v[20:21], v[78:79]
    v_pk_add_f32 v[12:13], v[12:13], v[22:23]
    v_pk_fma_f32 v[78:79], v[22:23], v[22:23], v[78:79]
    v_pk_add_f32 v[12:13], v[12:13], v[24:25]
    v_pk_fma_f32 v[78:79], v[24:25], v[24:25], v[78:79]
    v_pk_add_f32 v[12:13], v[12:13], v[26:27]
    v_pk_fma_f32 v[78:79], v[26:27], v[26:27], v[78:79]
    v_pk_add_f32 v[12:13], v[12:13], v[28:29]
    v_pk_fma_f32 v[78:79], v[28:29], v[28:29], v[78:79]
    v_pk_add_f32 v[12:13], v[12:13], v[30:31]
    v_pk_fma_f32 v[78:79], v[30:31], v[30:31], v[78:79]
    v_add_f32 v12, v12, v13
    v_add_f32 v14, v78, v79
    s_nop 1
    v_permlane32_swap_b32 v12, v14
    v_add_f32 v14, v12, v14
    buffer_store_dword v14, v7, s[16:19], s36 offen sc1
    ds_write_b128 v0, v[64:67] offset:0
    ds_write_b128 v0, v[68:71] offset:512
    s_lshl_b32 s44, s6, 14
    s_add_u32 s58, s34, s44
    s_waitcnt lgkmcnt(0)
    s_barrier
    ds_read_b128 v[88:91], v1 offset:0
    ds_read_b128 v[92:95], v1 offset:16384
    ds_read_b128 v[96:99], v1 offset:32768
    ds_read_b128 v[100:103], v1 offset:49152
    s_waitcnt lgkmcnt(3)
    v_mfma_f32_16x16x32_bf16 v[32:35], a[0:3], v[88:91], 0
    ds_read_b128 v[104:107], v1 offset:1024
    v_mov_b32 v248, 0x3f803f80
    v_mfma_f32_16x16x32_bf16 v[48:51], a[4:7], v[88:91], 0
    v_mov_b32 v249, 0x3f803f80
    v_mov_b32 v250, 0x3f803f80
    v_mfma_f32_16x16x32_bf16 v[72:75], v[88:91], a[8:11], 0
    s_waitcnt lgkmcnt(3)
    v_mov_b32 v251, 0x3f803f80
    s_mul_i32 s3, s6, 192
    v_mfma_f32_16x16x32_bf16 v[36:39], a[0:3], v[92:95], 0
    ds_read_b128 v[88:91], v1 offset:17408
    s_add_u32 s3, s3, 1024
    v_mfma_f32_16x16x32_bf16 v[52:55], a[4:7], v[92:95], 0
    v_mov_b32 v11, 4
    s_mov_b64 exec, 1
    s_waitcnt vmcnt(0)
    buffer_store_dword v11, off, s[16:19], s40 sc1
    s_mov_b64 exec, -1
    v_mfma_f32_16x16x32_bf16 v[76:79], v[92:95], a[8:11], 0
    s_waitcnt lgkmcnt(3)
    v_add_u32 v13, s3, v10
    s_add_u32 s3, s3, 81024
    v_mfma_f32_16x16x32_bf16 v[40:43], a[0:3], v[96:99], 0
    ds_read_b128 v[92:95], v1 offset:33792
    v_lshrrev_b32 v12, 1, v9
    v_mfma_f32_16x16x32_bf16 v[56:59], a[4:7], v[96:99], 0
    v_add_u32 v12, s3, v12
    v_mfma_f32_16x16x32_bf16 v[80:83], v[96:99], a[8:11], 0
    s_waitcnt lgkmcnt(3)
    ds_read_b128 v[236:239], v13 offset:0
    v_mfma_f32_16x16x32_bf16 v[44:47], a[0:3], v[100:103], 0
    ds_read_b128 v[96:99], v1 offset:50176
    v_mfma_f32_16x16x32_bf16 v[60:63], a[4:7], v[100:103], 0
    ds_read_b128 v[240:243], v13 offset:64
    v_mfma_f32_16x16x32_bf16 v[84:87], v[100:103], a[8:11], 0
    s_waitcnt lgkmcnt(5)
    ds_read_b32 v244, v12
    v_mfma_f32_16x16x32_bf16 v[32:35], a[12:15], v[104:107], v[32:35]
    v_mfma_f32_16x16x32_bf16 v[48:51], a[16:19], v[104:107], v[48:51]
    v_mfma_f32_16x16x32_bf16 v[72:75], v[104:107], a[20:23], v[72:75]
    s_waitcnt lgkmcnt(5)
    v_mfma_f32_16x16x32_bf16 v[36:39], a[12:15], v[88:91], v[36:39]
    v_mfma_f32_16x16x32_bf16 v[52:55], a[16:19], v[88:91], v[52:55]
    v_mfma_f32_16x16x32_bf16 v[76:79], v[88:91], a[20:23], v[76:79]
    s_waitcnt lgkmcnt(4)
    v_mfma_f32_16x16x32_bf16 v[40:43], a[12:15], v[92:95], v[40:43]
    v_mfma_f32_16x16x32_bf16 v[56:59], a[16:19], v[92:95], v[56:59]
    buffer_load_dword v11, v6, s[16:19], s39 offen sc1
    v_mfma_f32_16x16x32_bf16 v[80:83], v[92:95], a[20:23], v[80:83]
    s_waitcnt lgkmcnt(2)
    v_mfma_f32_16x16x32_bf16 v[44:47], a[12:15], v[96:99], v[44:47]
    v_mfma_f32_16x16x32_bf16 v[60:63], a[16:19], v[96:99], v[60:63]
    v_mfma_f32_16x16x32_bf16 v[84:87], v[96:99], a[20:23], v[84:87]
    s_bfe_u32 s3, s56, 196612
    s_lshl_b32 s3, s3, 11
    s_add_u32 m0, s44, 2048
    s_add_u32 s57, s3, s58
    s_waitcnt vmcnt(0)
    v_cmp_gt_i32 vcc, 4, v11
    s_cbranch_vccnz LS_spin_13
LS_got_14:
    buffer_load_dwordx4 v1, s[16:19], s57 offen offset:0 sc1 lds
    buffer_load_dwordx4 v1, s[16:19], s57 offen offset:1024 sc1 lds
    s_bfe_u32 s3, s56, 196616
    s_lshl_b32 s3, s3, 11
    s_add_u32 m0, s44, 4096
    s_add_u32 s57, s3, s58
    buffer_load_dwordx4 v1, s[16:19], s57 offen offset:0 sc1 lds
    s_waitcnt vmcnt(2)
    s_barrier
    ds_read_b128 v[88:91], v1 offset:2048
    ds_read_b128 v[92:95], v1 offset:18432
    ds_read_b128 v[96:99], v1 offset:34816
    ds_read_b128 v[100:103], v1 offset:51200
    s_waitcnt lgkmcnt(3)
    v_mfma_f32_16x16x32_bf16 v[32:35], a[24:27], v[88:91], v[32:35]
    s_waitcnt vmcnt(1)
    s_barrier
    ds_read_b128 v[104:107], v1 offset:3072
    v_mfma_f32_16x16x32_bf16 v[48:51], a[28:31], v[88:91], v[48:51]
    buffer_load_dwordx4 v1, s[16:19], s57 offen offset:1024 sc1 lds
    v_mfma_f32_16x16x32_bf16 v[72:75], v[88:91], a[32:35], v[72:75]
    s_waitcnt lgkmcnt(3)
    v_mov_b32 v11, 0xffff
    v_mov_b32 v12, 0xffff0000
    v_mfma_f32_16x16x32_bf16 v[36:39], a[24:27], v[92:95], v[36:39]
    ds_read_b128 v[88:91], v1 offset:19456
    v_cndmask_b32 v11, v11, v12, s[48:49]
    v_mfma_f32_16x16x32_bf16 v[52:55], a[28:31], v[92:95], v[52:55]
    s_bfe_u32 s3, s56, 196620
    s_lshl_b32 s3, s3, 11
    s_add_u32 m0, s44, 6144
    s_add_u32 s57, s3, s58
    buffer_load_dwordx4 v1, s[16:19], s57 offen offset:0 sc1 lds
    v_mfma_f32_16x16x32_bf16 v[76:79], v[92:95], a[32:35], v[76:79]
    s_waitcnt lgkmcnt(3)
    v_cndmask_b32 v252, v11, 0, s[50:51]
    v_cndmask_b32 v253, v11, 0, s[52:53]
    v_mfma_f32_16x16x32_bf16 v[40:43], a[24:27], v[96:99], v[40:43]
    ds_read_b128 v[92:95], v1 offset:35840
    v_cndmask_b32 v254, 0, v11, s[50:51]
    v_mfma_f32_16x16x32_bf16 v[56:59], a[28:31], v[96:99], v[56:59]
    s_mov_b32 exec_lo, 0xffff0000
    s_mov_b32 exec_hi, 0xffff0000
    buffer_store_dwordx4 v[64:67], v5, s[16:19], s42 offen offset:0 sc1
    s_mov_b64 exec, -1
    v_mfma_f32_16x16x32_bf16 v[80:83], v[96:99], a[32:35], v[80:83]
    s_waitcnt lgkmcnt(3)
    v_cndmask_b32 v255, 0, v11, s[52:53]
    v_mfma_f32_16x16x32_bf16 v[44:47], a[24:27], v[100:103], v[44:47]
    ds_read_b128 v[96:99], v1 offset:52224
    v_mfma_f32_16x16x32_bf16 v[60:63], a[28:31], v[100:103], v[60:63]
    s_mov_b32 exec_lo, 0xffff0000
    s_mov_b32 exec_hi, 0xffff0000
    buffer_store_dwordx4 v[68:71], v5, s[16:19], s42 offen offset:512 sc1
    s_mov_b64 exec, -1
    v_mfma_f32_16x16x32_bf16 v[84:87], v[100:103], a[32:35], v[84:87]
    s_waitcnt lgkmcnt(3)
    v_mfma_f32_16x16x32_bf16 v[32:35], a[36:39], v[104:107], v[32:35]
    s_waitcnt vmcnt(4)
    s_barrier
    ds_read_b128 v[100:103], v1 offset:4096
    v_mfma_f32_16x16x32_bf16 v[48:51], a[40:43], v[104:107], v[48:51]
    s_mov_b32 exec_lo, 0xffff0000
    s_mov_b32 exec_hi, 0xffff0000
    buffer_store_dword v14, v7, s[16:19], s96 offen offset:2048 sc1
    s_mov_b64 exec, -1
    v_mfma_f32_16x16x32_bf16 v[72:75], v[104:107], a[44:47], v[72:75]
    s_waitcnt lgkmcnt(3)
    v_mfma_f32_16x16x32_bf16 v[36:39], a[36:39], v[88:91], v[36:39]
    ds_read_b128 v[104:107], v1 offset:20480
    v_mfma_f32_16x16x32_bf16 v[52:55], a[40:43], v[88:91], v[52:55]
    buffer_load_dwordx4 v1, s[16:19], s57 offen offset:1024 sc1 lds
    v_mfma_f32_16x16x32_bf16 v[76:79], v[88:91], a[44:47], v[76:79]
    s_waitcnt lgkmcnt(3)
    v_mfma_f32_16x16x32_bf16 v[40:43], a[36:39], v[92:95], v[40:43]
    ds_read_b128 v[88:91], v1 offset:36864
    v_mfma_f32_16x16x32_bf16 v[56:59], a[40:43], v[92:95], v[56:59]
    s_bfe_u32 s3, s56, 196624
    s_lshl_b32 s3, s3, 11
    s_add_u32 m0, s44, 8192
    s_add_u32 s57, s3, s58
    buffer_load_dwordx4 v1, s[16:19], s57 offen offset:0 sc1 lds
    v_mfma_f32_16x16x32_bf16 v[80:83], v[92:95], a[44:47], v[80:83]
    s_waitcnt lgkmcnt(3)
    v_mfma_f32_16x16x32_bf16 v[44:47], a[36:39], v[96:99], v[44:47]
    ds_read_b128 v[92:95], v1 offset:53248
    v_mfma_f32_16x16x32_bf16 v[60:63], a[40:43], v[96:99], v[60:63]
    v_mfma_f32_16x16x32_bf16 v[84:87], v[96:99], a[44:47], v[84:87]
    s_waitcnt lgkmcnt(3)
    v_mfma_f32_16x16x32_bf16 v[32:35], a[48:51], v[100:103], v[32:35]
    s_waitcnt vmcnt(5)
    s_barrier
    ds_read_b128 v[96:99], v1 offset:5120
    v_mfma_f32_16x16x32_bf16 v[48:51], a[52:55], v[100:103], v[48:51]
    buffer_load_dwordx4 v1, s[16:19], s57 offen offset:1024 sc1 lds
    v_mfma_f32_16x16x32_bf16 v[72:75], v[100:103], a[56:59], v[72:75]
    s_waitcnt lgkmcnt(3)
    v_mfma_f32_16x16x32_bf16 v[36:39], a[48:51], v[104:107], v[36:39]
    ds_read_b128 v[100:103], v1 offset:21504
    v_mfma_f32_16x16x32_bf16 v[52:55], a[52:55], v[104:107], v[52:55]
    s_bfe_u32 s3, s56, 196628
    s_lshl_b32 s3, s3, 11
    s_add_u32 m0, s44, 10240
    s_add_u32 s57, s3, s58
    buffer_load_dwordx4 v1, s[16:19], s57 offen offset:0 sc1 lds
    v_mfma_f32_16x16x32_bf16 v[76:79], v[104:107], a[56:59], v[76:79]
    s_waitcnt lgkmcnt(3)
    v_mfma_f32_16x16x32_bf16 v[40:43], a[48:51], v[88:91], v[40:43]
    ds_read_b128 v[104:107], v1 offset:37888
    v_mfma_f32_16x16x32_bf16 v[56:59], a[52:55], v[88:91], v[56:59]
    buffer_load_dwordx4 v1, s[16:19], s57 offen offset:1024 sc1 lds
    v_mfma_f32_16x16x32_bf16 v[80:83], v[88:91], a[56:59], v[80:83]
    s_waitcnt lgkmcnt(3)
    v_mfma_f32_16x16x32_bf16 v[44:47], a[48:51], v[92:95], v[44:47]
    ds_read_b128 v[88:91], v1 offset:54272
    v_mfma_f32_16x16x32_bf16 v[60:63], a[52:55], v[92:95], v[60:63]
    v_mfma_f32_16x16x32_bf16 v[84:87], v[92:95], a[56:59], v[84:87]
    s_waitcnt lgkmcnt(3)
    v_mfma_f32_16x16x32_bf16 v[32:35], a[60:63], v[96:99], v[32:35]
    ds_read_b128 v[92:95], v1 offset:6144
    v_mfma_f32_16x16x32_bf16 v[48:51], a[64:67], v[96:99], v[48:51]
    s_bfe_u32 s3, s56, 196632
    s_lshl_b32 s3, s3, 11
    s_add_u32 m0, s44, 12288
    s_add_u32 s57, s3, s58
    buffer_load_dwordx4 v1, s[16:19], s57 offen offset:0 sc1 lds
    v_mfma_f32_16x16x32_bf16 v[72:75], v[96:99], a[68:71], v[72:75]
    s_waitcnt lgkmcnt(3)
    v_mfma_f32_16x16x32_bf16 v[36:39], a[60:63], v[100:103], v[36:39]
    ds_read_b128 v[96:99], v1 offset:22528
    v_mfma_f32_16x16x32_bf16 v[52:55], a[64:67], v[100:103], v[52:55]
    buffer_load_dwordx4 v1, s[16:19], s57 offen offset:1024 sc1 lds
    v_mfma_f32_16x16x32_bf16 v[76:79], v[100:103], a[68:71], v[76:79]
    s_waitcnt lgkmcnt(3)
    v_mfma_f32_16x16x32_bf16 v[40:43], a[60:63], v[104:107], v[40:43]
    ds_read_b128 v[100:103], v1 offset:38912
    v_mfma_f32_16x16x32_bf16 v[56:59], a[64:67], v[104:107], v[56:59]
    s_bfe_u32 s3, s56, 196636
    s_lshl_b32 s3, s3, 11
    s_add_u32 m0, s44, 14336
    s_add_u32 s57, s3, s58
    buffer_load_dwordx4 v1, s[16:19], s57 offen offset:0 sc1 lds
    v_mfma_f32_16x16x32_bf16 v[80:83], v[104:107], a[68:71], v[80:83]
    s_waitcnt lgkmcnt(3)
    v_mfma_f32_16x16x32_bf16 v[44:47], a[60:63], v[88:91], v[44:47]
    ds_read_b128 v[104:107], v1 offset:55296
    v_mfma_f32_16x16x32_bf16 v[60:63], a[64:67], v[88:91], v[60:63]
    v_mfma_f32_16x16x32_bf16 v[84:87], v[88:91], a[68:71], v[84:87]
    s_waitcnt lgkmcnt(3)
    v_mfma_f32_16x16x32_bf16 v[32:35], a[72:75], v[92:95], v[32:35]
    s_waitcnt vmcnt(4)
    s_barrier
    ds_read_b128 v[88:91], v1 offset:7168
    v_mfma_f32_16x16x32_bf16 v[48:51], a[76:79], v[92:95], v[48:51]
    buffer_load_dwordx4 v1, s[16:19], s57 offen offset:1024 sc1 lds
    v_mfma_f32_16x16x32_bf16 v[72:75], v[92:95], a[80:83], v[72:75]
    s_waitcnt lgkmcnt(3)
    v_mfma_f32_16x16x32_bf16 v[36:39], a[72:75], v[96:99], v[36:39]
    ds_read_b128 v[92:95], v1 offset:23552
    v_mfma_f32_16x16x32_bf16 v[52:55], a[76:79], v[96:99], v[52:55]
    buffer_load_dwordx4 v[108:111], v8, s[16:19], s37 offen offset:0 sc1
    v_mfma_f32_16x16x32_bf16 v[76:79], v[96:99], a[80:83], v[76:79]
    s_waitcnt lgkmcnt(3)
    v_mfma_f32_16x16x32_bf16 v[40:43], a[72:75], v[100:103], v[40:43]
    ds_read_b128 v[96:99], v1 offset:39936
    v_mfma_f32_16x16x32_bf16 v[56:59], a[76:79], v[100:103], v[56:59]
    buffer_load_dwordx4 v[112:115], v8, s[16:19], s37 offen offset:1024 sc1
    v_mfma_f32_16x16x32_bf16 v[80:83], v[100:103], a[80:83], v[80:83]
    s_waitcnt lgkmcnt(3)
    v_mfma_f32_16x16x32_bf16 v[44:47], a[72:75], v[104:107], v[44:47]
    ds_read_b128 v[100:103], v1 offset:56320
    v_mfma_f32_16x16x32_bf16 v[60:63], a[76:79], v[104:107], v[60:63]
    buffer_load_dwordx4 v[16:19], v1, s[16:19], s97 offen offset:0 sc1
    v_mfma_f32_16x16x32_bf16 v[84:87], v[104:107], a[80:83], v[84:87]
    s_waitcnt lgkmcnt(3)
    v_mfma_f32_16x16x32_bf16 v[32:35], a[84:87], v[88:91], v[32:35]
    ds_read_b128 v[104:107], v1 offset:8192
    v_mfma_f32_16x16x32_bf16 v[48:51], a[88:91], v[88:91], v[48:51]
    buffer_load_dwordx4 v[20:23], v1, s[16:19], s97 offen offset:1024 sc1
    v_mfma_f32_16x16x32_bf16 v[72:75], v[88:91], a[92:95], v[72:75]
    s_waitcnt lgkmcnt(3)
    v_mfma_f32_16x16x32_bf16 v[36:39], a[84:87], v[92:95], v[36:39]
    ds_read_b128 v[88:91], v1 offset:24576
    v_mfma_f32_16x16x32_bf16 v[52:55], a[88:91], v[92:95], v[52:55]
    buffer_load_dwordx4 v[24:27], v1, s[16:19], s98 offen offset:0 sc1
    v_mfma_f32_16x16x32_bf16 v[76:79], v[92:95], a[92:95], v[76:79]
    s_waitcnt lgkmcnt(3)
    v_mfma_f32_16x16x32_bf16 v[40:43], a[84:87], v[96:99], v[40:43]
    ds_read_b128 v[92:95], v1 offset:40960
    v_mfma_f32_16x16x32_bf16 v[56:59], a[88:91], v[96:99], v[56:59]
    buffer_load_dwordx4 v[28:31], v1, s[16:19], s98 offen offset:1024 sc1
    v_mfma_f32_16x16x32_bf16 v[80:83], v[96:99], a[92:95], v[80:83]
    s_waitcnt lgkmcnt(3)
    v_mfma_f32_16x16x32_bf16 v[44:47], a[84:87], v[100:103], v[44:47]
    ds_read_b128 v[96:99], v1 offset:57344
    v_mfma_f32_16x16x32_bf16 v[60:63], a[88:91], v[100:103], v[60:63]
    buffer_load_dwordx4 v[116:119], v124, s[16:19], s38 offen offset:2048 sc1
    v_mfma_f32_16x16x32_bf16 v[84:87], v[100:103], a[92:95], v[84:87]
    s_waitcnt lgkmcnt(3)
    v_mfma_f32_16x16x32_bf16 v[32:35], a[96:99], v[104:107], v[32:35]
    ds_read_b128 v[100:103], v1 offset:9216
    v_mfma_f32_16x16x32_bf16 v[48:51], a[100:103], v[104:107], v[48:51]
    buffer_load_dwordx4 v[120:123], v124, s[16:19], s38 offen offset:2304 sc1
    v_mfma_f32_16x16x32_bf16 v[72:75], v[104:107], a[104:107], v[72:75]
    s_waitcnt lgkmcnt(3)
    v_mfma_f32_16x16x32_bf16 v[36:39], a[96:99], v[88:91], v[36:39]
    ds_read_b128 v[104:107], v1 offset:25600
    v_mfma_f32_16x16x32_bf16 v[52:55], a[100:103], v[88:91], v[52:55]
    v_mfma_f32_16x16x32_bf16 v[76:79], v[88:91], a[104:107], v[76:79]
    s_waitcnt lgkmcnt(3)
    v_mfma_f32_16x16x32_bf16 v[40:43], a[96:99], v[92:95], v[40:43]
    ds_read_b128 v[88:91], v1 offset:41984
    v_mfma_f32_16x16x32_bf16 v[56:59], a[100:103], v[92:95], v[56:59]
    s_bfe_u32 s55, s56, 196608
    v_lshl_add_u32 v4, s55, 11, v1
    buffer_load_dwordx4 a[0:3], v4, s[20:23], s30 offen offset:0
    v_mfma_f32_16x16x32_bf16 v[80:83], v[92:95], a[104:107], v[80:83]
    s_waitcnt lgkmcnt(3)
    v_mfma_f32_16x16x32_bf16 v[44:47], a[96:99], v[96:99], v[44:47]
    ds_read_b128 v[92:95], v1 offset:58368
    v_mfma_f32_16x16x32_bf16 v[60:63], a[100:103], v[96:99], v[60:63]
    v_mfma_f32_16x16x32_bf16 v[84:87], v[96:99], a[104:107], v[84:87]
    s_waitcnt lgkmcnt(3)
    v_mfma_f32_16x16x32_bf16 v[32:35], a[108:111], v[100:103], v[32:35]
    ds_read_b128 v[96:99], v1 offset:10240
    v_mfma_f32_16x16x32_bf16 v[48:51], a[112:115], v[100:103], v[48:51]
    buffer_load_dwordx4 a[12:15], v4, s[20:23], s31 offen offset:0
    v_mfma_f32_16x16x32_bf16 v[72:75], v[100:103], a[116:119], v[72:75]
    s_waitcnt lgkmcnt(3)
    v_mfma_f32_16x16x32_bf16 v[36:39], a[108:111], v[104:107], v[36:39]
    ds_read_b128 v[100:103], v1 offset:26624
    v_mfma_f32_16x16x32_bf16 v[52:55], a[112:115], v[104:107], v[52:55]
    v_mfma_f32_16x16x32_bf16 v[76:79], v[104:107], a[116:119], v[76:79]
    s_waitcnt lgkmcnt(3)
    v_mfma_f32_16x16x32_bf16 v[40:43], a[108:111], v[88:91], v[40:43]
    ds_read_b128 v[104:107], v1 offset:43008
    v_mfma_f32_16x16x32_bf16 v[56:59], a[112:115], v[88:91], v[56:59]
    buffer_load_dwordx4 a[24:27], v4, s[20:23], s32 offen offset:0
    v_mfma_f32_16x16x32_bf16 v[80:83], v[88:91], a[116:119], v[80:83]
    s_waitcnt lgkmcnt(3)
    v_mfma_f32_16x16x32_bf16 v[44:47], a[108:111], v[92:95], v[44:47]
    ds_read_b128 v[88:91], v1 offset:59392
    v_mfma_f32_16x16x32_bf16 v[60:63], a[112:115], v[92:95], v[60:63]
    v_mfma_f32_16x16x32_bf16 v[84:87], v[92:95], a[116:119], v[84:87]
    s_waitcnt lgkmcnt(3)
    v_mfma_f32_16x16x32_bf16 v[32:35], a[120:123], v[96:99], v[32:35]
    s_waitcnt vmcnt(11)
    s_barrier
    ds_read_b128 v[92:95], v1 offset:11264
    v_mfma_f32_16x16x32_bf16 v[48:51], a[124:127], v[96:99], v[48:51]
    buffer_load_dwordx4 a[36:39], v4, s[20:23], s30 offen offset:1024
    v_mfma_f32_16x16x32_bf16 v[72:75], v[96:99], a[128:131], v[72:75]
    s_waitcnt lgkmcnt(3)
    v_mfma_f32_16x16x32_bf16 v[36:39], a[120:123], v[100:103], v[36:39]
    ds_read_b128 v[96:99], v1 offset:27648
    v_mfma_f32_16x16x32_bf16 v[52:55], a[124:127], v[100:103], v[52:55]
    v_mfma_f32_16x16x32_bf16 v[76:79], v[100:103], a[128:131], v[76:79]
    s_waitcnt lgkmcnt(3)
    v_mfma_f32_16x16x32_bf16 v[40:43], a[120:123], v[104:107], v[40:43]
    ds_read_b128 v[100:103], v1 offset:44032
    v_mfma_f32_16x16x32_bf16 v[56:59], a[124:127], v[104:107], v[56:59]
    buffer_load_dwordx4 a[48:51], v4, s[20:23], s31 offen offset:1024
    v_mfma_f32_16x16x32_bf16 v[80:83], v[104:107], a[128:131], v[80:83]
    s_waitcnt lgkmcnt(3)
    v_mfma_f32_16x16x32_bf16 v[44:47], a[120:123], v[88:91], v[44:47]
    ds_read_b128 v[104:107], v1 offset:60416
    v_mfma_f32_16x16x32_bf16 v[60:63], a[124:127], v[88:91], v[60:63]
    v_mfma_f32_16x16x32_bf16 v[84:87], v[88:91], a[128:131], v[84:87]
    s_waitcnt lgkmcnt(3)
    v_mfma_f32_16x16x32_bf16 v[32:35], a[132:135], v[92:95], v[32:35]
    ds_read_b128 v[88:91], v1 offset:12288
    v_mfma_f32_16x16x32_bf16 v[48:51], a[136:139], v[92:95], v[48:51]
    buffer_load_dwordx4 a[60:63], v4, s[20:23], s32 offen offset:1024
    v_mfma_f32_16x16x32_bf16 v[72:75], v[92:95], a[140:143], v[72:75]
    s_waitcnt lgkmcnt(3)
    v_mfma_f32_16x16x32_bf16 v[36:39], a[132:135], v[96:99], v[36:39]
    ds_read_b128 v[92:95], v1 offset:28672
    v_mfma_f32_16x16x32_bf16 v[52:55], a[136:139], v[96:99], v[52:55]
    v_mfma_f32_16x16x32_bf16 v[76:79], v[96:99], a[140:143], v[76:79]
    s_waitcnt lgkmcnt(3)
    v_mfma_f32_16x16x32_bf16 v[40:43], a[132:135], v[100:103], v[40:43]
    ds_read_b128 v[96:99], v1 offset:45056
    v_mfma_f32_16x16x32_bf16 v[56:59], a[136:139], v[100:103], v[56:59]
    s_bfe_u32 s55, s56, 196612
    v_lshl_add_u32 v4, s55, 11, v1
    buffer_load_dwordx4 a[72:75], v4, s[20:23], s30 offen offset:0
    v_mfma_f32_16x16x32_bf16 v[80:83], v[100:103], a[140:143], v[80:83]
    s_waitcnt lgkmcnt(3)
    v_mfma_f32_16x16x32_bf16 v[44:47], a[132:135], v[104:107], v[44:47]
    ds_read_b128 v[100:103], v1 offset:61440
    v_mfma_f32_16x16x32_bf16 v[60:63], a[136:139], v[104:107], v[60:63]
    v_mfma_f32_16x16x32_bf16 v[84:87], v[104:107], a[140:143], v[84:87]
    s_waitcnt lgkmcnt(3)
    v_mfma_f32_16x16x32_bf16 v[32:35], a[144:147], v[88:91], v[32:35]
    ds_read_b128 v[104:107], v1 offset:13312
    v_mfma_f32_16x16x32_bf16 v[48:51], a[148:151], v[88:91], v[48:51]
    buffer_load_dwordx4 a[84:87], v4, s[20:23], s31 offen offset:0
    v_mfma_f32_16x16x32_bf16 v[72:75], v[88:91], a[152:155], v[72:75]
    s_waitcnt lgkmcnt(3)
    s_waitcnt vmcnt(8)
    v_max3_u32 v11, v16, v17, v18
    v_mfma_f32_16x16x32_bf16 v[36:39], a[144:147], v[92:95], v[36:39]
    ds_read_b128 v[88:91], v1 offset:29696
    v_max3_u32 v11, v11, v19, v20
    v_mfma_f32_16x16x32_bf16 v[52:55], a[148:151], v[92:95], v[52:55]
    v_max3_u32 v11, v11, v21, v22
    v_max3_u32 v11, v11, v23, v24
    v_mfma_f32_16x16x32_bf16 v[76:79], v[92:95], a[152:155], v[76:79]
    s_waitcnt lgkmcnt(3)
    v_max3_u32 v11, v11, v25, v26
    v_max3_u32 v11, v11, v27, v28
    v_mfma_f32_16x16x32_bf16 v[40:43], a[144:147], v[96:99], v[40:43]
    ds_read_b128 v[92:95], v1 offset:46080
    v_max3_u32 v11, v11, v29, v30
    v_mfma_f32_16x16x32_bf16 v[56:59], a[148:151], v[96:99], v[56:59]
    buffer_load_dwordx4 a[96:99], v4, s[20:23], s32 offen offset:0
    v_mfma_f32_16x16x32_bf16 v[80:83], v[96:99], a[152:155], v[80:83]
    s_waitcnt lgkmcnt(3)
    v_max3_u32 v11, v11, v31, v116
    v_max3_u32 v11, v11, v117, v118
    v_mfma_f32_16x16x32_bf16 v[44:47], a[144:147], v[100:103], v[44:47]
    ds_read_b128 v[96:99], v1 offset:62464
    v_max3_u32 v11, v11, v119, v120
    v_mfma_f32_16x16x32_bf16 v[60:63], a[148:151], v[100:103], v[60:63]
    v_max3_u32 v11, v11, v121, v122
    v_max_u32 v11, v11, v123
    v_mfma_f32_16x16x32_bf16 v[84:87], v[100:103], a[152:155], v[84:87]
    s_waitcnt lgkmcnt(3)
    v_lshl_add_u32 v13, s6, 12, v2
    v_mfma_f32_16x16x32_bf16 v[32:35], a[156:159], v[104:107], v[32:35]
    ds_read_b128 v[100:103], v1 offset:14336
    v_mfma_f32_16x16x32_bf16 v[48:51], a[160:163], v[104:107], v[48:51]
    buffer_load_dwordx4 a[108:111], v4, s[20:23], s30 offen offset:1024
    v_mfma_f32_16x16x32_bf16 v[72:75], v[104:107], a[164:167], v[72:75]
    s_waitcnt lgkmcnt(3)
    v_cmp_eq_u32 vcc, -1, v11
    s_cbranch_vccnz LS_retry_15
LS_got_16:
    v_mfma_f32_16x16x32_bf16 v[36:39], a[156:159], v[88:91], v[36:39]
    ds_read_b128 v[104:107], v1 offset:30720
    v_mfma_f32_16x16x32_bf16 v[52:55], a[160:163], v[88:91], v[52:55]
    ds_write_b128 v13, v[16:19] offset:0
    v_mfma_f32_16x16x32_bf16 v[76:79], v[88:91], a[164:167], v[76:79]
    s_waitcnt lgkmcnt(4)
    v_add_f32 v108, v108, v110
    v_add_f32 v109, v109, v111
    v_mfma_f32_16x16x32_bf16 v[40:43], a[156:159], v[92:95], v[40:43]
    ds_read_b128 v[88:91], v1 offset:47104
    v_mfma_f32_16x16x32_bf16 v[56:59], a[160:163], v[92:95], v[56:59]
    buffer_load_dwordx4 a[120:123], v4, s[20:23], s31 offen offset:1024
    v_mfma_f32_16x16x32_bf16 v[80:83], v[92:95], a[164:167], v[80:83]
    s_waitcnt lgkmcnt(4)
    ds_write_b128 v13, v[20:23] offset:1024
    v_mfma_f32_16x16x32_bf16 v[44:47], a[156:159], v[96:99], v[44:47]
    ds_read_b128 v[92:95], v1 offset:63488
    v_add_f32 v112, v112, v114
    v_mfma_f32_16x16x32_bf16 v[60:63], a[160:163], v[96:99], v[60:63]
    v_add_f32 v113, v113, v115
    v_mfma_f32_16x16x32_bf16 v[84:87], v[96:99], a[164:167], v[84:87]
    s_waitcnt lgkmcnt(5)
    ds_write_b128 v13, v[24:27] offset:2048
    v_mfma_f32_16x16x32_bf16 v[32:35], a[168:171], v[100:103], v[32:35]
    ds_read_b128 v[96:99], v1 offset:15360
    v_add_f32 v108, v108, v112
    v_mfma_f32_16x16x32_bf16 v[48:51], a[172:175], v[100:103], v[48:51]
    buffer_load_dwordx4 a[132:135], v4, s[20:23], s32 offen offset:1024
    v_mfma_f32_16x16x32_bf16 v[72:75], v[100:103], a[176:179], v[72:75]
    s_waitcnt lgkmcnt(6)
    v_add_f32 v109, v109, v113
    v_mfma_f32_16x16x32_bf16 v[36:39], a[168:171], v[104:107], v[36:39]
    ds_read_b128 v[100:103], v1 offset:31744
    v_mfma_f32_16x16x32_bf16 v[52:55], a[172:175], v[104:107], v[52:55]
    ds_write_b128 v13, v[28:31] offset:3072
    v_mfma_f32_16x16x32_bf16 v[76:79], v[104:107], a[176:179], v[76:79]
    s_waitcnt lgkmcnt(6)
    v_add_f32 v116, v116, v118
    v_add_f32 v117, v117, v119
    v_mfma_f32_16x16x32_bf16 v[40:43], a[168:171], v[88:91], v[40:43]
    ds_read_b128 v[104:107], v1 offset:48128
    v_add_f32 v120, v120, v122
    v_mfma_f32_16x16x32_bf16 v[56:59], a[172:175], v[88:91], v[56:59]
    s_bfe_u32 s55, s56, 196616
    v_lshl_add_u32 v4, s55, 11, v1
    buffer_load_dwordx4 a[144:147], v4, s[20:23], s30 offen offset:0
    v_mfma_f32_16x16x32_bf16 v[80:83], v[88:91], a[176:179], v[80:83]
    s_waitcnt lgkmcnt(5)
    v_add_f32 v121, v121, v123
    v_add_f32 v116, v116, v120
    v_mfma_f32_16x16x32_bf16 v[44:47], a[168:171], v[92:95], v[44:47]
    ds_read_b128 v[88:91], v1 offset:64512
    v_add_f32 v117, v117, v121
    v_mfma_f32_16x16x32_bf16 v[60:63], a[172:175], v[92:95], v[60:63]
    v_lshl_add_u32 v110, s6, 7, v9
    v_add_u32 v111, 512, v9
    v_mfma_f32_16x16x32_bf16 v[84:87], v[92:95], a[176:179], v[84:87]
    s_waitcnt lgkmcnt(4)
    v_permlane32_swap_b32 v108, v116
    v_mfma_f32_16x16x32_bf16 v[32:35], a[180:183], v[96:99], v[32:35]
    s_waitcnt lgkmcnt(2)
    s_barrier
    ds_read_b128 v[92:95], v2 offset:0
    v_mfma_f32_16x16x32_bf16 v[48:51], a[184:187], v[96:99], v[48:51]
    buffer_load_dwordx4 a[156:159], v4, s[20:23], s31 offen offset:0
    v_mfma_f32_16x16x32_bf16 v[72:75], v[96:99], a[188:191], v[72:75]
    v_permlane32_swap_b32 v109, v117
    v_mfma_f32_16x16x32_bf16 v[36:39], a[180:183], v[100:103], v[36:39]
    ds_read_b128 v[96:99], v2 offset:1024
    v_add_f32 v112, v108, v116
    v_mfma_f32_16x16x32_bf16 v[52:55], a[184:187], v[100:103], v[52:55]
    v_add_f32 v113, v109, v117
    v_mfma_f32_16x16x32_bf16 v[76:79], v[100:103], a[188:191], v[76:79]
    s_waitcnt lgkmcnt(3)
    v_permlane32_swap_b32 v110, v111
    v_mfma_f32_16x16x32_bf16 v[40:43], a[180:183], v[104:107], v[40:43]
    ds_read_b128 v[100:103], v2 offset:2048
    v_mfma_f32_16x16x32_bf16 v[56:59], a[184:187], v[104:107], v[56:59]
    buffer_load_dwordx4 a[168:171], v4, s[20:23], s32 offen offset:0
    v_mfma_f32_16x16x32_bf16 v[80:83], v[104:107], a[188:191], v[80:83]
    s_waitcnt lgkmcnt(3)
    v_permlane16_swap_b32 v112, v113
    v_mfma_f32_16x16x32_bf16 v[44:47], a[180:183], v[88:91], v[44:47]
    ds_read_b128 v[104:107], v2 offset:3072
    v_add_f32 v108, v112, v113
    v_mfma_f32_16x16x32_bf16 v[60:63], a[184:187], v[88:91], v[60:63]
    v_add_f32 v109, v112, v113
    v_lshrrev_b32 v111, 1, v110
    v_mfma_f32_16x16x32_bf16 v[84:87], v[88:91], a[188:191], v[84:87]
    s_waitcnt lgkmcnt(3)
    v_add_u32 v111, 80896, v111
    v_mfma_f32_16x16x32_bf16 v[64:67], a[4:7], v[92:95], 0
    ds_read_b128 v[88:91], v2 offset:4096
    v_mfma_f32_16x16x32_bf16 v[68:71], v[92:95], a[8:11], 0
    s_waitcnt lgkmcnt(3)
    v_permlane16_swap_b32 v108, v109
    v_mfma_f32_16x16x32_bf16 v[64:67], a[16:19], v[96:99], v[64:67]
    ds_read_b128 v[92:95], v2 offset:5120
    v_mul_f32 v108, 0xbb000000, v108
    v_mfma_f32_16x16x32_bf16 v[68:71], v[96:99], a[20:23], v[68:71]
    s_waitcnt lgkmcnt(3)
    buffer_load_dwordx4 a[180:183], v4, s[20:23], s30 offen offset:1024
    v_mfma_f32_16x16x32_bf16 v[64:67], a[28:31], v[100:103], v[64:67]
    ds_read_b128 v[96:99], v2 offset:6144
    v_mul_f32 v109, 0x3b000000, v109
    v_mfma_f32_16x16x32_bf16 v[68:71], v[100:103], a[32:35], v[68:71]
    s_waitcnt lgkmcnt(3)
    v_fma_f32 v109, -v108, v108, v109
    v_max_f32 v109, 0, v109
    v_mfma_f32_16x16x32_bf16 v[64:67], a[40:43], v[104:107], v[64:67]
    ds_read_b128 v[100:103], v2 offset:7168
    v_add_f32 v109, 0x3727c5ac, v109
    v_mfma_f32_16x16x32_bf16 v[68:71], v[104:107], a[44:47], v[68:71]
    s_waitcnt lgkmcnt(3)
    buffer_load_dwordx4 a[4:7], v4, s[20:23], s31 offen offset:1024
    v_mfma_f32_16x16x32_bf16 v[64:67], a[52:55], v[88:91], v[64:67]
    ds_read_b128 v[104:107], v2 offset:8192
    v_mfma_f32_16x16x32_bf16 v[68:71], v[88:91], a[56:59], v[68:71]
    s_waitcnt lgkmcnt(3)
    v_rsq_f32 v109, v109
    v_mfma_f32_16x16x32_bf16 v[64:67], a[64:67], v[92:95], v[64:67]
    ds_read_b128 v[88:91], v2 offset:9216
    v_mfma_f32_16x16x32_bf16 v[68:71], v[92:95], a[68:71], v[68:71]
    s_waitcnt lgkmcnt(3)
    buffer_load_dwordx4 a[8:11], v4, s[20:23], s32 offen offset:1024
    v_mfma_f32_16x16x32_bf16 v[64:67], a[76:79], v[96:99], v[64:67]
    ds_read_b128 v[92:95], v2 offset:10240
    v_mfma_f32_16x16x32_bf16 v[68:71], v[96:99], a[80:83], v[68:71]
    s_waitcnt lgkmcnt(3)
    ds_write_b64 v110, v[108:109]
    v_mfma_f32_16x16x32_bf16 v[64:67], a[88:91], v[100:103], v[64:67]
    ds_read_b128 v[96:99], v2 offset:11264
    v_mfma_f32_16x16x32_bf16 v[68:71], v[100:103], a[92:95], v[68:71]
    s_waitcnt lgkmcnt(4)
    s_bfe_u32 s55, s56, 196620
    v_lshl_add_u32 v4, s55, 11, v1
    buffer_load_dwordx4 a[16:19], v4, s[20:23], s30 offen offset:0
    v_mfma_f32_16x16x32_bf16 v[64:67], a[100:103], v[104:107], v[64:67]
    ds_read_b128 v[100:103], v2 offset:12288
    v_mfma_f32_16x16x32_bf16 v[68:71], v[104:107], a[104:107], v[68:71]
    s_waitcnt lgkmcnt(4)
    ds_write2_b32 v111, v108, v109 offset0:0 offset1:128
    v_mfma_f32_16x16x32_bf16 v[64:67], a[112:115], v[88:91], v[64:67]
    ds_read_b128 v[104:107], v2 offset:13312
    v_mfma_f32_16x16x32_bf16 v[68:71], v[88:91], a[116:119], v[68:71]
    s_waitcnt lgkmcnt(5)
    buffer_load_dwordx4 a[20:23], v4, s[20:23], s31 offen offset:0
    v_mfma_f32_16x16x32_bf16 v[64:67], a[124:127], v[92:95], v[64:67]
    ds_read_b128 v[88:91], v2 offset:14336
    v_mfma_f32_16x16x32_bf16 v[68:71], v[92:95], a[128:131], v[68:71]
    s_waitcnt lgkmcnt(4)
    s_waitcnt lgkmcnt(0)
    s_barrier
    v_mfma_f32_16x16x32_bf16 v[64:67], a[136:139], v[96:99], v[64:67]
    ds_read_b128 v[92:95], v2 offset:15360
    v_mfma_f32_16x16x32_bf16 v[68:71], v[96:99], a[140:143], v[68:71]
    buffer_load_dwordx4 a[28:31], v4, s[20:23], s32 offen offset:0
    v_mfma_f32_16x16x32_bf16 v[64:67], a[148:151], v[100:103], v[64:67]
    ds_read_b128 v[108:111], v10 offset:256
    v_mfma_f32_16x16x32_bf16 v[68:71], v[100:103], a[152:155], v[68:71]
    ds_read_b128 v[112:115], v10 offset:768
    v_mfma_f32_16x16x32_bf16 v[64:67], a[160:163], v[104:107], v[64:67]
    ds_read_b128 v[116:119], v10 offset:0
    v_mfma_f32_16x16x32_bf16 v[68:71], v[104:107], a[164:167], v[68:71]
    buffer_load_dwordx4 a[32:35], v4, s[20:23], s30 offen offset:1024
    v_mfma_f32_16x16x32_bf16 v[64:67], a[172:175], v[88:91], v[64:67]
    ds_read_b128 v[120:123], v10 offset:512
    v_mfma_f32_16x16x32_bf16 v[68:71], v[88:91], a[176:179], v[68:71]
    s_waitcnt lgkmcnt(4)
    ds_read_b128 v[124:127], v10 offset:704
    v_mfma_f32_16x16x32_bf16 v[64:67], a[184:187], v[92:95], v[64:67]
    ds_read_b64 v[16:17], v9 offset:0
    v_mfma_f32_16x16x32_bf16 v[68:71], v[92:95], a[188:191], v[68:71]
    buffer_load_dwordx4 a[40:43], v4, s[20:23], s31 offen offset:1024
    ds_read_b64 v[18:19], v9 offset:128
    ds_read_b64 v[20:21], v9 offset:256
    ds_read_b64 v[22:23], v9 offset:384
    ds_read_b64 v[24:25], v9 offset:512
    ds_read_b128 v[88:91], v10 offset:64
    ds_read_b128 v[92:95], v10 offset:576
    ds_read_b128 v[96:99], v10 offset:128
    ds_read_b128 v[100:103], v10 offset:640
    ds_read_b128 v[104:107], v10 offset:192
    s_lshl2_add_u32 s3, s5, s6
    s_lshl_b32 s3, s3, 10
    s_add_u32 s3, s3, s35
    s_lshl_b32 s58, s25, 15
    s_xor_b32 s57, s58, 0x8000
    s_add_u32 s57, s57, s3
    s_add_u32 s58, s58, s3
    s_waitcnt lgkmcnt(5)
    v_pk_fma_f32 v[32:33], v[236:237], v[16:17], v[32:33] op_sel:[0,0,0] op_sel_hi:[1,0,1]
    v_pk_fma_f32 v[34:35], v[238:239], v[16:17], v[34:35] op_sel:[0,0,0] op_sel_hi:[1,0,1]
    v_cvt_pk_bf16_f32 v32, v32, v33
    v_cvt_pk_bf16_f32 v33, v34, v35
    v_pk_fma_f32 v[36:37], v[236:237], v[18:19], v[36:37] op_sel:[0,0,0] op_sel_hi:[1,0,1]
    v_pk_fma_f32 v[38:39], v[238:239], v[18:19], v[38:39] op_sel:[0,0,0] op_sel_hi:[1,0,1]
    v_cvt_pk_bf16_f32 v36, v36, v37
    v_cvt_pk_bf16_f32 v37, v38, v39
    v_pk_fma_f32 v[40:41], v[236:237], v[20:21], v[40:41] op_sel:[0,0,0] op_sel_hi:[1,0,1]
    v_pk_fma_f32 v[42:43], v[238:239], v[20:21], v[42:43] op_sel:[0,0,0] op_sel_hi:[1,0,1]
    v_cvt_pk_bf16_f32 v40, v40, v41
    v_cvt_pk_bf16_f32 v41, v42, v43
    v_pk_fma_f32 v[44:45], v[236:237], v[22:23], v[44:45] op_sel:[0,0,0] op_sel_hi:[1,0,1]
    v_pk_fma_f32 v[46:47], v[238:239], v[22:23], v[46:47] op_sel:[0,0,0] op_sel_hi:[1,0,1]
    v_cvt_pk_bf16_f32 v44, v44, v45
    v_cvt_pk_bf16_f32 v45, v46, v47
    v_pk_fma_f32 v[68:69], v[108:109], v[244:245], v[68:69] op_sel:[0,0,0] op_sel_hi:[1,0,1]
    v_pk_fma_f32 v[70:71], v[110:111], v[244:245], v[70:71] op_sel:[0,0,0] op_sel_hi:[1,0,1]
    v_pk_mul_f32 v[68:69], v[68:69], v[112:113]
    v_pk_mul_f32 v[70:71], v[70:71], v[114:115]
    v_cvt_pk_bf16_f32 v68, v68, v69
    v_cvt_pk_bf16_f32 v69, v70, v71
    buffer_load_dwordx4 a[44:47], v4, s[20:23], s32 offen offset:1024
    v_pk_fma_f32 v[72:73], v[116:117], v[244:245], v[72:73] op_sel:[0,0,0] op_sel_hi:[1,0,1]
    v_pk_fma_f32 v[74:75], v[118:119], v[244:245], v[74:75] op_sel:[0,0,0] op_sel_hi:[1,0,1]
    v_pk_mul_f32 v[72:73], v[72:73], v[120:121]
    v_pk_mul_f32 v[74:75], v[74:75], v[122:123]
    v_cvt_pk_bf16_f32 v70, v72, v73
    v_cvt_pk_bf16_f32 v71, v74, v75
    s_waitcnt lgkmcnt(0)
    v_pk_fma_f32 v[76:77], v[88:89], v[244:245], v[76:77] op_sel:[0,0,0] op_sel_hi:[1,0,1]
    v_pk_fma_f32 v[78:79], v[90:91], v[244:245], v[78:79] op_sel:[0,0,0] op_sel_hi:[1,0,1]
    v_pk_mul_f32 v[76:77], v[76:77], v[92:93]
    v_pk_mul_f32 v[78:79], v[78:79], v[94:95]
    v_cvt_pk_bf16_f32 v72, v76, v77
    v_cvt_pk_bf16_f32 v73, v78, v79
    v_pk_fma_f32 v[80:81], v[96:97], v[244:245], v[80:81] op_sel:[0,0,0] op_sel_hi:[1,0,1]
    v_pk_fma_f32 v[82:83], v[98:99], v[244:245], v[82:83] op_sel:[0,0,0] op_sel_hi:[1,0,1]
    v_pk_mul_f32 v[80:81], v[80:81], v[100:101]
    v_pk_mul_f32 v[82:83], v[82:83], v[102:103]
    v_cvt_pk_bf16_f32 v74, v80, v81
    v_cvt_pk_bf16_f32 v75, v82, v83
    s_bfe_u32 s55, s56, 196624
    v_lshl_add_u32 v4, s55, 11, v1
    buffer_load_dwordx4 a[52:55], v4, s[20:23], s30 offen offset:0
    v_pk_fma_f32 v[84:85], v[104:105], v[244:245], v[84:85] op_sel:[0,0,0] op_sel_hi:[1,0,1]
    v_pk_fma_f32 v[86:87], v[106:107], v[244:245], v[86:87] op_sel:[0,0,0] op_sel_hi:[1,0,1]
    v_pk_mul_f32 v[84:85], v[84:85], v[124:125]
    v_pk_mul_f32 v[86:87], v[86:87], v[126:127]
    v_cvt_pk_bf16_f32 v76, v84, v85
    v_cvt_pk_bf16_f32 v77, v86, v87
    v_pk_fma_f32 v[64:65], v[240:241], v[24:25], v[64:65] op_sel:[0,0,0] op_sel_hi:[1,0,1]
    v_pk_fma_f32 v[66:67], v[242:243], v[24:25], v[66:67] op_sel:[0,0,0] op_sel_hi:[1,0,1]
    v_pk_mul_f32 v[64:65], v[64:65], v[24:25] op_sel:[0,1] op_sel_hi:[1,1]
    v_pk_mul_f32 v[66:67], v[66:67], v[24:25] op_sel:[0,1] op_sel_hi:[1,1]
    v_cvt_pk_bf16_f32 v64, v64, v65
    v_cvt_pk_bf16_f32 v65, v66, v67
    v_pk_fma_f32 v[48:49], v[240:241], v[16:17], v[48:49] op_sel:[0,0,0] op_sel_hi:[1,0,1]
    v_pk_fma_f32 v[50:51], v[242:243], v[16:17], v[50:51] op_sel:[0,0,0] op_sel_hi:[1,0,1]
    v_pk_mul_f32 v[48:49], v[48:49], v[16:17] op_sel:[0,1] op_sel_hi:[1,1]
    v_pk_mul_f32 v[50:51], v[50:51], v[16:17] op_sel:[0,1] op_sel_hi:[1,1]
    v_cvt_pk_bf16_f32 v48, v48, v49
    v_cvt_pk_bf16_f32 v49, v50, v51
    buffer_load_dwordx4 a[56:59], v4, s[20:23], s31 offen offset:0
    v_pk_fma_f32 v[52:53], v[240:241], v[18:19], v[52:53] op_sel:[0,0,0] op_sel_hi:[1,0,1]
    v_pk_fma_f32 v[54:55], v[242:243], v[18:19], v[54:55] op_sel:[0,0,0] op_sel_hi:[1,0,1]
    v_pk_mul_f32 v[52:53], v[52:53], v[18:19] op_sel:[0,1] op_sel_hi:[1,1]
    v_pk_mul_f32 v[54:55], v[54:55], v[18:19] op_sel:[0,1] op_sel_hi:[1,1]
    v_cvt_pk_bf16_f32 v52, v52, v53
    v_cvt_pk_bf16_f32 v53, v54, v55
    v_pk_fma_f32 v[56:57], v[240:241], v[20:21], v[56:57] op_sel:[0,0,0] op_sel_hi:[1,0,1]
    v_pk_fma_f32 v[58:59], v[242:243], v[20:21], v[58:59] op_sel:[0,0,0] op_sel_hi:[1,0,1]
    v_pk_mul_f32 v[56:57], v[56:57], v[20:21] op_sel:[0,1] op_sel_hi:[1,1]
    v_pk_mul_f32 v[58:59], v[58:59], v[20:21] op_sel:[0,1] op_sel_hi:[1,1]
    v_cvt_pk_bf16_f32 v56, v56, v57
    v_cvt_pk_bf16_f32 v57, v58, v59
    v_pk_fma_f32 v[60:61], v[240:241], v[22:23], v[60:61] op_sel:[0,0,0] op_sel_hi:[1,0,1]
    v_pk_fma_f32 v[62:63], v[242:243], v[22:23], v[62:63] op_sel:[0,0,0] op_sel_hi:[1,0,1]
    v_pk_mul_f32 v[60:61], v[60:61], v[22:23] op_sel:[0,1] op_sel_hi:[1,1]
    v_pk_mul_f32 v[62:63], v[62:63], v[22:23] op_sel:[0,1] op_sel_hi:[1,1]
    v_cvt_pk_bf16_f32 v60, v60, v61
    v_cvt_pk_bf16_f32 v61, v62, v63
    buffer_load_dwordx4 a[64:67], v4, s[20:23], s32 offen offset:0
    v_mfma_f32_16x16x16_bf16 v[88:91], v[48:49], v[32:33], 0
    v_mul_f32 v16, 0x3eb8aa3b, v17
    v_mul_f32 v18, 0x3eb8aa3b, v19
    v_mfma_f32_16x16x16_bf16 v[92:95], v[64:65], v[32:33], 0
    v_mul_f32 v20, 0x3eb8aa3b, v21
    v_mul_f32 v22, 0x3eb8aa3b, v23
    v_mfma_f32_16x16x16_bf16 v[96:99], v[52:53], v[36:37], 0
    buffer_load_dwordx4 a[68:71], v4, s[20:23], s30 offen offset:1024
    v_mfma_f32_16x16x16_bf16 v[100:103], v[48:49], v[36:37], 0
    v_cndmask_b32 v88, v88, v89, s[48:49]
    v_cndmask_b32 v89, v90, v91, s[48:49]
    v_mfma_f32_16x16x16_bf16 v[104:107], v[56:57], v[40:41], 0
    v_cndmask_b32 v92, v92, v93, s[48:49]
    v_cndmask_b32 v93, v94, v95, s[48:49]
    v_mfma_f32_16x16x16_bf16 v[108:111], v[52:53], v[40:41], 0
    v_min_f32 v92, s45, v92
    v_min_f32 v93, s45, v93
    v_mfma_f32_16x16x16_bf16 v[112:115], v[60:61], v[44:45], 0
    v_cndmask_b32 v88, v92, v88, s[50:51]
    v_cndmask_b32 v89, v93, v89, s[52:53]
    v_mfma_f32_16x16x16_bf16 v[116:119], v[56:57], v[44:45], 0
    v_max_f32 v34, v88, v89
    v_cndmask_b32 v96, v96, v97, s[48:49]
    v_cndmask_b32 v97, v98, v99, s[48:49]
    v_cndmask_b32 v100, v100, v101, s[48:49]
    v_cndmask_b32 v101, v102, v103, s[48:49]
    v_cndmask_b32 v96, v100, v96, s[50:51]
    v_cndmask_b32 v97, v101, v97, s[52:53]
    v_max_f32 v38, v96, v97
    v_cndmask_b32 v104, v104, v105, s[48:49]
    v_cndmask_b32 v105, v106, v107, s[48:49]
    v_cndmask_b32 v108, v108, v109, s[48:49]
    v_permlane32_swap_b32 v34, v38
    v_cndmask_b32 v109, v110, v111, s[48:49]
    v_cndmask_b32 v104, v108, v104, s[50:51]
    v_cndmask_b32 v105, v109, v105, s[52:53]
    v_max_f32 v42, v104, v105
    v_cndmask_b32 v112, v112, v113, s[48:49]
    v_cndmask_b32 v113, v114, v115, s[48:49]
    v_cndmask_b32 v116, v116, v117, s[48:49]
    v_cndmask_b32 v117, v118, v119, s[48:49]
    v_cndmask_b32 v112, v116, v112, s[50:51]
    v_cndmask_b32 v113, v117, v113, s[52:53]
    v_max_f32 v46, v112, v113
    v_max_f32 v120, v34, v38
    s_nop 0
    v_permlane32_swap_b32 v42, v46
    v_max_f32 v122, v42, v46
    buffer_load_dwordx4 a[76:79], v4, s[20:23], s31 offen offset:1024
    s_nop 0
    v_permlane16_swap_b32 v120, v122
    v_max_f32 v124, v120, v122
    v_max_f32 v126, v120, v122
    s_nop 1
    v_permlane16_swap_b32 v124, v126
    v_mov_b32 v125, v124
    v_mov_b32 v127, v126
    s_nop 0
    v_permlane32_swap_b32 v124, v125
    v_permlane32_swap_b32 v126, v127
    v_pk_add_f32 v[88:89], v[88:89], v[124:125] op_sel:[0,0] op_sel_hi:[1,0] neg_lo:[0,1] neg_hi:[0,1]
    v_pk_add_f32 v[96:97], v[96:97], v[124:125] op_sel:[0,1] op_sel_hi:[1,1] neg_lo:[0,1] neg_hi:[0,1]
    v_pk_add_f32 v[104:105], v[104:105], v[126:127] op_sel:[0,0] op_sel_hi:[1,0] neg_lo:[0,1] neg_hi:[0,1]
    v_pk_add_f32 v[112:113], v[112:113], v[126:127] op_sel:[0,1] op_sel_hi:[1,1] neg_lo:[0,1] neg_hi:[0,1]
    v_pk_mul_f32 v[88:89], v[88:89], v[16:17] op_sel:[0,0] op_sel_hi:[1,0]
    v_pk_mul_f32 v[96:97], v[96:97], v[18:19] op_sel:[0,0] op_sel_hi:[1,0]
    v_pk_mul_f32 v[104:105], v[104:105], v[20:21] op_sel:[0,0] op_sel_hi:[1,0]
    v_pk_mul_f32 v[112:113], v[112:113], v[22:23] op_sel:[0,0] op_sel_hi:[1,0]
    v_exp_f32 v88, v88
    v_exp_f32 v89, v89
    v_cvt_pk_bf16_f32 v88, v88, v88
    v_cvt_pk_bf16_f32 v89, v89, v89
    v_and_b32 v92, v252, v88
    v_and_b32 v94, v254, v88
    v_and_b32 v93, v253, v89
    v_and_b32 v95, v255, v89
    v_exp_f32 v96, v96
    v_exp_f32 v97, v97
    v_mfma_f32_16x16x32_bf16 v[48:51], v[248:251], v[92:95], 0
    v_cvt_pk_bf16_f32 v96, v96, v96
    v_cvt_pk_bf16_f32 v97, v97, v97
    v_mfma_f32_16x16x32_bf16 v[88:91], v[68:71], v[92:95], 0
    v_and_b32 v100, v252, v96
    v_and_b32 v102, v254, v96
    v_and_b32 v101, v253, v97
    v_and_b32 v103, v255, v97
    v_exp_f32 v104, v104
    v_exp_f32 v105, v105
    v_mfma_f32_16x16x32_bf16 v[52:55], v[248:251], v[100:103], 0
    v_cvt_pk_bf16_f32 v104, v104, v104
    v_cvt_pk_bf16_f32 v105, v105, v105
    v_mfma_f32_16x16x32_bf16 v[96:99], v[70:73], v[100:103], 0
    v_and_b32 v108, v252, v104
    v_and_b32 v110, v254, v104
    v_and_b32 v109, v253, v105
    v_and_b32 v111, v255, v105
    v_exp_f32 v112, v112
    v_exp_f32 v113, v113
    v_mfma_f32_16x16x32_bf16 v[56:59], v[248:251], v[108:111], 0
    v_cvt_pk_bf16_f32 v112, v112, v112
    v_cvt_pk_bf16_f32 v113, v113, v113
    v_mfma_f32_16x16x32_bf16 v[104:107], v[72:75], v[108:111], 0
    v_and_b32 v116, v252, v112
    v_and_b32 v118, v254, v112
    v_and_b32 v117, v253, v113
    v_and_b32 v119, v255, v113
    v_rcp_f32 v48, v48
    v_rcp_f32 v52, v52
    v_mfma_f32_16x16x32_bf16 v[60:63], v[248:251], v[116:119], 0
    v_mul_f32 v88, v88, v48
    v_mul_f32 v89, v89, v48
    v_mfma_f32_16x16x32_bf16 v[112:115], v[74:77], v[116:119], 0
    v_mul_f32 v90, v90, v48
    v_mul_f32 v91, v91, v48
    v_cvt_pk_bf16_f32 v32, v88, v89
    v_cvt_pk_bf16_f32 v33, v90, v91
    v_mul_f32 v96, v96, v52
    v_mul_f32 v97, v97, v52
    v_mul_f32 v98, v98, v52
    v_mul_f32 v99, v99, v52
    v_cvt_pk_bf16_f32 v34, v96, v97
    v_cvt_pk_bf16_f32 v35, v98, v99
    v_rcp_f32 v56, v56
    v_rcp_f32 v60, v60
    v_permlane16_swap_b32 v32, v34
    v_permlane16_swap_b32 v33, v35
    buffer_store_dwordx4 v[32:35], v1, s[16:19], s57 offen sc1
    v_mul_f32 v104, v104, v56
    v_mul_f32 v105, v105, v56
    v_mul_f32 v106, v106, v56
    v_mul_f32 v107, v107, v56
    v_mul_f32 v112, v112, v60
    v_mul_f32 v113, v113, v60
    v_mul_f32 v114, v114, v60
    v_mul_f32 v115, v115, v60
    v_cvt_pk_bf16_f32 v40, v104, v105
    v_cvt_pk_bf16_f32 v42, v112, v113
    v_cvt_pk_bf16_f32 v41, v106, v107
    v_cvt_pk_bf16_f32 v43, v114, v115
    v_permlane16_swap_b32 v40, v42
    s_nop 0
    v_permlane16_swap_b32 v41, v43
    buffer_store_dwordx4 v[40:43], v1, s[16:19], s58 offen sc1
    v_add_u32 v11, 512, v0
    ds_read_b128 v[64:67], v0
    ds_read_b128 v[68:71], v11
    v_add_u32 v14, 0x8000, v15
    ds_read_b64_tr_b16 v[16:17], v14 offset:28672
    ds_read_b64_tr_b16 v[18:19], v14 offset:29184
    ds_read_b64_tr_b16 v[20:21], v14 offset:32768
    ds_read_b64_tr_b16 v[22:23], v14 offset:33280
    ds_read_b64_tr_b16 v[24:25], v14 offset:36864
    ds_read_b64_tr_b16 v[26:27], v14 offset:37376
    ds_read_b64_tr_b16 v[28:29], v15 offset:12288
    ds_read_b64_tr_b16 v[30:31], v15 offset:12800
    ds_read_b64_tr_b16 v[236:237], v15 offset:16384
    ds_read_b64_tr_b16 v[238:239], v15 offset:16896
    ds_read_b64_tr_b16 v[240:241], v15 offset:20480
    ds_read_b64_tr_b16 v[242:243], v15 offset:20992
    s_waitcnt lgkmcnt(12)
    v_lshlrev_b32 v32, 16, v64
    v_and_b32 v33, 0xffff0000, v64
    v_lshlrev_b32 v34, 16, v65
    v_and_b32 v35, 0xffff0000, v65
    v_lshlrev_b32 v36, 16, v66
    v_and_b32 v37, 0xffff0000, v66
    v_lshlrev_b32 v38, 16, v67
    v_and_b32 v39, 0xffff0000, v67
    v_lshlrev_b32 v40, 16, v68
    v_and_b32 v41, 0xffff0000, v68
    v_lshlrev_b32 v42, 16, v69
    v_and_b32 v43, 0xffff0000, v69
    v_lshlrev_b32 v44, 16, v70
    v_and_b32 v45, 0xffff0000, v70
    v_lshlrev_b32 v46, 16, v71
    v_and_b32 v47, 0xffff0000, v71
    v_mov_b32 v11, 5
    s_mov_b64 exec, 1
    s_waitcnt vmcnt(0)
    buffer_store_dword v11, off, s[16:19], s40 sc1
    s_mov_b64 exec, -1
    ds_read_b64_tr_b16 v[244:245], v15 offset:24576
    ds_read_b64_tr_b16 v[246:247], v15 offset:25088
    ds_read_b64_tr_b16 v[248:249], v15 offset:28672
    ds_read_b64_tr_b16 v[250:251], v15 offset:29184
    ds_read_b64_tr_b16 v[96:97], v14 offset:0
    ds_read_b64_tr_b16 v[98:99], v14 offset:512
    ds_read_b64_tr_b16 v[100:101], v14 offset:4096
    ds_read_b64_tr_b16 v[102:103], v14 offset:4608
    ds_read_b64_tr_b16 v[104:105], v14 offset:8192
    ds_read_b64_tr_b16 v[106:107], v14 offset:8704
    ds_read_b64_tr_b16 v[108:109], v14 offset:12288
    ds_read_b64_tr_b16 v[110:111], v14 offset:12800
    ds_read_b64_tr_b16 v[112:113], v14 offset:16384
    ds_read_b64_tr_b16 v[114:115], v14 offset:16896
    ds_read_b64_tr_b16 v[116:117], v14 offset:20480
    ds_read_b64_tr_b16 v[118:119], v14 offset:20992
    ds_read_b64_tr_b16 v[120:121], v14 offset:24576
    ds_read_b64_tr_b16 v[122:123], v14 offset:25088
    ds_read_b64_tr_b16 v[124:125], v14 offset:40960
    ds_read_b64_tr_b16 v[126:127], v14 offset:41472
    s_lshl_b32 s44, s6, 11
    s_add_u32 s57, s35, s44
    s_cmp_ge_u32 s6, 2
    s_cselect_b32 s58, 134217728, s57
    v_lshl_add_u32 v12, s6, 12, v2
    v_xor_b32 v13, 0x1000, v12
LS_poll_17:
    buffer_load_dword v11, v6, s[16:19], s39 offen sc1
    s_sub_u32 s46, s46, 1
    s_cbranch_scc1 L_end
    s_waitcnt vmcnt(0)
    v_cmp_gt_i32 vcc, 5, v11
    s_cbranch_vccnz LS_poll_17
    s_add_u32 m0, s44, 0
    s_nop 0
    buffer_load_dwordx4 v1, s[16:19], s57 offen offset:0 sc1 lds
    buffer_load_dwordx4 v1, s[16:19], s57 offen offset:1024 sc1 lds
    s_add_u32 s54, s57, 8192
    s_add_u32 m0, s44, 8192
    s_nop 0
    buffer_load_dwordx4 v1, s[16:19], s54 offen offset:0 sc1 lds
    buffer_load_dwordx4 v1, s[16:19], s54 offen offset:1024 sc1 lds
    s_add_u32 s54, s57, 16384
    s_add_u32 m0, s44, 16384
    s_nop 0
    buffer_load_dwordx4 v1, s[16:19], s54 offen offset:0 sc1 lds
    buffer_load_dwordx4 v1, s[16:19], s54 offen offset:1024 sc1 lds
    s_waitcnt vmcnt(4)
    s_barrier
    ds_read_b128 v[64:67], v3 offset:0
    ds_read_b128 v[68:71], v3 offset:2048
    ds_read_b128 v[72:75], v3 offset:4096
    ds_read_b128 v[76:79], v3 offset:6144
    s_add_u32 s54, s57, 24576
    s_add_u32 m0, s44, 24576
    s_nop 0
    buffer_load_dwordx4 v1, s[16:19], s54 offen offset:0 sc1 lds
    buffer_load_dwordx4 v1, s[16:19], s54 offen offset:1024 sc1 lds
    s_waitcnt lgkmcnt(3)
    v_mfma_f32_32x32x16_bf16 v[48:63], v[16:19], v[64:67], 0
    s_add_u32 s54, s57, 32768
    s_add_u32 m0, s44, 32768
    s_nop 0
    buffer_load_dwordx4 v1, s[16:19], s54 offen offset:0 sc1 lds
    s_waitcnt lgkmcnt(2)
    v_mfma_f32_32x32x16_bf16 v[48:63], v[20:23], v[68:71], v[48:63]
    s_waitcnt vmcnt(5)
    s_barrier
    ds_read_b128 v[80:83], v3 offset:8192
    ds_read_b128 v[84:87], v3 offset:10240
    s_waitcnt lgkmcnt(3)
    v_mfma_f32_32x32x16_bf16 v[48:63], v[24:27], v[72:75], v[48:63]
    ds_read_b128 v[88:91], v3 offset:12288
    ds_read_b128 v[92:95], v3 offset:14336
    s_waitcnt lgkmcnt(4)
    v_mfma_f32_32x32x16_bf16 v[48:63], v[28:31], v[76:79], v[48:63]
    buffer_load_dwordx4 v1, s[16:19], s54 offen offset:1024 sc1 lds
    s_waitcnt lgkmcnt(3)
    v_mfma_f32_32x32x16_bf16 v[48:63], v[236:239], v[80:83], v[48:63]
    s_add_u32 s54, s57, 40960
    s_add_u32 m0, s44, 40960
    s_nop 0
    buffer_load_dwordx4 v1, s[16:19], s54 offen offset:0 sc1 lds
    s_waitcnt lgkmcnt(2)
    v_mfma_f32_32x32x16_bf16 v[48:63], v[240:243], v[84:87], v[48:63]
    s_waitcnt vmcnt(5)
    s_barrier
    ds_read_b128 v[64:67], v3 offset:16384
    ds_read_b128 v[68:71], v3 offset:18432
    s_waitcnt lgkmcnt(3)
    v_mfma_f32_32x32x16_bf16 v[48:63], v[244:247], v[88:91], v[48:63]
    ds_read_b128 v[72:75], v3 offset:20480
    ds_read_b128 v[76:79], v3 offset:22528
    s_waitcnt lgkmcnt(4)
    v_mfma_f32_32x32x16_bf16 v[48:63], v[248:251], v[92:95], v[48:63]
    buffer_load_dwordx4 v1, s[16:19], s54 offen offset:1024 sc1 lds
    s_waitcnt lgkmcnt(3)
    v_mfma_f32_32x32x16_bf16 v[48:63], v[96:99], v[64:67], v[48:63]
    s_add_u32 s54, s57, 49152
    s_add_u32 m0, s44, 49152
    s_nop 0
    buffer_load_dwordx4 v1, s[16:19], s54 offen offset:0 sc1 lds
    s_waitcnt lgkmcnt(2)
    v_mfma_f32_32x32x16_bf16 v[48:63], v[100:103], v[68:71], v[48:63]
    s_waitcnt vmcnt(5)
    s_barrier
    ds_read_b128 v[80:83], v3 offset:24576
    ds_read_b128 v[84:87], v3 offset:26624
    s_waitcnt lgkmcnt(3)
    v_mfma_f32_32x32x16_bf16 v[48:63], v[104:107], v[72:75], v[48:63]
    ds_read_b128 v[88:91], v3 offset:28672
    ds_read_b128 v[92:95], v3 offset:30720
    s_waitcnt lgkmcnt(4)
    v_mfma_f32_32x32x16_bf16 v[48:63], v[108:111], v[76:79], v[48:63]
    buffer_load_dwordx4 v1, s[16:19], s54 offen offset:1024 sc1 lds
    s_waitcnt lgkmcnt(3)
    v_mfma_f32_32x32x16_bf16 v[48:63], v[112:115], v[80:83], v[48:63]
    s_add_u32 s54, s57, 57344
    s_add_u32 m0, s44, 57344
    s_nop 0
    buffer_load_dwordx4 v1, s[16:19], s54 offen offset:0 sc1 lds
    s_waitcnt lgkmcnt(2)
    v_mfma_f32_32x32x16_bf16 v[48:63], v[116:119], v[84:87], v[48:63]
    s_waitcnt vmcnt(5)
    s_barrier
    ds_read_b128 v[64:67], v3 offset:32768
    ds_read_b128 v[68:71], v3 offset:34816
    s_waitcnt lgkmcnt(3)
    v_mfma_f32_32x32x16_bf16 v[48:63], v[120:123], v[88:91], v[48:63]
    ds_read_b128 v[72:75], v3 offset:36864
    ds_read_b128 v[76:79], v3 offset:38912
    s_waitcnt lgkmcnt(4)
    v_mfma_f32_32x32x16_bf16 v[48:63], v[124:127], v[92:95], v[48:63]
    buffer_load_dwordx4 v1, s[16:19], s54 offen offset:1024 sc1 lds
    s_waitcnt lgkmcnt(3)
    v_mfma_f32_32x32x16_bf16 v[32:47], v[16:19], v[64:67], v[32:47]
    s_waitcnt lgkmcnt(2)
    v_mfma_f32_32x32x16_bf16 v[32:47], v[20:23], v[68:71], v[32:47]
    s_waitcnt vmcnt(4)
    s_barrier
    ds_read_b128 v[80:83], v3 offset:40960
    ds_read_b128 v[84:87], v3 offset:43008
    s_nop 2
    v_cvt_pk_bf16_f32 v48, v48, v49
    s_waitcnt lgkmcnt(3)
    v_mfma_f32_32x32x16_bf16 v[32:47], v[24:27], v[72:75], v[32:47]
    ds_read_b128 v[88:91], v3 offset:45056
    ds_read_b128 v[92:95], v3 offset:47104
    v_cvt_pk_bf16_f32 v49, v50, v51
    v_cvt_pk_bf16_f32 v50, v52, v53
    v_cvt_pk_bf16_f32 v51, v54, v55
    s_waitcnt lgkmcnt(4)
    v_mfma_f32_32x32x16_bf16 v[32:47], v[28:31], v[76:79], v[32:47]
    v_cvt_pk_bf16_f32 v52, v56, v57
    v_cvt_pk_bf16_f32 v53, v58, v59
    v_cvt_pk_bf16_f32 v54, v60, v61
    v_cvt_pk_bf16_f32 v55, v62, v63
    s_waitcnt lgkmcnt(3)
    v_mfma_f32_32x32x16_bf16 v[32:47], v[236:239], v[80:83], v[32:47]
    s_waitcnt lgkmcnt(2)
    v_mfma_f32_32x32x16_bf16 v[32:47], v[240:243], v[84:87], v[32:47]
    s_waitcnt vmcnt(2)
    s_barrier
    ds_read_b128 v[64:67], v3 offset:49152
    ds_read_b128 v[68:71], v3 offset:51200
    s_waitcnt lgkmcnt(3)
    v_mfma_f32_32x32x16_bf16 v[32:47], v[244:247], v[88:91], v[32:47]
    ds_read_b128 v[72:75], v3 offset:53248
    ds_read_b128 v[76:79], v3 offset:55296
    s_waitcnt lgkmcnt(4)
    v_mfma_f32_32x32x16_bf16 v[32:47], v[248:251], v[92:95], v[32:47]
    ds_write_b128 v12, v[48:51] offset:0
    s_waitcnt lgkmcnt(4)
    v_mfma_f32_32x32x16_bf16 v[32:47], v[96:99], v[64:67], v[32:47]
    ds_write_b128 v12, v[52:55] offset:1024
    buffer_load_dwordx4 a[80:83], v4, s[20:23], s32 offen offset:1024
    s_waitcnt lgkmcnt(4)
    v_mfma_f32_32x32x16_bf16 v[32:47], v[100:103], v[68:71], v[32:47]
    s_waitcnt lgkmcnt(0)
    s_waitcnt vmcnt(1)
    s_barrier
    ds_read_b128 v[80:83], v3 offset:57344
    ds_read_b128 v[84:87], v3 offset:59392
    v_mfma_f32_32x32x16_bf16 v[32:47], v[104:107], v[72:75], v[32:47]
    ds_read_b128 v[88:91], v3 offset:61440
    ds_read_b128 v[92:95], v3 offset:63488
    s_bfe_u32 s55, s56, 196628
    v_lshl_add_u32 v4, s55, 11, v1
    buffer_load_dwordx4 a[88:91], v4, s[20:23], s30 offen offset:0
    v_mfma_f32_32x32x16_bf16 v[32:47], v[108:111], v[76:79], v[32:47]
    ds_read_b128 v[56:59], v13 offset:0
    ds_read_b128 v[60:63], v13 offset:1024
    s_waitcnt lgkmcnt(5)
    v_mfma_f32_32x32x16_bf16 v[32:47], v[112:115], v[80:83], v[32:47]
    buffer_load_dwordx4 a[92:95], v4, s[20:23], s31 offen offset:0
    s_waitcnt lgkmcnt(0)
    v_lshlrev_b32 v48, 16, v56
    v_and_b32 v49, 0xffff0000, v56
    v_lshlrev_b32 v50, 16, v57
    v_mfma_f32_32x32x16_bf16 v[32:47], v[116:119], v[84:87], v[32:47]
    v_and_b32 v51, 0xffff0000, v57
    v_lshlrev_b32 v52, 16, v58
    v_and_b32 v53, 0xffff0000, v58
    v_lshlrev_b32 v54, 16, v59
    v_and_b32 v55, 0xffff0000, v59
    v_lshlrev_b32 v56, 16, v60
    v_mfma_f32_32x32x16_bf16 v[32:47], v[120:123], v[88:91], v[32:47]
    buffer_load_dwordx4 a[100:103], v4, s[20:23], s32 offen offset:0
    v_and_b32 v57, 0xffff0000, v60
    v_lshlrev_b32 v58, 16, v61
    v_and_b32 v59, 0xffff0000, v61
    v_lshlrev_b32 v60, 16, v62
    v_mfma_f32_32x32x16_bf16 v[32:47], v[124:127], v[92:95], v[32:47]
    v_and_b32 v61, 0xffff0000, v62
    v_lshlrev_b32 v62, 16, v63
    v_and_b32 v63, 0xffff0000, v63
    s_nop 8
    v_pk_add_f32 v[16:17], v[32:33], v[48:49]
    v_pk_add_f32 v[18:19], v[34:35], v[50:51]
    v_pk_add_f32 v[20:21], v[36:37], v[52:53]
    v_pk_add_f32 v[22:23], v[38:39], v[54:55]
    v_cvt_pk_bf16_f32 v80, v16, v17
    v_cvt_pk_bf16_f32 v81, v18, v19
    v_cvt_pk_bf16_f32 v82, v20, v21
    v_cvt_pk_bf16_f32 v83, v22, v23
    buffer_store_dwordx4 v[80:83], v5, s[16:19], s47 offen offset:0 sc1
    v_pk_add_f32 v[24:25], v[40:41], v[56:57]
    v_pk_add_f32 v[26:27], v[42:43], v[58:59]
    v_pk_add_f32 v[28:29], v[44:45], v[60:61]
    v_pk_add_f32 v[30:31], v[46:47], v[62:63]
    v_cvt_pk_bf16_f32 v84, v24, v25
    v_cvt_pk_bf16_f32 v85, v26, v27
    v_cvt_pk_bf16_f32 v86, v28, v29
    v_cvt_pk_bf16_f32 v87, v30, v31
    buffer_store_dwordx4 v[84:87], v5, s[16:19], s47 offen offset:512 sc1
    v_pk_add_f32 v[12:13], v[16:17], v[18:19]
    v_pk_mul_f32 v[78:79], v[16:17], v[16:17]
    v_pk_fma_f32 v[78:79], v[18:19], v[18:19], v[78:79]
    v_pk_add_f32 v[12:13], v[12:13], v[20:21]
    v_pk_fma_f32 v[78:79], v[20:21], v[20:21], v[78:79]
    v_pk_add_f32 v[12:13], v[12:13], v[22:23]
    v_pk_fma_f32 v[78:79], v[22:23], v[22:23], v[78:79]
    v_pk_add_f32 v[12:13], v[12:13], v[24:25]
    v_pk_fma_f32 v[78:79], v[24:25], v[24:25], v[78:79]
    v_pk_add_f32 v[12:13], v[12:13], v[26:27]
    v_pk_fma_f32 v[78:79], v[26:27], v[26:27], v[78:79]
    v_pk_add_f32 v[12:13], v[12:13], v[28:29]
    v_pk_fma_f32 v[78:79], v[28:29], v[28:29], v[78:79]
    v_pk_add_f32 v[12:13], v[12:13], v[30:31]
    v_pk_fma_f32 v[78:79], v[30:31], v[30:31], v[78:79]
    v_add_f32 v12, v12, v13
    v_add_f32 v14, v78, v79
    s_nop 1
    v_permlane32_swap_b32 v12, v14
    v_add_f32 v14, v12, v14
    buffer_store_dword v14, v7, s[16:19], s36 offen sc1
    ds_write_b128 v0, v[80:83] offset:0
    ds_write_b128 v0, v[84:87] offset:512
    s_lshl_b32 s44, s6, 14
    s_add_u32 s58, s34, s44
    s_waitcnt lgkmcnt(0)
    s_barrier
    ds_read_b128 v[88:91], v1 offset:0
    ds_read_b128 v[92:95], v1 offset:16384
    ds_read_b128 v[96:99], v1 offset:32768
    ds_read_b128 v[100:103], v1 offset:49152
    s_waitcnt lgkmcnt(3)
    v_mfma_f32_16x16x32_bf16 v[32:35], a[0:3], v[88:91], 0
    ds_read_b128 v[104:107], v1 offset:1024
    s_mul_i32 s3, s6, 192
    v_mfma_f32_16x16x32_bf16 v[48:51], a[12:15], v[88:91], 0
    s_add_u32 s3, s3, 1792
    v_add_u32 v13, s3, v10
    v_mfma_f32_16x16x32_bf16 v[64:67], a[24:27], v[88:91], 0
    s_waitcnt lgkmcnt(3)
    ds_read_b128 v[108:111], v13 offset:0
    v_mfma_f32_16x16x32_bf16 v[36:39], a[0:3], v[92:95], 0
    ds_read_b128 v[88:91], v1 offset:17408
    v_mfma_f32_16x16x32_bf16 v[52:55], a[12:15], v[92:95], 0
    v_mov_b32 v11, 6
    s_mov_b64 exec, 1
    s_waitcnt vmcnt(0)
    buffer_store_dword v11, off, s[16:19], s40 sc1
    s_mov_b64 exec, -1
    v_mfma_f32_16x16x32_bf16 v[68:71], a[24:27], v[92:95], 0
    s_waitcnt lgkmcnt(4)
    ds_read_b128 v[112:115], v13 offset:64
    v_mfma_f32_16x16x32_bf16 v[40:43], a[0:3], v[96:99], 0
    ds_read_b128 v[92:95], v1 offset:33792
    v_mfma_f32_16x16x32_bf16 v[56:59], a[12:15], v[96:99], 0
    ds_read_b128 v[116:119], v13 offset:128
    v_mfma_f32_16x16x32_bf16 v[72:75], a[24:27], v[96:99], 0
    s_waitcnt lgkmcnt(6)
    v_mfma_f32_16x16x32_bf16 v[44:47], a[0:3], v[100:103], 0
    ds_read_b128 v[96:99], v1 offset:50176
    v_mfma_f32_16x16x32_bf16 v[60:63], a[12:15], v[100:103], 0
    v_mfma_f32_16x16x32_bf16 v[76:79], a[24:27], v[100:103], 0
    s_waitcnt lgkmcnt(6)
    v_mfma_f32_16x16x32_bf16 v[32:35], a[36:39], v[104:107], v[32:35]
    v_mfma_f32_16x16x32_bf16 v[48:51], a[48:51], v[104:107], v[48:51]
    v_mfma_f32_16x16x32_bf16 v[64:67], a[60:63], v[104:107], v[64:67]
    s_waitcnt lgkmcnt(4)
    v_mfma_f32_16x16x32_bf16 v[36:39], a[36:39], v[88:91], v[36:39]
    v_mfma_f32_16x16x32_bf16 v[52:55], a[48:51], v[88:91], v[52:55]
    v_mfma_f32_16x16x32_bf16 v[68:71], a[60:63], v[88:91], v[68:71]
    s_waitcnt lgkmcnt(2)
    v_mfma_f32_16x16x32_bf16 v[40:43], a[36:39], v[92:95], v[40:43]
    v_mfma_f32_16x16x32_bf16 v[56:59], a[48:51], v[92:95], v[56:59]
    buffer_load_dword v11, v6, s[16:19], s39 offen sc1
    v_mfma_f32_16x16x32_bf16 v[72:75], a[60:63], v[92:95], v[72:75]
    s_waitcnt lgkmcnt(0)
    v_mfma_f32_16x16x32_bf16 v[44:47], a[36:39], v[96:99], v[44:47]
    v_mfma_f32_16x16x32_bf16 v[60:63], a[48:51], v[96:99], v[60:63]
    v_mfma_f32_16x16x32_bf16 v[76:79], a[60:63], v[96:99], v[76:79]
    s_bfe_u32 s3, s56, 196612
    s_lshl_b32 s3, s3, 11
    s_add_u32 m0, s44, 2048
    s_add_u32 s57, s3, s58
    s_waitcnt vmcnt(0)
    v_cmp_gt_i32 vcc, 6, v11
    s_cbranch_vccnz LS_spin_19
LS_got_20:
    buffer_load_dwordx4 v1, s[16:19], s57 offen offset:0 sc1 lds
    buffer_load_dwordx4 v1, s[16:19], s57 offen offset:1024 sc1 lds
    s_bfe_u32 s3, s56, 196616
    s_lshl_b32 s3, s3, 11
    s_add_u32 m0, s44, 4096
    s_add_u32 s57, s3, s58
    buffer_load_dwordx4 v1, s[16:19], s57 offen offset:0 sc1 lds
    s_waitcnt vmcnt(2)
    s_barrier
    ds_read_b128 v[88:91], v1 offset:2048
    ds_read_b128 v[92:95], v1 offset:18432
    ds_read_b128 v[96:99], v1 offset:34816
    ds_read_b128 v[100:103], v1 offset:51200
    s_waitcnt lgkmcnt(3)
    v_mfma_f32_16x16x32_bf16 v[32:35], a[72:75], v[88:91], v[32:35]
    s_waitcnt vmcnt(1)
    s_barrier
    ds_read_b128 v[104:107], v1 offset:3072
    v_mfma_f32_16x16x32_bf16 v[48:51], a[84:87], v[88:91], v[48:51]
    buffer_load_dwordx4 v1, s[16:19], s57 offen offset:1024 sc1 lds
    v_mfma_f32_16x16x32_bf16 v[64:67], a[96:99], v[88:91], v[64:67]
    s_waitcnt lgkmcnt(3)
    v_mfma_f32_16x16x32_bf16 v[36:39], a[72:75], v[92:95], v[36:39]
    ds_read_b128 v[88:91], v1 offset:19456
    v_mfma_f32_16x16x32_bf16 v[52:55], a[84:87], v[92:95], v[52:55]
    s_bfe_u32 s3, s56, 196620
    s_lshl_b32 s3, s3, 11
    s_add_u32 m0, s44, 6144
    s_add_u32 s57, s3, s58
    buffer_load_dwordx4 v1, s[16:19], s57 offen offset:0 sc1 lds
    v_mfma_f32_16x16x32_bf16 v[68:71], a[96:99], v[92:95], v[68:71]
    s_waitcnt lgkmcnt(3)
    v_mfma_f32_16x16x32_bf16 v[40:43], a[72:75], v[96:99], v[40:43]
    ds_read_b128 v[92:95], v1 offset:35840
    v_mfma_f32_16x16x32_bf16 v[56:59], a[84:87], v[96:99], v[56:59]
    buffer_load_dwordx4 v1, s[16:19], s57 offen offset:1024 sc1 lds
    v_mfma_f32_16x16x32_bf16 v[72:75], a[96:99], v[96:99], v[72:75]
    s_waitcnt lgkmcnt(3)
    v_mfma_f32_16x16x32_bf16 v[44:47], a[72:75], v[100:103], v[44:47]
    ds_read_b128 v[96:99], v1 offset:52224
    v_mfma_f32_16x16x32_bf16 v[60:63], a[84:87], v[100:103], v[60:63]
    v_mfma_f32_16x16x32_bf16 v[76:79], a[96:99], v[100:103], v[76:79]
    s_waitcnt lgkmcnt(3)
    v_mfma_f32_16x16x32_bf16 v[32:35], a[108:111], v[104:107], v[32:35]
    s_waitcnt vmcnt(3)
    s_barrier
    ds_read_b128 v[100:103], v1 offset:4096
    v_mfma_f32_16x16x32_bf16 v[48:51], a[120:123], v[104:107], v[48:51]
    s_bfe_u32 s3, s56, 196624
    s_lshl_b32 s3, s3, 11
    s_add_u32 m0, s44, 8192
    s_add_u32 s57, s3, s58
    buffer_load_dwordx4 v1, s[16:19], s57 offen offset:0 sc1 lds
    v_mfma_f32_16x16x32_bf16 v[64:67], a[132:135], v[104:107], v[64:67]
    s_waitcnt lgkmcnt(3)
    v_mfma_f32_16x16x32_bf16 v[36:39], a[108:111], v[88:91], v[36:39]
    ds_read_b128 v[104:107], v1 offset:20480
    v_mfma_f32_16x16x32_bf16 v[52:55], a[120:123], v[88:91], v[52:55]
    buffer_load_dwordx4 v1, s[16:19], s57 offen offset:1024 sc1 lds
    v_mfma_f32_16x16x32_bf16 v[68:71], a[132:135], v[88:91], v[68:71]
    s_waitcnt lgkmcnt(3)
    v_mfma_f32_16x16x32_bf16 v[40:43], a[108:111], v[92:95], v[40:43]
    ds_read_b128 v[88:91], v1 offset:36864
    v_mfma_f32_16x16x32_bf16 v[56:59], a[120:123], v[92:95], v[56:59]
    s_bfe_u32 s3, s56, 196628
    s_lshl_b32 s3, s3, 11
    s_add_u32 m0, s44, 10240
    s_add_u32 s57, s3, s58
    buffer_load_dwordx4 v1, s[16:19], s57 offen offset:0 sc1 lds
    v_mfma_f32_16x16x32_bf16 v[72:75], a[132:135], v[92:95], v[72:75]
    s_waitcnt lgkmcnt(3)
    v_mfma_f32_16x16x32_bf16 v[44:47], a[108:111], v[96:99], v[44:47]
    ds_read_b128 v[92:95], v1 offset:53248
    v_mfma_f32_16x16x32_bf16 v[60:63], a[120:123], v[96:99], v[60:63]
    v_mfma_f32_16x16x32_bf16 v[76:79], a[132:135], v[96:99], v[76:79]
    s_waitcnt lgkmcnt(3)
    v_mfma_f32_16x16x32_bf16 v[32:35], a[144:147], v[100:103], v[32:35]
    s_waitcnt vmcnt(4)
    s_barrier
    ds_read_b128 v[96:99], v1 offset:5120
    v_mfma_f32_16x16x32_bf16 v[48:51], a[156:159], v[100:103], v[48:51]
    buffer_load_dwordx4 v1, s[16:19], s57 offen offset:1024 sc1 lds
    v_mfma_f32_16x16x32_bf16 v[64:67], a[168:171], v[100:103], v[64:67]
    s_waitcnt lgkmcnt(3)
    v_mfma_f32_16x16x32_bf16 v[36:39], a[144:147], v[104:107], v[36:39]
    ds_read_b128 v[100:103], v1 offset:21504
    v_mfma_f32_16x16x32_bf16 v[52:55], a[156:159], v[104:107], v[52:55]
    s_bfe_u32 s3, s56, 196632
    s_lshl_b32 s3, s3, 11
    s_add_u32 m0, s44, 12288
    s_add_u32 s57, s3, s58
    buffer_load_dwordx4 v1, s[16:19], s57 offen offset:0 sc1 lds
    v_mfma_f32_16x16x32_bf16 v[68:71], a[168:171], v[104:107], v[68:71]
    s_waitcnt lgkmcnt(3)
    v_mfma_f32_16x16x32_bf16 v[40:43], a[144:147], v[88:91], v[40:43]
    ds_read_b128 v[104:107], v1 offset:37888
    v_mfma_f32_16x16x32_bf16 v[56:59], a[156:159], v[88:91], v[56:59]
    buffer_load_dwordx4 v1, s[16:19], s57 offen offset:1024 sc1 lds
    v_mfma_f32_16x16x32_bf16 v[72:75], a[168:171], v[88:91], v[72:75]
    s_waitcnt lgkmcnt(3)
    v_mfma_f32_16x16x32_bf16 v[44:47], a[144:147], v[92:95], v[44:47]
    ds_read_b128 v[88:91], v1 offset:54272
    v_mfma_f32_16x16x32_bf16 v[60:63], a[156:159], v[92:95], v[60:63]
    v_mfma_f32_16x16x32_bf16 v[76:79], a[168:171], v[92:95], v[76:79]
    s_waitcnt lgkmcnt(3)
    v_mfma_f32_16x16x32_bf16 v[32:35], a[180:183], v[96:99], v[32:35]
    ds_read_b128 v[92:95], v1 offset:6144
    v_mfma_f32_16x16x32_bf16 v[48:51], a[4:7], v[96:99], v[48:51]
    s_bfe_u32 s3, s56, 196636
    s_lshl_b32 s3, s3, 11
    s_add_u32 m0, s44, 14336
    s_add_u32 s57, s3, s58
    buffer_load_dwordx4 v1, s[16:19], s57 offen offset:0 sc1 lds
    v_mfma_f32_16x16x32_bf16 v[64:67], a[8:11], v[96:99], v[64:67]
    s_waitcnt lgkmcnt(3)
    v_mfma_f32_16x16x32_bf16 v[36:39], a[180:183], v[100:103], v[36:39]
    ds_read_b128 v[96:99], v1 offset:22528
    v_mfma_f32_16x16x32_bf16 v[52:55], a[4:7], v[100:103], v[52:55]
    buffer_load_dwordx4 v1, s[16:19], s57 offen offset:1024 sc1 lds
    v_mfma_f32_16x16x32_bf16 v[68:71], a[8:11], v[100:103], v[68:71]
    s_waitcnt lgkmcnt(3)
    v_mfma_f32_16x16x32_bf16 v[40:43], a[180:183], v[104:107], v[40:43]
    ds_read_b128 v[100:103], v1 offset:38912
    v_mfma_f32_16x16x32_bf16 v[56:59], a[4:7], v[104:107], v[56:59]
    buffer_load_dwordx4 v[80:83], v8, s[16:19], s37 offen offset:0 sc1
    v_mfma_f32_16x16x32_bf16 v[72:75], a[8:11], v[104:107], v[72:75]
    s_waitcnt lgkmcnt(3)
    v_mfma_f32_16x16x32_bf16 v[44:47], a[180:183], v[88:91], v[44:47]
    ds_read_b128 v[104:107], v1 offset:55296
    v_mfma_f32_16x16x32_bf16 v[60:63], a[4:7], v[88:91], v[60:63]
    buffer_load_dwordx4 v[84:87], v8, s[16:19], s37 offen offset:1024 sc1
    v_mfma_f32_16x16x32_bf16 v[76:79], a[8:11], v[88:91], v[76:79]
    s_waitcnt lgkmcnt(3)
    v_mfma_f32_16x16x32_bf16 v[32:35], a[16:19], v[92:95], v[32:35]
    s_waitcnt vmcnt(6)
    s_barrier
    ds_read_b128 v[88:91], v1 offset:7168
    v_mfma_f32_16x16x32_bf16 v[48:51], a[20:23], v[92:95], v[48:51]
    v_mfma_f32_16x16x32_bf16 v[64:67], a[28:31], v[92:95], v[64:67]
    s_waitcnt lgkmcnt(3)
    v_mfma_f32_16x16x32_bf16 v[36:39], a[16:19], v[96:99], v[36:39]
    ds_read_b128 v[92:95], v1 offset:23552
    v_mfma_f32_16x16x32_bf16 v[52:55], a[20:23], v[96:99], v[52:55]
    buffer_load_dwordx4 a[104:107], v4, s[20:23], s30 offen offset:1024
    v_mfma_f32_16x16x32_bf16 v[68:71], a[28:31], v[96:99], v[68:71]
    s_waitcnt lgkmcnt(3)
    v_mfma_f32_16x16x32_bf16 v[40:43], a[16:19], v[100:103], v[40:43]
    ds_read_b128 v[96:99], v1 offset:39936
    v_mfma_f32_16x16x32_bf16 v[56:59], a[20:23], v[100:103], v[56:59]
    buffer_load_dwordx4 a[112:115], v4, s[20:23], s31 offen offset:1024
    v_mfma_f32_16x16x32_bf16 v[72:75], a[28:31], v[100:103], v[72:75]
    s_waitcnt lgkmcnt(3)
    v_mfma_f32_16x16x32_bf16 v[44:47], a[16:19], v[104:107], v[44:47]
    ds_read_b128 v[100:103], v1 offset:56320
    v_mfma_f32_16x16x32_bf16 v[60:63], a[20:23], v[104:107], v[60:63]
    buffer_load_dwordx4 a[116:119], v4, s[20:23], s32 offen offset:1024
    v_mfma_f32_16x16x32_bf16 v[76:79], a[28:31], v[104:107], v[76:79]
    s_waitcnt lgkmcnt(3)
    v_mfma_f32_16x16x32_bf16 v[32:35], a[32:35], v[88:91], v[32:35]
    ds_read_b128 v[104:107], v1 offset:8192
    v_mfma_f32_16x16x32_bf16 v[48:51], a[40:43], v[88:91], v[48:51]
    v_mfma_f32_16x16x32_bf16 v[64:67], a[44:47], v[88:91], v[64:67]
    s_waitcnt lgkmcnt(3)
    v_mfma_f32_16x16x32_bf16 v[36:39], a[32:35], v[92:95], v[36:39]
    ds_read_b128 v[88:91], v1 offset:24576
    v_mfma_f32_16x16x32_bf16 v[52:55], a[40:43], v[92:95], v[52:55]
    s_bfe_u32 s55, s56, 196632
    v_lshl_add_u32 v4, s55, 11, v1
    buffer_load_dwordx4 a[124:127], v4, s[20:23], s30 offen offset:0
    v_mfma_f32_16x16x32_bf16 v[68:71], a[44:47], v[92:95], v[68:71]
    s_waitcnt lgkmcnt(3)
    v_mfma_f32_16x16x32_bf16 v[40:43], a[32:35], v[96:99], v[40:43]
    ds_read_b128 v[92:95], v1 offset:40960
    v_mfma_f32_16x16x32_bf16 v[56:59], a[40:43], v[96:99], v[56:59]
    buffer_load_dwordx4 a[128:131], v4, s[20:23], s31 offen offset:0
    v_mfma_f32_16x16x32_bf16 v[72:75], a[44:47], v[96:99], v[72:75]
    s_waitcnt lgkmcnt(3)
    v_mfma_f32_16x16x32_bf16 v[44:47], a[32:35], v[100:103], v[44:47]
    ds_read_b128 v[96:99], v1 offset:57344
    v_mfma_f32_16x16x32_bf16 v[60:63], a[40:43], v[100:103], v[60:63]
    buffer_load_dwordx4 a[136:139], v4, s[20:23], s32 offen offset:0
    v_mfma_f32_16x16x32_bf16 v[76:79], a[44:47], v[100:103], v[76:79]
    s_waitcnt lgkmcnt(3)
    v_mfma_f32_16x16x32_bf16 v[32:35], a[52:55], v[104:107], v[32:35]
    ds_read_b128 v[100:103], v1 offset:9216
    v_mfma_f32_16x16x32_bf16 v[48:51], a[56:59], v[104:107], v[48:51]
    v_mfma_f32_16x16x32_bf16 v[64:67], a[64:67], v[104:107], v[64:67]
    s_waitcnt lgkmcnt(3)
    s_waitcnt vmcnt(6)
    v_add_f32 v80, v80, v82
    v_mfma_f32_16x16x32_bf16 v[36:39], a[52:55], v[88:91], v[36:39]
    ds_read_b128 v[104:107], v1 offset:25600
    v_add_f32 v81, v81, v83
    v_mfma_f32_16x16x32_bf16 v[52:55], a[56:59], v[88:91], v[52:55]
    buffer_load_dwordx4 a[140:143], v4, s[20:23], s30 offen offset:1024
    v_mfma_f32_16x16x32_bf16 v[68:71], a[64:67], v[88:91], v[68:71]
    s_waitcnt lgkmcnt(3)
    v_add_f32 v84, v84, v86
    v_add_f32 v85, v85, v87
    v_mfma_f32_16x16x32_bf16 v[40:43], a[52:55], v[92:95], v[40:43]
    ds_read_b128 v[88:91], v1 offset:41984
    v_add_f32 v80, v80, v84
    v_mfma_f32_16x16x32_bf16 v[56:59], a[56:59], v[92:95], v[56:59]
    buffer_load_dwordx4 a[148:151], v4, s[20:23], s31 offen offset:1024
    v_mfma_f32_16x16x32_bf16 v[72:75], a[64:67], v[92:95], v[72:75]
    s_waitcnt lgkmcnt(3)
    v_add_f32 v81, v81, v85
    v_lshl_add_u32 v82, s6, 7, v9
    v_mfma_f32_16x16x32_bf16 v[44:47], a[52:55], v[96:99], v[44:47]
    ds_read_b128 v[92:95], v1 offset:58368
    v_lshrrev_b32 v83, 1, v82
    v_mfma_f32_16x16x32_bf16 v[60:63], a[56:59], v[96:99], v[60:63]
    buffer_load_dwordx4 a[152:155], v4, s[20:23], s32 offen offset:1024
    v_mfma_f32_16x16x32_bf16 v[76:79], a[64:67], v[96:99], v[76:79]
    s_waitcnt lgkmcnt(3)
    v_permlane32_swap_b32 v80, v81
    v_mfma_f32_16x16x32_bf16 v[32:35], a[68:71], v[100:103], v[32:35]
    ds_read_b128 v[96:99], v1 offset:10240
    v_add_f32 v84, v80, v81
    v_mfma_f32_16x16x32_bf16 v[48:51], a[76:79], v[100:103], v[48:51]
    v_add_f32 v85, v80, v81
    v_add_u32 v83, 80896, v83
    v_mfma_f32_16x16x32_bf16 v[64:67], a[80:83], v[100:103], v[64:67]
    s_waitcnt lgkmcnt(3)
    v_permlane16_swap_b32 v84, v85
    v_mfma_f32_16x16x32_bf16 v[36:39], a[68:71], v[104:107], v[36:39]
    ds_read_b128 v[100:103], v1 offset:26624
    v_add_f32 v80, v84, v85
    v_mfma_f32_16x16x32_bf16 v[52:55], a[76:79], v[104:107], v[52:55]
    s_bfe_u32 s55, s56, 196636
    v_lshl_add_u32 v4, s55, 11, v1
    buffer_load_dwordx4 a[160:163], v4, s[20:23], s30 offen offset:0
    v_mfma_f32_16x16x32_bf16 v[68:71], a[80:83], v[104:107], v[68:71]
    s_waitcnt lgkmcnt(3)
    v_add_f32 v81, v84, v85
    v_mfma_f32_16x16x32_bf16 v[40:43], a[68:71], v[88:91], v[40:43]
    ds_read_b128 v[104:107], v1 offset:11264
    v_mfma_f32_16x16x32_bf16 v[56:59], a[76:79], v[88:91], v[56:59]
    buffer_load_dwordx4 a[164:167], v4, s[20:23], s31 offen offset:0
    v_mfma_f32_16x16x32_bf16 v[72:75], a[80:83], v[88:91], v[72:75]
    s_waitcnt lgkmcnt(3)
    v_permlane32_swap_b32 v80, v81
    v_mfma_f32_16x16x32_bf16 v[44:47], a[68:71], v[92:95], v[44:47]
    ds_read_b128 v[88:91], v1 offset:27648
    v_mul_f32 v80, 0xbb000000, v80
    v_mfma_f32_16x16x32_bf16 v[60:63], a[76:79], v[92:95], v[60:63]
    buffer_load_dwordx4 a[172:175], v4, s[20:23], s32 offen offset:0
    v_mfma_f32_16x16x32_bf16 v[76:79], a[80:83], v[92:95], v[76:79]
    s_waitcnt lgkmcnt(3)
    v_mul_f32 v81, 0x3b000000, v81
    v_fma_f32 v81, -v80, v80, v81
    v_mfma_f32_16x16x32_bf16 v[32:35], a[88:91], v[96:99], v[32:35]
    s_barrier
    ds_read_b128 v[92:95], v1 offset:12288
    v_mfma_f32_16x16x32_bf16 v[48:51], a[92:95], v[96:99], v[48:51]
    v_max_f32 v81, 0, v81
    v_add_f32 v81, 0x3727c5ac, v81
    v_mfma_f32_16x16x32_bf16 v[64:67], a[100:103], v[96:99], v[64:67]
    s_waitcnt lgkmcnt(3)
    v_rsq_f32 v81, v81
    v_mfma_f32_16x16x32_bf16 v[36:39], a[88:91], v[100:103], v[36:39]
    ds_read_b128 v[96:99], v1 offset:28672
    v_mfma_f32_16x16x32_bf16 v[52:55], a[92:95], v[100:103], v[52:55]
    buffer_load_dwordx4 a[176:179], v4, s[20:23], s30 offen offset:1024
    v_mfma_f32_16x16x32_bf16 v[68:71], a[100:103], v[100:103], v[68:71]
    s_waitcnt lgkmcnt(3)
    ds_write_b64 v82, v[80:81]
    s_waitcnt vmcnt(12)
    v_mfma_f32_16x16x32_bf16 v[32:35], a[104:107], v[104:107], v[32:35]
    ds_read_b128 v[100:103], v1 offset:13312
    s_waitcnt vmcnt(11)
    v_mfma_f32_16x16x32_bf16 v[48:51], a[112:115], v[104:107], v[48:51]
    buffer_load_dwordx4 a[184:187], v4, s[20:23], s31 offen offset:1024
    s_waitcnt vmcnt(11)
    v_mfma_f32_16x16x32_bf16 v[64:67], a[116:119], v[104:107], v[64:67]
    s_waitcnt lgkmcnt(4)
    ds_write2_b32 v83, v80, v81 offset0:0 offset1:128
    v_mfma_f32_16x16x32_bf16 v[36:39], a[104:107], v[88:91], v[36:39]
    ds_read_b128 v[104:107], v1 offset:29696
    v_mfma_f32_16x16x32_bf16 v[52:55], a[112:115], v[88:91], v[52:55]
    buffer_load_dwordx4 a[188:191], v4, s[20:23], s32 offen offset:1024
    v_mfma_f32_16x16x32_bf16 v[68:71], a[116:119], v[88:91], v[68:71]
    s_waitcnt lgkmcnt(5)
    s_waitcnt lgkmcnt(0)
    s_barrier
    ds_read_b64 v[80:81], v9 offset:0
    ds_read_b64 v[82:83], v9 offset:128
    ds_read_b64 v[84:85], v9 offset:256
    ds_read_b64 v[86:87], v9 offset:384
    s_waitcnt vmcnt(11)
    v_mfma_f32_16x16x32_bf16 v[32:35], a[124:127], v[92:95], v[32:35]
    ds_read_b128 v[88:91], v1 offset:14336
    s_waitcnt vmcnt(10)
    v_mfma_f32_16x16x32_bf16 v[48:51], a[128:131], v[92:95], v[48:51]
    s_waitcnt vmcnt(9)
    v_mfma_f32_16x16x32_bf16 v[64:67], a[136:139], v[92:95], v[64:67]
    v_mfma_f32_16x16x32_bf16 v[36:39], a[124:127], v[96:99], v[36:39]
    ds_read_b128 v[92:95], v1 offset:30720
    v_mfma_f32_16x16x32_bf16 v[52:55], a[128:131], v[96:99], v[52:55]
    v_mfma_f32_16x16x32_bf16 v[68:71], a[136:139], v[96:99], v[68:71]
    s_waitcnt vmcnt(8)
    v_mfma_f32_16x16x32_bf16 v[32:35], a[140:143], v[100:103], v[32:35]
    ds_read_b128 v[96:99], v1 offset:15360
    s_waitcnt vmcnt(7)
    v_mfma_f32_16x16x32_bf16 v[48:51], a[148:151], v[100:103], v[48:51]
    s_waitcnt vmcnt(6)
    v_mfma_f32_16x16x32_bf16 v[64:67], a[152:155], v[100:103], v[64:67]
    v_mfma_f32_16x16x32_bf16 v[36:39], a[140:143], v[104:107], v[36:39]
    ds_read_b128 v[100:103], v1 offset:31744
    v_mfma_f32_16x16x32_bf16 v[52:55], a[148:151], v[104:107], v[52:55]
    v_mfma_f32_16x16x32_bf16 v[68:71], a[152:155], v[104:107], v[68:71]
    s_waitcnt lgkmcnt(3)
    s_waitcnt vmcnt(5)
    v_mfma_f32_16x16x32_bf16 v[32:35], a[160:163], v[88:91], v[32:35]
    ds_read_b128 v[104:107], v1 offset:43008
    s_waitcnt vmcnt(4)
    v_mfma_f32_16x16x32_bf16 v[48:51], a[164:167], v[88:91], v[48:51]
    s_waitcnt vmcnt(3)
    v_mfma_f32_16x16x32_bf16 v[64:67], a[172:175], v[88:91], v[64:67]
    s_waitcnt lgkmcnt(3)
    v_mfma_f32_16x16x32_bf16 v[36:39], a[160:163], v[92:95], v[36:39]
    ds_read_b128 v[88:91], v1 offset:59392
    v_mfma_f32_16x16x32_bf16 v[52:55], a[164:167], v[92:95], v[52:55]
    v_mfma_f32_16x16x32_bf16 v[68:71], a[172:175], v[92:95], v[68:71]
    s_waitcnt lgkmcnt(3)
    s_waitcnt vmcnt(2)
    v_mfma_f32_16x16x32_bf16 v[32:35], a[176:179], v[96:99], v[32:35]
    ds_read_b128 v[92:95], v1 offset:44032
    s_waitcnt vmcnt(1)
    v_mfma_f32_16x16x32_bf16 v[48:51], a[184:187], v[96:99], v[48:51]
    s_waitcnt vmcnt(0)
    v_mfma_f32_16x16x32_bf16 v[64:67], a[188:191], v[96:99], v[64:67]
    s_waitcnt lgkmcnt(3)
    v_mfma_f32_16x16x32_bf16 v[36:39], a[176:179], v[100:103], v[36:39]
    ds_read_b128 v[96:99], v1 offset:60416
    v_mfma_f32_16x16x32_bf16 v[52:55], a[184:187], v[100:103], v[52:55]
    v_mfma_f32_16x16x32_bf16 v[68:71], a[188:191], v[100:103], v[68:71]
    s_waitcnt lgkmcnt(3)
    v_mfma_f32_16x16x32_bf16 v[40:43], a[88:91], v[104:107], v[40:43]
    ds_read_b128 v[100:103], v1 offset:45056
    v_mfma_f32_16x16x32_bf16 v[56:59], a[92:95], v[104:107], v[56:59]
    v_mfma_f32_16x16x32_bf16 v[72:75], a[100:103], v[104:107], v[72:75]
    s_waitcnt lgkmcnt(3)
    v_mfma_f32_16x16x32_bf16 v[44:47], a[88:91], v[88:91], v[44:47]
    ds_read_b128 v[104:107], v1 offset:61440
    v_mfma_f32_16x16x32_bf16 v[60:63], a[92:95], v[88:91], v[60:63]
    v_fmac_f32 v32, v108, v80
    v_fmac_f32 v33, v109, v80
    v_mfma_f32_16x16x32_bf16 v[76:79], a[100:103], v[88:91], v[76:79]
    s_waitcnt lgkmcnt(3)
    v_fmac_f32 v34, v110, v80
    v_fmac_f32 v35, v111, v80
    v_mfma_f32_16x16x32_bf16 v[40:43], a[104:107], v[92:95], v[40:43]
    ds_read_b128 v[88:91], v1 offset:46080
    v_cvt_pk_bf16_f32 v120, v32, v33
    v_mfma_f32_16x16x32_bf16 v[56:59], a[112:115], v[92:95], v[56:59]
    v_cvt_pk_bf16_f32 v121, v34, v35
    v_fmac_f32 v36, v108, v82
    v_mfma_f32_16x16x32_bf16 v[72:75], a[116:119], v[92:95], v[72:75]
    s_waitcnt lgkmcnt(3)
    v_fmac_f32 v37, v109, v82
    v_fmac_f32 v38, v110, v82
    v_mfma_f32_16x16x32_bf16 v[44:47], a[104:107], v[96:99], v[44:47]
    ds_read_b128 v[92:95], v1 offset:62464
    v_fmac_f32 v39, v111, v82
    v_mfma_f32_16x16x32_bf16 v[60:63], a[112:115], v[96:99], v[60:63]
    v_cvt_pk_bf16_f32 v122, v36, v37
    v_cvt_pk_bf16_f32 v123, v38, v39
    v_mfma_f32_16x16x32_bf16 v[76:79], a[116:119], v[96:99], v[76:79]
    s_waitcnt lgkmcnt(3)
    v_pk_max_i16 v120, v120, 0
    v_pk_max_i16 v122, v122, 0
    v_mfma_f32_16x16x32_bf16 v[40:43], a[124:127], v[100:103], v[40:43]
    ds_read_b128 v[96:99], v1 offset:47104
    v_pk_max_i16 v121, v121, 0
    v_mfma_f32_16x16x32_bf16 v[56:59], a[128:131], v[100:103], v[56:59]
    v_pk_max_i16 v123, v123, 0
    v_mfma_f32_16x16x32_bf16 v[72:75], a[136:139], v[100:103], v[72:75]
    s_waitcnt lgkmcnt(3)
    v_permlane16_swap_b32 v120, v122
    v_mfma_f32_16x16x32_bf16 v[44:47], a[124:127], v[104:107], v[44:47]
    ds_read_b128 v[100:103], v1 offset:63488
    v_mfma_f32_16x16x32_bf16 v[60:63], a[128:131], v[104:107], v[60:63]
    v_permlane16_swap_b32 v121, v123
    v_mfma_f32_16x16x32_bf16 v[76:79], a[136:139], v[104:107], v[76:79]
    s_waitcnt lgkmcnt(3)
    buffer_store_dwordx4 v[120:123], v1, s[16:19], s99 offen offset:0 sc1
    v_mfma_f32_16x16x32_bf16 v[40:43], a[140:143], v[88:91], v[40:43]
    ds_read_b128 v[104:107], v1 offset:48128
    v_fmac_f32 v48, v112, v80
    v_mfma_f32_16x16x32_bf16 v[56:59], a[148:151], v[88:91], v[56:59]
    v_fmac_f32 v49, v113, v80
    v_fmac_f32 v50, v114, v80
    v_mfma_f32_16x16x32_bf16 v[72:75], a[152:155], v[88:91], v[72:75]
    s_waitcnt lgkmcnt(3)
    v_fmac_f32 v51, v115, v80
    v_cvt_pk_bf16_f32 v124, v48, v49
    v_mfma_f32_16x16x32_bf16 v[44:47], a[140:143], v[92:95], v[44:47]
    ds_read_b128 v[88:91], v1 offset:64512
    v_cvt_pk_bf16_f32 v125, v50, v51
    v_mfma_f32_16x16x32_bf16 v[60:63], a[148:151], v[92:95], v[60:63]
    v_fmac_f32 v52, v112, v82
    v_fmac_f32 v53, v113, v82
    v_mfma_f32_16x16x32_bf16 v[76:79], a[152:155], v[92:95], v[76:79]
    s_waitcnt lgkmcnt(3)
    v_fmac_f32 v54, v114, v82
    v_fmac_f32 v55, v115, v82
    v_mfma_f32_16x16x32_bf16 v[40:43], a[160:163], v[96:99], v[40:43]
    v_cvt_pk_bf16_f32 v126, v52, v53
    v_cvt_pk_bf16_f32 v127, v54, v55
    v_mfma_f32_16x16x32_bf16 v[56:59], a[164:167], v[96:99], v[56:59]
    v_pk_max_i16 v124, v124, 0
    v_pk_max_i16 v126, v126, 0
    v_mfma_f32_16x16x32_bf16 v[72:75], a[172:175], v[96:99], v[72:75]
    s_waitcnt lgkmcnt(2)
    v_pk_max_i16 v125, v125, 0
    v_pk_max_i16 v127, v127, 0
    v_mfma_f32_16x16x32_bf16 v[44:47], a[160:163], v[100:103], v[44:47]
    v_permlane16_swap_b32 v124, v126
    v_mfma_f32_16x16x32_bf16 v[60:63], a[164:167], v[100:103], v[60:63]
    v_permlane16_swap_b32 v125, v127
    v_mfma_f32_16x16x32_bf16 v[76:79], a[172:175], v[100:103], v[76:79]
    s_waitcnt lgkmcnt(1)
    buffer_store_dwordx4 v[124:127], v1, s[16:19], s100 offen offset:1024 sc1
    v_mfma_f32_16x16x32_bf16 v[40:43], a[176:179], v[104:107], v[40:43]
    v_fmac_f32 v64, v116, v80
    v_fmac_f32 v65, v117, v80
    v_mfma_f32_16x16x32_bf16 v[56:59], a[184:187], v[104:107], v[56:59]
    v_fmac_f32 v66, v118, v80
    v_fmac_f32 v67, v119, v80
    v_mfma_f32_16x16x32_bf16 v[72:75], a[188:191], v[104:107], v[72:75]
    s_waitcnt lgkmcnt(0)
    v_cvt_pk_bf16_f32 v120, v64, v65
    v_cvt_pk_bf16_f32 v121, v66, v67
    v_mfma_f32_16x16x32_bf16 v[44:47], a[176:179], v[88:91], v[44:47]
    v_fmac_f32 v68, v116, v82
    v_fmac_f32 v69, v117, v82
    v_mfma_f32_16x16x32_bf16 v[60:63], a[184:187], v[88:91], v[60:63]
    v_fmac_f32 v70, v118, v82
    v_fmac_f32 v71, v119, v82
    v_mfma_f32_16x16x32_bf16 v[76:79], a[188:191], v[88:91], v[76:79]
    v_cvt_pk_bf16_f32 v122, v68, v69
    v_cvt_pk_bf16_f32 v123, v70, v71
    v_pk_max_i16 v120, v120, 0
    v_pk_max_i16 v122, v122, 0
    v_pk_max_i16 v121, v121, 0
    v_pk_max_i16 v123, v123, 0
    v_permlane16_swap_b32 v120, v122
    s_nop 0
    v_permlane16_swap_b32 v121, v123
    buffer_store_dwordx4 v[120:123], v1, s[16:19], s60 offen offset:2048 sc1
    v_pk_fma_f32 v[40:41], v[108:109], v[84:85], v[40:41] op_sel:[0,0,0] op_sel_hi:[1,0,1]
    v_pk_fma_f32 v[42:43], v[110:111], v[84:85], v[42:43] op_sel:[0,0,0] op_sel_hi:[1,0,1]
    v_cvt_pk_bf16_f32 v88, v40, v41
    v_cvt_pk_bf16_f32 v89, v42, v43
    v_pk_fma_f32 v[44:45], v[108:109], v[86:87], v[44:45] op_sel:[0,0,0] op_sel_hi:[1,0,1]
    v_pk_fma_f32 v[46:47], v[110:111], v[86:87], v[46:47] op_sel:[0,0,0] op_sel_hi:[1,0,1]
    v_cvt_pk_bf16_f32 v90, v44, v45
    v_cvt_pk_bf16_f32 v91, v46, v47
    v_pk_max_i16 v88, v88, 0
    v_pk_max_i16 v90, v90, 0
    v_pk_max_i16 v89, v89, 0
    v_pk_max_i16 v91, v91, 0
    v_permlane16_swap_b32 v88, v90
    s_nop 0
    v_permlane16_swap_b32 v89, v91
    buffer_store_dwordx4 v[88:91], v1, s[16:19], s100 offen offset:0 sc1
    v_pk_fma_f32 v[56:57], v[112:113], v[84:85], v[56:57] op_sel:[0,0,0] op_sel_hi:[1,0,1]
    v_pk_fma_f32 v[58:59], v[114:115], v[84:85], v[58:59] op_sel:[0,0,0] op_sel_hi:[1,0,1]
    v_cvt_pk_bf16_f32 v92, v56, v57
    v_cvt_pk_bf16_f32 v93, v58, v59
    v_pk_fma_f32 v[60:61], v[112:113], v[86:87], v[60:61] op_sel:[0,0,0] op_sel_hi:[1,0,1]
    v_pk_fma_f32 v[62:63], v[114:115], v[86:87], v[62:63] op_sel:[0,0,0] op_sel_hi:[1,0,1]
    v_cvt_pk_bf16_f32 v94, v60, v61
    v_cvt_pk_bf16_f32 v95, v62, v63
    v_pk_max_i16 v92, v92, 0
    v_pk_max_i16 v94, v94, 0
    v_pk_max_i16 v93, v93, 0
    v_pk_max_i16 v95, v95, 0
    v_permlane16_swap_b32 v92, v94
    s_nop 0
    v_permlane16_swap_b32 v93, v95
    buffer_store_dwordx4 v[92:95], v1, s[16:19], s99 offen offset:1024 sc1
    v_pk_fma_f32 v[72:73], v[116:117], v[84:85], v[72:73] op_sel:[0,0,0] op_sel_hi:[1,0,1]
    v_pk_fma_f32 v[74:75], v[118:119], v[84:85], v[74:75] op_sel:[0,0,0] op_sel_hi:[1,0,1]
    v_cvt_pk_bf16_f32 v96, v72, v73
    v_cvt_pk_bf16_f32 v97, v74, v75
    v_pk_fma_f32 v[76:77], v[116:117], v[86:87], v[76:77] op_sel:[0,0,0] op_sel_hi:[1,0,1]
    v_pk_fma_f32 v[78:79], v[118:119], v[86:87], v[78:79] op_sel:[0,0,0] op_sel_hi:[1,0,1]
    v_cvt_pk_bf16_f32 v98, v76, v77
    v_cvt_pk_bf16_f32 v99, v78, v79
    v_pk_max_i16 v96, v96, 0
    v_pk_max_i16 v98, v98, 0
    v_pk_max_i16 v97, v97, 0
    v_pk_max_i16 v99, v99, 0
    v_permlane16_swap_b32 v96, v98
    s_nop 0
    v_permlane16_swap_b32 v97, v99
    buffer_store_dwordx4 v[96:99], v1, s[16:19], s61 offen offset:2048 sc1
    v_mov_b32 v11, 7
    s_mov_b64 exec, 1
    s_waitcnt vmcnt(0)
    buffer_store_dword v11, off, s[16:19], s40 sc1
    s_mov_b64 exec, -1
    v_lshl_add_u32 v11, s25, 7, v6
    v_add_u32 v11, 161280, v11
    ds_read_b32 v14, v11
    s_lshl_b32 s44, s6, 11
    s_add_u32 s57, s35, s44
    s_cmp_ge_u32 s6, 2
    s_cselect_b32 s58, 134217728, s57
    v_lshl_add_u32 v12, s6, 12, v2
    v_xor_b32 v13, 0x1000, v12
    v_lshlrev_b32 v0, 8, v6
    v_lshrrev_b32 v11, 9, v1
    v_lshl_add_u32 v0, v11, 4, v0
    s_sleep 2
LS_poll_21:
    buffer_load_dword v11, v6, s[16:19], s39 offen sc1
    s_sub_u32 s46, s46, 1
    s_cbranch_scc1 L_end
    s_waitcnt vmcnt(0)
    v_cmp_gt_i32 vcc, 7, v11
    s_cbranch_vccnz LS_poll_21
    s_add_u32 m0, s44, 0
    s_nop 0
    buffer_load_dwordx4 v1, s[16:19], s57 offen offset:0 sc1 lds
    buffer_load_dwordx4 v1, s[16:19], s57 offen offset:1024 sc1 lds
    s_add_u32 s54, s57, 8192
    s_add_u32 m0, s44, 8192
    s_nop 0
    buffer_load_dwordx4 v1, s[16:19], s54 offen offset:0 sc1 lds
    buffer_load_dwordx4 v1, s[16:19], s54 offen offset:1024 sc1 lds
    s_add_u32 s54, s57, 16384
    s_add_u32 m0, s44, 16384
    s_nop 0
    buffer_load_dwordx4 v1, s[16:19], s54 offen offset:0 sc1 lds
    buffer_load_dwordx4 v1, s[16:19], s54 offen offset:1024 sc1 lds
    s_waitcnt vmcnt(4)
    s_barrier
    ds_read_b128 v[64:67], v3 offset:0
    ds_read_b128 v[68:71], v3 offset:2048
    ds_read_b128 v[72:75], v3 offset:4096
    ds_read_b128 v[76:79], v3 offset:6144
    s_add_u32 s54, s57, 24576
    s_add_u32 m0, s44, 24576
    s_nop 0
    buffer_load_dwordx4 v1, s[16:19], s54 offen offset:0 sc1 lds
    buffer_load_dwordx4 v1, s[16:19], s54 offen offset:1024 sc1 lds
    s_waitcnt lgkmcnt(3)
    v_mfma_f32_32x32x16_bf16 v[48:63], a[192:195], v[64:67], 0
    s_add_u32 s54, s57, 32768
    s_add_u32 m0, s44, 32768
    s_nop 0
    buffer_load_dwordx4 v1, s[16:19], s54 offen offset:0 sc1 lds
    s_waitcnt lgkmcnt(2)
    v_mfma_f32_32x32x16_bf16 v[48:63], a[196:199], v[68:71], v[48:63]
    s_waitcnt vmcnt(5)
    s_barrier
    ds_read_b128 v[80:83], v3 offset:8192
    ds_read_b128 v[84:87], v3 offset:10240
    s_waitcnt lgkmcnt(3)
    v_mfma_f32_32x32x16_bf16 v[48:63], a[200:203], v[72:75], v[48:63]
    ds_read_b128 v[88:91], v3 offset:12288
    ds_read_b128 v[92:95], v3 offset:14336
    s_waitcnt lgkmcnt(4)
    v_mfma_f32_32x32x16_bf16 v[48:63], a[204:207], v[76:79], v[48:63]
    buffer_load_dwordx4 v1, s[16:19], s54 offen offset:1024 sc1 lds
    s_waitcnt lgkmcnt(3)
    v_mfma_f32_32x32x16_bf16 v[48:63], a[208:211], v[80:83], v[48:63]
    s_add_u32 s54, s57, 40960
    s_add_u32 m0, s44, 40960
    s_nop 0
    buffer_load_dwordx4 v1, s[16:19], s54 offen offset:0 sc1 lds
    s_waitcnt lgkmcnt(2)
    v_mfma_f32_32x32x16_bf16 v[48:63], a[212:215], v[84:87], v[48:63]
    s_waitcnt vmcnt(5)
    s_barrier
    ds_read_b128 v[64:67], v3 offset:16384
    ds_read_b128 v[68:71], v3 offset:18432
    s_waitcnt lgkmcnt(3)
    v_mfma_f32_32x32x16_bf16 v[48:63], a[216:219], v[88:91], v[48:63]
    ds_read_b128 v[72:75], v3 offset:20480
    ds_read_b128 v[76:79], v3 offset:22528
    s_waitcnt lgkmcnt(4)
    v_mfma_f32_32x32x16_bf16 v[48:63], a[220:223], v[92:95], v[48:63]
    buffer_load_dwordx4 v1, s[16:19], s54 offen offset:1024 sc1 lds
    s_waitcnt lgkmcnt(3)
    v_mfma_f32_32x32x16_bf16 v[48:63], a[224:227], v[64:67], v[48:63]
    s_add_u32 s54, s57, 49152
    s_add_u32 m0, s44, 49152
    s_nop 0
    buffer_load_dwordx4 v1, s[16:19], s54 offen offset:0 sc1 lds
    s_waitcnt lgkmcnt(2)
    v_mfma_f32_32x32x16_bf16 v[48:63], a[228:231], v[68:71], v[48:63]
    s_waitcnt vmcnt(5)
    s_barrier
    ds_read_b128 v[80:83], v3 offset:24576
    ds_read_b128 v[84:87], v3 offset:26624
    s_waitcnt lgkmcnt(3)
    v_mfma_f32_32x32x16_bf16 v[48:63], a[232:235], v[72:75], v[48:63]
    ds_read_b128 v[88:91], v3 offset:28672
    ds_read_b128 v[92:95], v3 offset:30720
    s_waitcnt lgkmcnt(4)
    v_mfma_f32_32x32x16_bf16 v[48:63], a[236:239], v[76:79], v[48:63]
    buffer_load_dwordx4 v1, s[16:19], s54 offen offset:1024 sc1 lds
    s_waitcnt lgkmcnt(3)
    v_mfma_f32_32x32x16_bf16 v[48:63], a[240:243], v[80:83], v[48:63]
    s_add_u32 s54, s57, 57344
    s_add_u32 m0, s44, 57344
    s_nop 0
    buffer_load_dwordx4 v1, s[16:19], s54 offen offset:0 sc1 lds
    s_waitcnt lgkmcnt(2)
    v_mfma_f32_32x32x16_bf16 v[48:63], a[244:247], v[84:87], v[48:63]
    s_waitcnt vmcnt(5)
    s_barrier
    ds_read_b128 v[64:67], v3 offset:32768
    ds_read_b128 v[68:71], v3 offset:34816
    s_waitcnt lgkmcnt(3)
    v_mfma_f32_32x32x16_bf16 v[48:63], a[248:251], v[88:91], v[48:63]
    ds_read_b128 v[72:75], v3 offset:36864
    ds_read_b128 v[76:79], v3 offset:38912
    s_waitcnt lgkmcnt(4)
    v_mfma_f32_32x32x16_bf16 v[48:63], a[252:255], v[92:95], v[48:63]
    buffer_load_dwordx4 v1, s[16:19], s54 offen offset:1024 sc1 lds
    s_waitcnt lgkmcnt(3)
    v_mfma_f32_32x32x16_bf16 v[48:63], v[128:131], v[64:67], v[48:63]
    s_add_u32 s54, s57, 65536
    s_add_u32 m0, s44, 0
    s_nop 0
    buffer_load_dwordx4 v1, s[16:19], s54 offen offset:0 sc1 lds
    s_waitcnt lgkmcnt(2)
    v_mfma_f32_32x32x16_bf16 v[48:63], v[132:135], v[68:71], v[48:63]
    s_waitcnt vmcnt(5)
    s_barrier
    ds_read_b128 v[80:83], v3 offset:40960
    ds_read_b128 v[84:87], v3 offset:43008
    s_waitcnt lgkmcnt(3)
    v_mfma_f32_32x32x16_bf16 v[48:63], v[136:139], v[72:75], v[48:63]
    ds_read_b128 v[88:91], v3 offset:45056
    ds_read_b128 v[92:95], v3 offset:47104
    s_waitcnt lgkmcnt(4)
    v_mfma_f32_32x32x16_bf16 v[48:63], v[140:143], v[76:79], v[48:63]
    buffer_load_dwordx4 v1, s[16:19], s54 offen offset:1024 sc1 lds
    s_waitcnt lgkmcnt(3)
    v_mfma_f32_32x32x16_bf16 v[48:63], v[144:147], v[80:83], v[48:63]
    s_add_u32 s54, s57, 73728
    s_add_u32 m0, s44, 8192
    s_nop 0
    buffer_load_dwordx4 v1, s[16:19], s54 offen offset:0 sc1 lds
    s_waitcnt lgkmcnt(2)
    v_mfma_f32_32x32x16_bf16 v[48:63], v[148:151], v[84:87], v[48:63]
    s_waitcnt vmcnt(5)
    s_barrier
    ds_read_b128 v[64:67], v3 offset:49152
    ds_read_b128 v[68:71], v3 offset:51200
    s_waitcnt lgkmcnt(3)
    v_mfma_f32_32x32x16_bf16 v[48:63], v[152:155], v[88:91], v[48:63]
    ds_read_b128 v[72:75], v3 offset:53248
    ds_read_b128 v[76:79], v3 offset:55296
    s_waitcnt lgkmcnt(4)
    v_mfma_f32_32x32x16_bf16 v[48:63], v[156:159], v[92:95], v[48:63]
    buffer_load_dwordx4 v1, s[16:19], s54 offen offset:1024 sc1 lds
    s_waitcnt lgkmcnt(3)
    v_mfma_f32_32x32x16_bf16 v[48:63], v[160:163], v[64:67], v[48:63]
    s_add_u32 s54, s57, 81920
    s_add_u32 m0, s44, 16384
    s_nop 0
    buffer_load_dwordx4 v1, s[16:19], s54 offen offset:0 sc1 lds
    s_waitcnt lgkmcnt(2)
    v_mfma_f32_32x32x16_bf16 v[48:63], v[164:167], v[68:71], v[48:63]
    s_waitcnt vmcnt(5)
    s_barrier
    ds_read_b128 v[80:83], v3 offset:57344
    ds_read_b128 v[84:87], v3 offset:59392
    s_waitcnt lgkmcnt(3)
    v_mfma_f32_32x32x16_bf16 v[48:63], v[168:171], v[72:75], v[48:63]
    ds_read_b128 v[88:91], v3 offset:61440
    ds_read_b128 v[92:95], v3 offset:63488
    s_waitcnt lgkmcnt(4)
    v_mfma_f32_32x32x16_bf16 v[48:63], v[172:175], v[76:79], v[48:63]
    buffer_load_dwordx4 v1, s[16:19], s54 offen offset:1024 sc1 lds
    s_waitcnt lgkmcnt(3)
    v_mfma_f32_32x32x16_bf16 v[48:63], v[176:179], v[80:83], v[48:63]
    s_add_u32 s54, s57, 90112
    s_add_u32 m0, s44, 24576
    s_nop 0
    buffer_load_dwordx4 v1, s[16:19], s54 offen offset:0 sc1 lds
    s_waitcnt lgkmcnt(2)
    v_mfma_f32_32x32x16_bf16 v[48:63], v[180:183], v[84:87], v[48:63]
    s_waitcnt vmcnt(5)
    s_barrier
    ds_read_b128 v[64:67], v3 offset:0
    ds_read_b128 v[68:71], v3 offset:2048
    s_waitcnt lgkmcnt(3)
    v_mfma_f32_32x32x16_bf16 v[48:63], v[184:187], v[88:91], v[48:63]
    ds_read_b128 v[72:75], v3 offset:4096
    ds_read_b128 v[76:79], v3 offset:6144
    s_waitcnt lgkmcnt(4)
    v_mfma_f32_32x32x16_bf16 v[48:63], v[188:191], v[92:95], v[48:63]
    buffer_load_dwordx4 v1, s[16:19], s54 offen offset:1024 sc1 lds
    s_waitcnt lgkmcnt(3)
    v_mfma_f32_32x32x16_bf16 v[48:63], v[192:195], v[64:67], v[48:63]
    s_add_u32 s54, s57, 98304
    s_add_u32 m0, s44, 32768
    s_nop 0
    buffer_load_dwordx4 v1, s[16:19], s54 offen offset:0 sc1 lds
    s_waitcnt lgkmcnt(2)
    v_mfma_f32_32x32x16_bf16 v[48:63], v[196:199], v[68:71], v[48:63]
    s_waitcnt vmcnt(5)
    s_barrier
    ds_read_b128 v[80:83], v3 offset:8192
    ds_read_b128 v[84:87], v3 offset:10240
    s_waitcnt lgkmcnt(3)
    v_mfma_f32_32x32x16_bf16 v[48:63], v[200:203], v[72:75], v[48:63]
    ds_read_b128 v[88:91], v3 offset:12288
    ds_read_b128 v[92:95], v3 offset:14336
    s_waitcnt lgkmcnt(4)
    v_mfma_f32_32x32x16_bf16 v[48:63], v[204:207], v[76:79], v[48:63]
    buffer_load_dwordx4 v1, s[16:19], s54 offen offset:1024 sc1 lds
    s_waitcnt lgkmcnt(3)
    v_mfma_f32_32x32x16_bf16 v[48:63], v[208:211], v[80:83], v[48:63]
    s_add_u32 s54, s57, 106496
    s_add_u32 m0, s44, 40960
    s_nop 0
    buffer_load_dwordx4 v1, s[16:19], s54 offen offset:0 sc1 lds
    s_waitcnt lgkmcnt(2)
    v_mfma_f32_32x32x16_bf16 v[48:63], v[212:215], v[84:87], v[48:63]
    s_waitcnt vmcnt(5)
    s_barrier
    ds_read_b128 v[64:67], v3 offset:16384
    ds_read_b128 v[68:71], v3 offset:18432
    s_waitcnt lgkmcnt(3)
    v_mfma_f32_32x32x16_bf16 v[48:63], v[216:219], v[88:91], v[48:63]
    ds_read_b128 v[72:75], v3 offset:20480
    ds_read_b128 v[76:79], v3 offset:22528
    s_waitcnt lgkmcnt(4)
    v_mfma_f32_32x32x16_bf16 v[48:63], v[220:223], v[92:95], v[48:63]
    buffer_load_dwordx4 v1, s[16:19], s54 offen offset:1024 sc1 lds
    s_waitcnt lgkmcnt(3)
    v_mfma_f32_32x32x16_bf16 v[48:63], v[224:227], v[64:67], v[48:63]
    s_add_u32 s54, s57, 114688
    s_add_u32 m0, s44, 49152
    s_nop 0
    buffer_load_dwordx4 v1, s[16:19], s54 offen offset:0 sc1 lds
    s_waitcnt lgkmcnt(2)
    v_mfma_f32_32x32x16_bf16 v[48:63], v[228:231], v[68:71], v[48:63]
    s_waitcnt vmcnt(5)
    s_barrier
    ds_read_b128 v[80:83], v3 offset:24576
    ds_read_b128 v[84:87], v3 offset:26624
    s_waitcnt lgkmcnt(3)
    v_mfma_f32_32x32x16_bf16 v[48:63], v[232:235], v[72:75], v[48:63]
    ds_read_b128 v[88:91], v3 offset:28672
    ds_read_b128 v[92:95], v3 offset:30720
    s_waitcnt lgkmcnt(4)
    v_mfma_f32_32x32x16_bf16 v[32:47], a[192:195], v[76:79], 0
    buffer_load_dwordx4 v1, s[16:19], s54 offen offset:1024 sc1 lds
    s_waitcnt lgkmcnt(3)
    v_mfma_f32_32x32x16_bf16 v[32:47], a[196:199], v[80:83], v[32:47]
    s_add_u32 s54, s57, 122880
    s_add_u32 m0, s44, 57344
    s_nop 0
    buffer_load_dwordx4 v1, s[16:19], s54 offen offset:0 sc1 lds
    s_nop 0
    v_cvt_pk_bf16_f32 v48, v48, v49
    v_cvt_pk_bf16_f32 v49, v50, v51
    s_waitcnt lgkmcnt(2)
    v_mfma_f32_32x32x16_bf16 v[32:47], a[200:203], v[84:87], v[32:47]
    s_waitcnt vmcnt(5)
    s_barrier
    ds_read_b128 v[64:67], v3 offset:32768
    ds_read_b128 v[68:71], v3 offset:34816
    v_cvt_pk_bf16_f32 v50, v52, v53
    s_waitcnt lgkmcnt(3)
    v_mfma_f32_32x32x16_bf16 v[32:47], a[204:207], v[88:91], v[32:47]
    ds_read_b128 v[72:75], v3 offset:36864
    ds_read_b128 v[76:79], v3 offset:38912
    v_cvt_pk_bf16_f32 v51, v54, v55
    v_cvt_pk_bf16_f32 v52, v56, v57
    v_cvt_pk_bf16_f32 v53, v58, v59
    s_waitcnt lgkmcnt(4)
    v_mfma_f32_32x32x16_bf16 v[32:47], a[208:211], v[92:95], v[32:47]
    buffer_load_dwordx4 v1, s[16:19], s54 offen offset:1024 sc1 lds
    v_cvt_pk_bf16_f32 v54, v60, v61
    v_cvt_pk_bf16_f32 v55, v62, v63
    s_waitcnt lgkmcnt(3)
    v_mfma_f32_32x32x16_bf16 v[32:47], a[212:215], v[64:67], v[32:47]
    s_add_u32 s54, s57, 131072
    s_add_u32 m0, s44, 0
    s_nop 0
    buffer_load_dwordx4 v1, s[16:19], s54 offen offset:0 sc1 lds
    s_waitcnt lgkmcnt(2)
    v_mfma_f32_32x32x16_bf16 v[32:47], a[216:219], v[68:71], v[32:47]
    s_waitcnt vmcnt(5)
    s_barrier
    ds_read_b128 v[80:83], v3 offset:40960
    ds_read_b128 v[84:87], v3 offset:43008
    s_waitcnt lgkmcnt(3)
    v_mfma_f32_32x32x16_bf16 v[32:47], a[220:223], v[72:75], v[32:47]
    ds_read_b128 v[88:91], v3 offset:45056
    ds_read_b128 v[92:95], v3 offset:47104
    s_waitcnt lgkmcnt(4)
    v_mfma_f32_32x32x16_bf16 v[32:47], a[224:227], v[76:79], v[32:47]
    buffer_load_dwordx4 v1, s[16:19], s54 offen offset:1024 sc1 lds
    s_waitcnt lgkmcnt(3)
    v_mfma_f32_32x32x16_bf16 v[32:47], a[228:231], v[80:83], v[32:47]
    s_add_u32 s54, s57, 139264
    s_add_u32 m0, s44, 8192
    s_nop 0
    buffer_load_dwordx4 v1, s[16:19], s54 offen offset:0 sc1 lds
    s_waitcnt lgkmcnt(2)
    v_mfma_f32_32x32x16_bf16 v[32:47], a[232:235], v[84:87], v[32:47]
    s_waitcnt vmcnt(5)
    s_barrier
    ds_read_b128 v[64:67], v3 offset:49152
    ds_read_b128 v[68:71], v3 offset:51200
    s_waitcnt lgkmcnt(3)
    v_mfma_f32_32x32x16_bf16 v[32:47], a[236:239], v[88:91], v[32:47]
    ds_read_b128 v[72:75], v3 offset:53248
    ds_read_b128 v[76:79], v3 offset:55296
    s_waitcnt lgkmcnt(4)
    v_mfma_f32_32x32x16_bf16 v[32:47], a[240:243], v[92:95], v[32:47]
    buffer_load_dwordx4 v1, s[16:19], s54 offen offset:1024 sc1 lds
    s_waitcnt lgkmcnt(3)
    v_mfma_f32_32x32x16_bf16 v[32:47], a[244:247], v[64:67], v[32:47]
    s_add_u32 s54, s57, 147456
    s_add_u32 m0, s44, 16384
    s_nop 0
    buffer_load_dwordx4 v1, s[16:19], s54 offen offset:0 sc1 lds
    s_waitcnt lgkmcnt(2)
    v_mfma_f32_32x32x16_bf16 v[32:47], a[248:251], v[68:71], v[32:47]
    s_waitcnt vmcnt(5)
    s_barrier
    ds_read_b128 v[80:83], v3 offset:57344
    ds_read_b128 v[84:87], v3 offset:59392
    s_waitcnt lgkmcnt(3)
    v_mfma_f32_32x32x16_bf16 v[32:47], a[252:255], v[72:75], v[32:47]
    ds_read_b128 v[88:91], v3 offset:61440
    ds_read_b128 v[92:95], v3 offset:63488
    s_waitcnt lgkmcnt(4)
    v_mfma_f32_32x32x16_bf16 v[32:47], v[128:131], v[76:79], v[32:47]
    buffer_load_dwordx4 v1, s[16:19], s54 offen offset:1024 sc1 lds
    s_waitcnt lgkmcnt(3)
    v_mfma_f32_32x32x16_bf16 v[32:47], v[132:135], v[80:83], v[32:47]
    s_add_u32 s54, s57, 155648
    s_add_u32 m0, s44, 24576
    s_nop 0
    buffer_load_dwordx4 v1, s[16:19], s54 offen offset:0 sc1 lds
    s_waitcnt lgkmcnt(2)
    v_mfma_f32_32x32x16_bf16 v[32:47], v[136:139], v[84:87], v[32:47]
    s_waitcnt vmcnt(5)
    s_barrier
    ds_read_b128 v[64:67], v3 offset:0
    ds_read_b128 v[68:71], v3 offset:2048
    s_waitcnt lgkmcnt(3)
    v_mfma_f32_32x32x16_bf16 v[32:47], v[140:143], v[88:91], v[32:47]
    ds_read_b128 v[72:75], v3 offset:4096
    ds_read_b128 v[76:79], v3 offset:6144
    s_waitcnt lgkmcnt(4)
    v_mfma_f32_32x32x16_bf16 v[32:47], v[144:147], v[92:95], v[32:47]
    buffer_load_dwordx4 v1, s[16:19], s54 offen offset:1024 sc1 lds
    s_waitcnt lgkmcnt(3)
    v_mfma_f32_32x32x16_bf16 v[32:47], v[148:151], v[64:67], v[32:47]
    s_add_u32 s54, s57, 163840
    s_add_u32 m0, s44, 32768
    s_nop 0
    buffer_load_dwordx4 v1, s[16:19], s54 offen offset:0 sc1 lds
    s_waitcnt lgkmcnt(2)
    v_mfma_f32_32x32x16_bf16 v[32:47], v[152:155], v[68:71], v[32:47]
    s_waitcnt vmcnt(5)
    s_barrier
    ds_read_b128 v[80:83], v3 offset:8192
    ds_read_b128 v[84:87], v3 offset:10240
    s_waitcnt lgkmcnt(3)
    v_mfma_f32_32x32x16_bf16 v[32:47], v[156:159], v[72:75], v[32:47]
    ds_read_b128 v[88:91], v3 offset:12288
    ds_read_b128 v[92:95], v3 offset:14336
    s_waitcnt lgkmcnt(4)
    v_mfma_f32_32x32x16_bf16 v[32:47], v[160:163], v[76:79], v[32:47]
    buffer_load_dwordx4 v1, s[16:19], s54 offen offset:1024 sc1 lds
    s_waitcnt lgkmcnt(3)
    v_mfma_f32_32x32x16_bf16 v[32:47], v[164:167], v[80:83], v[32:47]
    s_add_u32 s54, s58, 172032
    s_add_u32 m0, s44, 40960
    s_nop 0
    buffer_load_dwordx4 v1, s[16:19], s54 offen offset:0 sc1 lds
    s_waitcnt lgkmcnt(2)
    v_mfma_f32_32x32x16_bf16 v[32:47], v[168:171], v[84:87], v[32:47]
    s_waitcnt vmcnt(5)
    s_barrier
    ds_read_b128 v[64:67], v3 offset:16384
    ds_read_b128 v[68:71], v3 offset:18432
    s_waitcnt lgkmcnt(3)
    v_mfma_f32_32x32x16_bf16 v[32:47], v[172:175], v[88:91], v[32:47]
    ds_read_b128 v[72:75], v3 offset:20480
    ds_read_b128 v[76:79], v3 offset:22528
    s_waitcnt lgkmcnt(4)
    v_mfma_f32_32x32x16_bf16 v[32:47], v[176:179], v[92:95], v[32:47]
    buffer_load_dwordx4 v1, s[16:19], s54 offen offset:1024 sc1 lds
    s_waitcnt lgkmcnt(3)
    v_mfma_f32_32x32x16_bf16 v[32:47], v[180:183], v[64:67], v[32:47]
    s_waitcnt lgkmcnt(2)
    v_mfma_f32_32x32x16_bf16 v[32:47], v[184:187], v[68:71], v[32:47]
    s_waitcnt vmcnt(4)
    s_barrier
    ds_read_b128 v[80:83], v3 offset:24576
    ds_read_b128 v[84:87], v3 offset:26624
    s_waitcnt lgkmcnt(3)
    v_mfma_f32_32x32x16_bf16 v[32:47], v[188:191], v[72:75], v[32:47]
    ds_read_b128 v[88:91], v3 offset:28672
    ds_read_b128 v[92:95], v3 offset:30720
    s_waitcnt lgkmcnt(4)
    v_mfma_f32_32x32x16_bf16 v[32:47], v[192:195], v[76:79], v[32:47]
    s_waitcnt lgkmcnt(3)
    v_mfma_f32_32x32x16_bf16 v[32:47], v[196:199], v[80:83], v[32:47]
    s_waitcnt lgkmcnt(2)
    v_mfma_f32_32x32x16_bf16 v[32:47], v[200:203], v[84:87], v[32:47]
    s_waitcnt vmcnt(2)
    s_barrier
    ds_read_b128 v[64:67], v3 offset:32768
    ds_read_b128 v[68:71], v3 offset:34816
    s_waitcnt lgkmcnt(3)
    v_mfma_f32_32x32x16_bf16 v[32:47], v[204:207], v[88:91], v[32:47]
    ds_read_b128 v[72:75], v3 offset:36864
    ds_read_b128 v[76:79], v3 offset:38912
    s_waitcnt lgkmcnt(4)
    v_mfma_f32_32x32x16_bf16 v[32:47], v[208:211], v[92:95], v[32:47]
    ds_write_b128 v12, v[48:51] offset:0
    s_waitcnt lgkmcnt(4)
    v_mfma_f32_32x32x16_bf16 v[32:47], v[212:215], v[64:67], v[32:47]
    ds_write_b128 v12, v[52:55] offset:1024
    s_waitcnt lgkmcnt(4)
    v_mfma_f32_32x32x16_bf16 v[32:47], v[216:219], v[68:71], v[32:47]
    s_waitcnt lgkmcnt(0)
    s_waitcnt vmcnt(0)
    s_barrier
    ds_read_b128 v[80:83], v3 offset:40960
    ds_read_b128 v[84:87], v3 offset:43008
    v_mfma_f32_32x32x16_bf16 v[32:47], v[220:223], v[72:75], v[32:47]
    ds_read_b128 v[56:59], v13 offset:0
    ds_read_b128 v[60:63], v13 offset:1024
    v_mfma_f32_32x32x16_bf16 v[32:47], v[224:227], v[76:79], v[32:47]
    s_waitcnt lgkmcnt(0)
    v_lshlrev_b32 v48, 16, v56
    v_and_b32 v49, 0xffff0000, v56
    v_lshlrev_b32 v50, 16, v57
    v_and_b32 v51, 0xffff0000, v57
    v_lshlrev_b32 v52, 16, v58
    v_and_b32 v53, 0xffff0000, v58
    v_mfma_f32_32x32x16_bf16 v[32:47], v[228:231], v[80:83], v[32:47]
    v_lshlrev_b32 v54, 16, v59
    v_and_b32 v55, 0xffff0000, v59
    v_lshlrev_b32 v56, 16, v60
    v_and_b32 v57, 0xffff0000, v60
    v_lshlrev_b32 v58, 16, v61
    v_and_b32 v59, 0xffff0000, v61
    v_mfma_f32_32x32x16_bf16 v[32:47], v[232:235], v[84:87], v[32:47]
    v_lshlrev_b32 v60, 16, v62
    v_and_b32 v61, 0xffff0000, v62
    v_lshlrev_b32 v62, 16, v63
    v_and_b32 v63, 0xffff0000, v63
    v_fmac_f32 v16, v14, v48
    v_fmac_f32 v17, v14, v49
    v_fmac_f32 v18, v14, v50
    v_fmac_f32 v19, v14, v51
    v_fmac_f32 v20, v14, v52
    v_fmac_f32 v21, v14, v53
    v_fmac_f32 v22, v14, v54
    v_fmac_f32 v23, v14, v55
    v_fmac_f32 v24, v14, v56
    v_fmac_f32 v25, v14, v57
    v_fmac_f32 v26, v14, v58
    v_fmac_f32 v27, v14, v59
    v_fmac_f32 v28, v14, v60
    v_fmac_f32 v29, v14, v61
    v_fmac_f32 v30, v14, v62
    v_fmac_f32 v31, v14, v63
    v_pk_fma_f32 v[16:17], v[32:33], v[14:15], v[16:17] op_sel:[0,0,0] op_sel_hi:[1,0,1]
    v_pk_fma_f32 v[18:19], v[34:35], v[14:15], v[18:19] op_sel:[0,0,0] op_sel_hi:[1,0,1]
    v_pk_fma_f32 v[20:21], v[36:37], v[14:15], v[20:21] op_sel:[0,0,0] op_sel_hi:[1,0,1]
    v_pk_fma_f32 v[22:23], v[38:39], v[14:15], v[22:23] op_sel:[0,0,0] op_sel_hi:[1,0,1]
    v_cvt_pk_bf16_f32 v64, v16, v17
    v_cvt_pk_bf16_f32 v65, v18, v19
    v_cvt_pk_bf16_f32 v66, v20, v21
    v_cvt_pk_bf16_f32 v67, v22, v23
    buffer_store_dwordx4 v[64:67], v0, s[12:15], s41 offen offset:0
    v_pk_fma_f32 v[24:25], v[40:41], v[14:15], v[24:25] op_sel:[0,0,0] op_sel_hi:[1,0,1]
    v_pk_fma_f32 v[26:27], v[42:43], v[14:15], v[26:27] op_sel:[0,0,0] op_sel_hi:[1,0,1]
    v_pk_fma_f32 v[28:29], v[44:45], v[14:15], v[28:29] op_sel:[0,0,0] op_sel_hi:[1,0,1]
    v_pk_fma_f32 v[30:31], v[46:47], v[14:15], v[30:31] op_sel:[0,0,0] op_sel_hi:[1,0,1]
    v_cvt_pk_bf16_f32 v68, v24, v25
    v_cvt_pk_bf16_f32 v69, v26, v27
    v_cvt_pk_bf16_f32 v70, v28, v29
    v_cvt_pk_bf16_f32 v71, v30, v31
    buffer_store_dwordx4 v[68:71], v0, s[12:15], s41 offen offset:32
    s_or_b32 s3, s2, s6
    s_cmp_lg_u32 s3, 0
    s_cbranch_scc1 LS_noE_22
    v_mov_b32 v12, s62
    v_mov_b32 v13, s63
    v_mov_b32 v11, 0
    s_mov_b64 exec, 1
    buffer_store_dwordx2 v[12:13], v11, s[16:19], 0 offen sc1
    s_mov_b64 exec, -1
LS_noE_22:
    s_endpgm
LS_retry_3:
    s_sleep 4
    s_mov_b64 exec, vcc
    s_movk_i32 s3, 8192
    buffer_load_dwordx4 v[128:131], v1, s[16:19], s3 offen offset:0 sc1
    buffer_load_dwordx4 v[132:135], v1, s[16:19], s3 offen offset:1024 sc1
    s_mov_b64 exec, -1
    s_sub_u32 s46, s46, 1
    s_cbranch_scc1 L_end
    s_waitcnt vmcnt(0)
    v_and_b32 v11, -16, v128
    v_xor_b32 v11, s62, v11
    v_xor_b32 v153, s63, v129
    v_or_b32 v152, v11, v153
    v_and_b32 v11, -16, v130
    v_xor_b32 v11, s62, v11
    v_xor_b32 v153, s63, v131
    v_or3_b32 v152, v11, v153, v152
    v_and_b32 v11, -16, v132
    v_xor_b32 v11, s62, v11
    v_xor_b32 v153, s63, v133
    v_or3_b32 v152, v11, v153, v152
    v_and_b32 v11, -16, v134
    v_xor_b32 v11, s62, v11
    v_xor_b32 v153, s63, v135
    v_or3_b32 v152, v11, v153, v152
    v_cmp_ne_u32 vcc, 0, v152
    s_cbranch_vccnz LS_retry_3
    s_branch LS_got_4
LS_spin_6:
    buffer_load_dword v11, v6, s[16:19], s39 offen sc1
    s_sub_u32 s46, s46, 1
    s_cbranch_scc1 L_end
    s_waitcnt vmcnt(0)
    v_cmp_gt_i32 vcc, 1, v11
    s_cbranch_vccnz LS_spin_6
    s_branch LS_got_7
LS_spin_10:
    buffer_load_dword v11, v6, s[16:19], s39 offen sc1
    s_sub_u32 s46, s46, 1
    s_cbranch_scc1 L_end
    s_waitcnt vmcnt(0)
    v_cmp_gt_i32 vcc, 3, v11
    s_cbranch_vccnz LS_spin_10
    s_branch LS_got_11
LS_spin_13:
    buffer_load_dword v11, v6, s[16:19], s39 offen sc1
    s_sub_u32 s46, s46, 1
    s_cbranch_scc1 L_end
    s_waitcnt vmcnt(0)
    v_cmp_gt_i32 vcc, 4, v11
    s_cbranch_vccnz LS_spin_13
    s_branch LS_got_14
LS_retry_15:
    s_sleep 4
    s_mov_b64 exec, vcc
    buffer_load_dwordx4 v[16:19], v1, s[16:19], s97 offen offset:0 sc1
    buffer_load_dwordx4 v[20:23], v1, s[16:19], s97 offen offset:1024 sc1
    buffer_load_dwordx4 v[24:27], v1, s[16:19], s98 offen offset:0 sc1
    buffer_load_dwordx4 v[28:31], v1, s[16:19], s98 offen offset:1024 sc1
    buffer_load_dwordx4 v[116:119], v124, s[16:19], s38 offen offset:2048 sc1
    buffer_load_dwordx4 v[120:123], v124, s[16:19], s38 offen offset:2304 sc1
    s_mov_b64 exec, -1
    s_sub_u32 s46, s46, 1
    s_cbranch_scc1 L_end
    s_waitcnt vmcnt(0)
    v_max3_u32 v11, v16, v17, v18
    v_max3_u32 v11, v11, v19, v20
    v_max3_u32 v11, v11, v21, v22
    v_max3_u32 v11, v11, v23, v24
    v_max3_u32 v11, v11, v25, v26
    v_max3_u32 v11, v11, v27, v28
    v_max3_u32 v11, v11, v29, v30
    v_max3_u32 v11, v11, v31, v116
    v_max3_u32 v11, v11, v117, v118
    v_max3_u32 v11, v11, v119, v120
    v_max3_u32 v11, v11, v121, v122
    v_max_u32 v11, v11, v123
    v_cmp_eq_u32 vcc, -1, v11
    s_cbranch_vccnz LS_retry_15
    s_branch LS_got_16
LS_spin_19:
    buffer_load_dword v11, v6, s[16:19], s39 offen sc1
    s_sub_u32 s46, s46, 1
    s_cbranch_scc1 L_end
    s_waitcnt vmcnt(0)
    v_cmp_gt_i32 vcc, 6, v11
    s_cbranch_vccnz LS_spin_19
    s_branch LS_got_20
.section .rodata,"a"
.p2align 6
.amdhsa_kernel interleave_layers__sliding_local_dilated__dense_activation_relu__prompt_kernel
  .amdhsa_next_free_vgpr 512
  .amdhsa_next_free_sgpr 102
  .amdhsa_accum_offset 256
  .amdhsa_group_segment_fixed_size 0
  .amdhsa_kernarg_size 72
  .amdhsa_user_sgpr_count 2
  .amdhsa_user_sgpr_kernarg_segment_ptr 1
  .amdhsa_system_sgpr_workgroup_id_x 1
  .amdhsa_float_denorm_mode_32 3
.end_amdhsa_kernel
```
